```python
import torch

def _softmax(x, axis=-1):
    return torch.softmax(x, dim=axis)

def _gelu(x):
    return torch.nn.functional.gelu(x, approximate='tanh')

def _silu(x):
    return torch.nn.functional.silu(x)

def _sigmoid(x):
    return torch.sigmoid(x)

def _layernorm(x, axis=-1, eps=1e-05):
    m = x.mean(dim=axis, keepdim=True)
    v = x.var(dim=axis, keepdim=True, unbiased=False)
    return (x - m) / torch.sqrt(v + eps)

def _scatter_add(tgt, idx, src, axis=0):
    return tgt.clone().index_add_(axis, idx, src)

def _segment_sum(src, seg, n):
    out = torch.zeros((n,) + src.shape[1:], dtype=src.dtype)
    return out.index_add_(0, seg, src)

def _pad(x, pw):
    flat = tuple((v for pair in reversed(pw) for v in pair))
    return torch.nn.functional.pad(x, flat)
kernel_name = 'adaLN_cond__mha_block__glu_gated_glu__prompt'

def setup_inputs():

    _w = lambda a: (lambda t: t.to(torch.bfloat16) if t.is_floating_point() else t)(torch.as_tensor(a))

    def _A_setup():
        B, S, D, H = (1, 2048, 512, 32)
        return {'x': _w((lambda *s: torch.randn(*s, dtype=torch.bfloat16) * 0.05)(B, S, D)), 'wqkv': _w((lambda *s: torch.randn(*s, dtype=torch.bfloat16) * 0.05)(D, 3 * D)), 'wo': _w((lambda *s: torch.randn(*s, dtype=torch.bfloat16) * 0.05)(D, D))}
    _A_in = _A_setup()

    def _B_setup():
        B, S, D, F = (1, 2048, 512, 1376)
        return {'x': _w((lambda *s: torch.randn(*s, dtype=torch.bfloat16) * 0.05)(B, S, D)), 'w_gate': _w((lambda *s: torch.randn(*s, dtype=torch.bfloat16) * 0.05)(D, F)), 'w_up': _w((lambda *s: torch.randn(*s, dtype=torch.bfloat16) * 0.05)(D, F)), 'w_down': _w((lambda *s: torch.randn(*s, dtype=torch.bfloat16) * 0.05)(F, D))}
    _B_in = _B_setup()
    return {'A_x': _A_in['x'], 'A_wqkv': _A_in['wqkv'], 'A_wo': _A_in['wo'], 'B_x': _B_in['x'], 'B_w_gate': _B_in['w_gate'], 'B_w_up': _B_in['w_up'], 'B_w_down': _B_in['w_down'], 'c': _w((lambda *s: torch.randn(*s, dtype=torch.bfloat16) * 0.1)(1, 512) * 8.0), 'w_mod': _w((lambda *s: torch.randn(*s, dtype=torch.bfloat16) * 0.1)(512, 6 * 512) * 512 ** (-0.5) * 8.0)}

def reference(A_x, A_wqkv, A_wo, B_x, B_w_gate, B_w_up, B_w_down, c, w_mod):

    def _A_ref(x, wqkv, wo):
        B, S, D = x.shape
        H = 32
        Dh = D // H
        qkv = (lambda x, *d: x.permute(*d))((x @ wqkv).reshape(B, S, 3, H, Dh), 2, 0, 3, 1, 4)
        q, k, v = (qkv[0], qkv[1], qkv[2])
        scores = torch.einsum('bhqd,bhkd->bhqk', q, k) * Dh ** (-0.5)
        p = _softmax(scores, axis=-1)
        o = torch.einsum('bhqk,bhkd->bhqd', p, v)
        return (lambda x, *d: x.permute(*d))(o, 0, 2, 1, 3).reshape(B, S, D) @ wo

    def _B_ref(x, w_gate, w_up, w_down):
        g = torch.einsum('bsd,df->bsf', x, w_gate)
        u = torch.einsum('bsd,df->bsf', x, w_up)
        h = _sigmoid(g) * u
        return torch.einsum('bsf,fd->bsd', h, w_down)
    x = A_x
    mod = (_silu(c) @ w_mod).reshape(c.shape[0], 6, 1, -1)
    sa, ca, ga, sb, cb, gb = (mod[:, 0].clone(), mod[:, 1].clone(), mod[:, 2].clone(), mod[:, 3].clone(), mod[:, 4].clone(), mod[:, 5].clone())
    h = _layernorm(x, axis=-1) * (1 + ca) + sa
    x = x + ga * _A_ref(h, A_wqkv, A_wo)
    h = _layernorm(x, axis=-1) * (1 + cb) + sb
    x = x + gb * _B_ref(h, B_w_gate, B_w_up, B_w_down)
    return x
```

```asm
; @launch kernel=k01_kernel grid=(256,1,1) block=(1024,1,1) lds=163840
; @launch kernel=k2_kernel grid=(256,1,1) block=(640,1,1) lds=147776
; @launch kernel=k345_kernel grid=(256,1,1) block=(256,1,1) lds=155712
.amdgcn_target "amdgcn-amd-amdhsa--gfx950"
.text
.p2align 8
.globl k01_kernel
.type k01_kernel,@function
k01_kernel:
    s_cmp_ge_u32 s2, 256
    s_cbranch_scc1 k01_kernel_end
    s_load_dwordx16 s[16:31], s[0:1], 0
    s_load_dwordx8 s[32:39], s[0:1], 64
    v_lshrrev_b32 v1, 6, v0
    v_and_b32 v2, 63, v0
    s_and_b32 s4, s2, 3
    v_readfirstlane_b32 s3, v1
    s_lshl_b32 s4, s4, 3
    s_lshr_b32 s9, s2, 6
    s_bfe_u32 s6, s2, 0x20003
    s_add_u32 s5, s6, s9
    s_and_b32 s5, s5, 3
    s_bfe_u32 s7, s2, 0x10005
    s_lshl_b32 s7, s7, 2
    s_add_u32 s5, s5, s7
    s_add_u32 s5, s5, s4
    s_bfe_u32 s4, s2, 0x10002
    s_lshl_b32 s4, s4, 2
    s_add_u32 s4, s4, s6
    s_and_b32 s10, s2, 63
    v_lshlrev_b32 v3, 4, v2
    v_lshrrev_b32 v4, 5, v2
    v_and_b32 v5, 31, v2
    s_cmp_ge_u32 s3, 8
    s_cbranch_scc1 k01_a
    s_cmp_ge_u32 s3, 4
    s_cbranch_scc1 k01_dma
    s_setprio 3
    v_lshrrev_b32 v7, 3, v2
    v_and_b32 v8, 7, v2
    v_mul_u32_u24 v6, 0x6000, v7
    v_lshl_add_u32 v6, v8, 4, v6
    v_lshlrev_b32 v7, 3, v7
    v_lshrrev_b32 v44, 4, v2
    v_lshlrev_b32 v44, 3, v44
    v_lshl_add_u32 v44, v8, 5, v44
    s_and_b32 s54, s10, 15
    s_lshl_b32 s52, s9, 4
    s_add_u32 s54, s54, s52
    s_lshr_b32 s62, s10, 4
    s_lshl_b32 s61, s62, 2
    s_add_u32 s61, s61, s3
    s_lshl_b32 s63, s62, 13
    s_lshl_b32 s62, s62, 12
    s_lshl_b32 s52, s54, 8
    s_add_u32 s62, s62, s52
    s_add_u32 s62, s62, 0x8000
    s_add_u32 s63, s63, s52
    s_add_u32 s63, s63, 0xff000
    s_mov_b32 s53, 0
    s_mov_b32 s8, 0
    v_mov_b32 v10, 0
    v_mov_b32 v42, 0
    v_mov_b32 v43, 0
    v_mov_b32 v46, 0x7fc5dead
    v_mov_b32 v47, 0x7fc5dead
    ds_write_b64 v10, v[42:43] offset:1024
    ds_write_b64 v10, v[42:43] offset:1032
    v_mov_b32 v36, 0
    v_mov_b32 v37, 0
    v_mov_b32 v38, 0
    v_mov_b32 v39, 0
    v_mov_b32 v40, 0
    v_mov_b32 v41, 0
    v_mov_b32 v42, 0
    v_mov_b32 v43, 0
    s_waitcnt lgkmcnt(0)
    s_mov_b32 s48, s30
    s_and_b32 s49, s31, 0xffff
    s_mov_b32 s50, 0x400
    s_mov_b32 s51, 0x20000
    s_mov_b32 s44, s32
    s_and_b32 s45, s33, 0xffff
    s_mov_b32 s46, 0x300000
    s_mov_b32 s47, 0x20000
    s_mov_b32 s40, s38
    s_and_b32 s41, s39, 0xffff
    s_mov_b32 s42, 0x2200000
    s_mov_b32 s43, 0x20000
    s_mov_b32 s56, s36
    s_and_b32 s57, s37, 0xffff
    s_mov_b32 s58, 0x100
    s_mov_b32 s59, 0x20000
    s_cmp_lg_u32 s9, 0
    s_cbranch_scc1 k01_np
    s_cmp_lg_u32 s3, 0
    s_cbranch_scc1 k01_nm
    s_mov_b32 exec_lo, 0x00ff00ff
    s_mov_b32 exec_hi, 0x00ff00ff
    buffer_store_dwordx2 v[46:47], v44, s[40:43], s62 offen sc1
    s_mov_b64 exec, -1
    s_lshl_b32 s52, s61, 6
    buffer_load_dwordx2 v[16:17], v7, s[48:51], s52 offen
    s_mul_i32 s52, s61, 196608
    s_lshl_b32 s55, s54, 7
    s_add_u32 s52, s52, s55
    buffer_load_dwordx4 v[48:51], v6, s[44:47], s52 offen
    s_add_u32 s52, s52, 6144
    buffer_load_dwordx4 v[52:55], v6, s[44:47], s52 offen
    s_add_u32 s52, s52, 6144
    buffer_load_dwordx4 v[56:59], v6, s[44:47], s52 offen
    s_add_u32 s52, s52, 6144
    buffer_load_dwordx4 v[60:63], v6, s[44:47], s52 offen
    s_mov_b32 s8, 1
    s_barrier
    s_waitcnt vmcnt(4)
    v_mov_b32 v46, 0
    v_mov_b32 v47, 1
    s_mov_b64 exec, 1
    buffer_atomic_add v47, v46, s[56:59], 0 offen offset:128 sc0
    s_mov_b64 exec, -1
    v_lshlrev_b32 v20, 16, v16
    v_and_b32 v21, 0xffff0000, v16
    v_lshlrev_b32 v22, 16, v17
    v_and_b32 v23, 0xffff0000, v17
    v_mul_f32 v28, 0xbfb8aa3b, v20
    v_mul_f32 v29, 0xbfb8aa3b, v21
    v_mul_f32 v30, 0xbfb8aa3b, v22
    v_mul_f32 v31, 0xbfb8aa3b, v23
    v_exp_f32 v28, v28
    v_exp_f32 v29, v29
    v_exp_f32 v30, v30
    v_exp_f32 v31, v31
    v_add_f32 v28, 1.0, v28
    v_add_f32 v29, 1.0, v29
    v_add_f32 v30, 1.0, v30
    v_add_f32 v31, 1.0, v31
    v_rcp_f32 v28, v28
    v_rcp_f32 v29, v29
    v_rcp_f32 v30, v30
    v_rcp_f32 v31, v31
    v_mul_f32 v20, v20, v28
    v_mul_f32 v21, v21, v29
    v_mul_f32 v22, v22, v30
    v_mul_f32 v23, v23, v31
    v_cvt_pk_bf16_f32 v20, v20, v20
    v_cvt_pk_bf16_f32 v21, v21, v21
    v_cvt_pk_bf16_f32 v22, v22, v22
    v_cvt_pk_bf16_f32 v23, v23, v23
    v_and_b32 v28, 0xffff, v20
    v_and_b32 v20, 0xffff0000, v20
    v_and_b32 v29, 0xffff, v21
    v_and_b32 v21, 0xffff0000, v21
    v_and_b32 v30, 0xffff, v22
    v_and_b32 v22, 0xffff0000, v22
    v_and_b32 v31, 0xffff, v23
    v_and_b32 v23, 0xffff0000, v23
    s_waitcnt vmcnt(4)
    v_dot2_f32_bf16 v36, v48, v28, v36
    v_dot2_f32_bf16 v37, v48, v20, v37
    v_dot2_f32_bf16 v38, v49, v28, v38
    v_dot2_f32_bf16 v39, v49, v20, v39
    v_dot2_f32_bf16 v40, v50, v28, v40
    v_dot2_f32_bf16 v41, v50, v20, v41
    v_dot2_f32_bf16 v42, v51, v28, v42
    v_dot2_f32_bf16 v43, v51, v20, v43
    s_waitcnt vmcnt(3)
    v_dot2_f32_bf16 v36, v52, v29, v36
    v_dot2_f32_bf16 v37, v52, v21, v37
    v_dot2_f32_bf16 v38, v53, v29, v38
    v_dot2_f32_bf16 v39, v53, v21, v39
    v_dot2_f32_bf16 v40, v54, v29, v40
    v_dot2_f32_bf16 v41, v54, v21, v41
    v_dot2_f32_bf16 v42, v55, v29, v42
    v_dot2_f32_bf16 v43, v55, v21, v43
    s_waitcnt vmcnt(2)
    v_dot2_f32_bf16 v36, v56, v30, v36
    v_dot2_f32_bf16 v37, v56, v22, v37
    v_dot2_f32_bf16 v38, v57, v30, v38
    v_dot2_f32_bf16 v39, v57, v22, v39
    v_dot2_f32_bf16 v40, v58, v30, v40
    v_dot2_f32_bf16 v41, v58, v22, v41
    v_dot2_f32_bf16 v42, v59, v30, v42
    v_dot2_f32_bf16 v43, v59, v22, v43
    s_waitcnt vmcnt(1)
    v_dot2_f32_bf16 v36, v60, v31, v36
    v_dot2_f32_bf16 v37, v60, v23, v37
    v_dot2_f32_bf16 v38, v61, v31, v38
    v_dot2_f32_bf16 v39, v61, v23, v39
    v_dot2_f32_bf16 v40, v62, v31, v40
    v_dot2_f32_bf16 v41, v62, v23, v41
    v_dot2_f32_bf16 v42, v63, v31, v42
    v_dot2_f32_bf16 v43, v63, v23, v43
    s_branch k01_red
k01_nm:
    s_lshl_b32 s52, s61, 6
    buffer_load_dwordx2 v[16:17], v7, s[48:51], s52 offen
    s_mul_i32 s52, s61, 196608
    s_lshl_b32 s55, s54, 7
    s_add_u32 s52, s52, s55
    buffer_load_dwordx4 v[48:51], v6, s[44:47], s52 offen
    s_add_u32 s52, s52, 6144
    buffer_load_dwordx4 v[52:55], v6, s[44:47], s52 offen
    s_add_u32 s52, s52, 6144
    buffer_load_dwordx4 v[56:59], v6, s[44:47], s52 offen
    s_add_u32 s52, s52, 6144
    buffer_load_dwordx4 v[60:63], v6, s[44:47], s52 offen
    s_barrier
    s_branch k01_dot
k01_np:
    s_sleep 8
    s_cmp_eq_u32 s9, 3
    s_cbranch_scc1 k01_c3
    s_lshl_b32 s52, s61, 6
    buffer_load_dwordx2 v[16:17], v7, s[48:51], s52 offen
    s_mul_i32 s52, s61, 196608
    s_lshl_b32 s55, s54, 7
    s_add_u32 s52, s52, s55
    buffer_load_dwordx4 v[48:51], v6, s[44:47], s52 offen
    s_add_u32 s52, s52, 6144
    buffer_load_dwordx4 v[52:55], v6, s[44:47], s52 offen
    s_add_u32 s52, s52, 6144
    buffer_load_dwordx4 v[56:59], v6, s[44:47], s52 offen
    s_add_u32 s52, s52, 6144
    buffer_load_dwordx4 v[60:63], v6, s[44:47], s52 offen
    s_barrier
    s_branch k01_dot
k01_c3:
    s_barrier
    s_branch k01_setup
k01_mod:
    s_lshl_b32 s52, s61, 6
    buffer_load_dwordx2 v[16:17], v7, s[48:51], s52 offen
    s_mul_i32 s52, s61, 196608
    s_lshl_b32 s55, s54, 7
    s_add_u32 s52, s52, s55
    buffer_load_dwordx4 v[48:51], v6, s[44:47], s52 offen
    s_add_u32 s52, s52, 6144
    buffer_load_dwordx4 v[52:55], v6, s[44:47], s52 offen
    s_add_u32 s52, s52, 6144
    buffer_load_dwordx4 v[56:59], v6, s[44:47], s52 offen
    s_add_u32 s52, s52, 6144
    buffer_load_dwordx4 v[60:63], v6, s[44:47], s52 offen
k01_dot:
    s_waitcnt vmcnt(4)
    v_lshlrev_b32 v20, 16, v16
    v_and_b32 v21, 0xffff0000, v16
    v_lshlrev_b32 v22, 16, v17
    v_and_b32 v23, 0xffff0000, v17
    v_mul_f32 v28, 0xbfb8aa3b, v20
    v_mul_f32 v29, 0xbfb8aa3b, v21
    v_mul_f32 v30, 0xbfb8aa3b, v22
    v_mul_f32 v31, 0xbfb8aa3b, v23
    v_exp_f32 v28, v28
    v_exp_f32 v29, v29
    v_exp_f32 v30, v30
    v_exp_f32 v31, v31
    v_add_f32 v28, 1.0, v28
    v_add_f32 v29, 1.0, v29
    v_add_f32 v30, 1.0, v30
    v_add_f32 v31, 1.0, v31
    v_rcp_f32 v28, v28
    v_rcp_f32 v29, v29
    v_rcp_f32 v30, v30
    v_rcp_f32 v31, v31
    v_mul_f32 v20, v20, v28
    v_mul_f32 v21, v21, v29
    v_mul_f32 v22, v22, v30
    v_mul_f32 v23, v23, v31
    v_cvt_pk_bf16_f32 v20, v20, v20
    v_cvt_pk_bf16_f32 v21, v21, v21
    v_cvt_pk_bf16_f32 v22, v22, v22
    v_cvt_pk_bf16_f32 v23, v23, v23
    v_and_b32 v28, 0xffff, v20
    v_and_b32 v20, 0xffff0000, v20
    v_and_b32 v29, 0xffff, v21
    v_and_b32 v21, 0xffff0000, v21
    v_and_b32 v30, 0xffff, v22
    v_and_b32 v22, 0xffff0000, v22
    v_and_b32 v31, 0xffff, v23
    v_and_b32 v23, 0xffff0000, v23
    s_waitcnt vmcnt(3)
    v_dot2_f32_bf16 v36, v48, v28, v36
    v_dot2_f32_bf16 v37, v48, v20, v37
    v_dot2_f32_bf16 v38, v49, v28, v38
    v_dot2_f32_bf16 v39, v49, v20, v39
    v_dot2_f32_bf16 v40, v50, v28, v40
    v_dot2_f32_bf16 v41, v50, v20, v41
    v_dot2_f32_bf16 v42, v51, v28, v42
    v_dot2_f32_bf16 v43, v51, v20, v43
    s_waitcnt vmcnt(2)
    v_dot2_f32_bf16 v36, v52, v29, v36
    v_dot2_f32_bf16 v37, v52, v21, v37
    v_dot2_f32_bf16 v38, v53, v29, v38
    v_dot2_f32_bf16 v39, v53, v21, v39
    v_dot2_f32_bf16 v40, v54, v29, v40
    v_dot2_f32_bf16 v41, v54, v21, v41
    v_dot2_f32_bf16 v42, v55, v29, v42
    v_dot2_f32_bf16 v43, v55, v21, v43
    s_waitcnt vmcnt(1)
    v_dot2_f32_bf16 v36, v56, v30, v36
    v_dot2_f32_bf16 v37, v56, v22, v37
    v_dot2_f32_bf16 v38, v57, v30, v38
    v_dot2_f32_bf16 v39, v57, v22, v39
    v_dot2_f32_bf16 v40, v58, v30, v40
    v_dot2_f32_bf16 v41, v58, v22, v41
    v_dot2_f32_bf16 v42, v59, v30, v42
    v_dot2_f32_bf16 v43, v59, v22, v43
    s_waitcnt vmcnt(0)
    v_dot2_f32_bf16 v36, v60, v31, v36
    v_dot2_f32_bf16 v37, v60, v23, v37
    v_dot2_f32_bf16 v38, v61, v31, v38
    v_dot2_f32_bf16 v39, v61, v23, v39
    v_dot2_f32_bf16 v40, v62, v31, v40
    v_dot2_f32_bf16 v41, v62, v23, v41
    v_dot2_f32_bf16 v42, v63, v31, v42
    v_dot2_f32_bf16 v43, v63, v23, v43
    s_cmp_lg_u32 s53, 2
    s_cbranch_scc1 k01_red
    s_add_u32 s61, s61, 1
    s_cmp_lt_u32 s61, 16
    s_cbranch_scc1 k01_mod
k01_red:
    v_permlane32_swap_b32 v36, v40
    v_permlane32_swap_b32 v37, v41
    v_permlane32_swap_b32 v38, v42
    v_permlane32_swap_b32 v39, v43
    v_add_f32 v36, v36, v40
    v_add_f32 v37, v37, v41
    v_add_f32 v38, v38, v42
    v_add_f32 v39, v39, v43
    s_nop 0
    v_permlane16_swap_b32 v36, v38
    v_permlane16_swap_b32 v37, v39
    v_add_f32 v36, v36, v38
    v_add_f32 v37, v37, v39
    s_nop 0
    v_add_f32_dpp v36, v36, v36 row_ror:8 row_mask:0xf bank_mask:0xf
    v_add_f32_dpp v37, v37, v37 row_ror:8 row_mask:0xf bank_mask:0xf
    s_mov_b32 exec_lo, 0x00ff00ff
    s_mov_b32 exec_hi, 0x00ff00ff
    s_cmp_eq_u32 s53, 2
    s_cbranch_scc1 k01_fb
    s_lshl_b32 s52, s3, 8
    s_add_u32 s52, s52, 0
    v_add_u32 v45, s52, v44
    ds_write_b64 v45, v[36:37]
    v_mov_b32 v42, 1
    s_mov_b32 exec_lo, 1
    s_mov_b32 exec_hi, 0
    s_waitcnt lgkmcnt(0)
    ds_add_rtn_u32 v43, v10, v42 offset:1024
    s_waitcnt lgkmcnt(0)
    v_readfirstlane_b32 s52, v43
    s_mov_b64 exec, -1
    s_cmp_lg_u32 s52, 3
    s_cbranch_scc1 k01_setup
    s_mov_b32 exec_lo, 0x00ff00ff
    s_mov_b32 exec_hi, 0x00ff00ff
    ds_read_b64 v[36:37], v44 offset:0
    ds_read_b64 v[38:39], v44 offset:256
    ds_read_b64 v[40:41], v44 offset:512
    ds_read_b64 v[42:43], v44 offset:768
    s_waitcnt lgkmcnt(0)
    v_add_f32 v36, v36, v38
    v_add_f32 v37, v37, v39
    v_add_f32 v40, v40, v42
    v_add_f32 v41, v41, v43
    v_add_f32 v36, v36, v40
    v_add_f32 v37, v37, v41
    s_cmp_eq_u32 s9, 0
    s_cbranch_scc1 k01_urg
    buffer_store_dwordx2 v[36:37], v44, s[40:43], s63 offen
    s_mov_b64 exec, -1
    s_branch k01_setup
k01_urg:
    v_mov_b32 v38, 1
    v_mov_b32 v39, 0
    v_mov_b32 v40, 1
    buffer_store_dwordx2 v[36:37], v44, s[40:43], s62 offen sc1
    s_mov_b32 exec_lo, 1
    s_mov_b32 exec_hi, 0
    ds_write_b32 v10, v40 offset:1028
    s_mov_b64 exec, -1
    s_cmp_eq_u32 s8, 0
    s_cbranch_scc1 k01_nl
    s_waitcnt vmcnt(1)
    s_mov_b32 s8, 0
    v_readfirstlane_b32 s52, v47
    s_nop 0
    s_cmp_lg_u32 s52, 63
    s_cbranch_scc1 k01_nl
    v_mov_b32 v47, 1
    s_mov_b64 exec, 1
    buffer_store_dword v47, v46, s[56:59], 0 offen sc1
    s_mov_b64 exec, -1
k01_nl:
    s_mov_b64 exec, -1
    s_branch k01_setup
k01_fb:
    v_cvt_pk_bf16_f32 v40, v36, v37
    v_lshlrev_b32 v36, 16, v40
    v_and_b32 v37, 0xffff0000, v40
    v_add_f32 v38, 1.0, v36
    v_add_f32 v39, 1.0, v37
    v_cvt_pk_bf16_f32 v41, v38, v39
    v_lshlrev_b32 v38, 16, v41
    v_and_b32 v39, 0xffff0000, v41
    s_cmp_lt_u32 s54, 8
    s_cbranch_scc1 k01_sa
    v_mov_b32 v36, v38
    v_mov_b32 v37, v39
k01_sa:
    s_lshr_b32 s52, s54, 2
    s_lshl_b32 s52, s52, 10
    s_and_b32 s55, s54, 3
    s_lshl_b32 s55, s55, 7
    s_add_u32 s52, s52, s55
    s_add_u32 s52, s52, 16384
    v_and_b32 v38, 7, v2
    v_lshl_add_u32 v38, v38, 4, s52
    v_lshl_add_u32 v38, v4, 9, v38
    v_bfe_u32 v39, v2, 4, 1
    v_lshl_add_u32 v38, v39, 3, v38
    ds_write_b64 v38, v[36:37]
    s_mov_b64 exec, -1
k01_fb0:
    v_mov_b32 v36, 0
    v_mov_b32 v37, 0
    v_mov_b32 v38, 0
    v_mov_b32 v39, 0
    v_mov_b32 v40, 0
    v_mov_b32 v41, 0
    v_mov_b32 v42, 0
    v_mov_b32 v43, 0
    s_mov_b32 s61, 0
    s_add_u32 s54, s54, 1
    s_cmp_lt_u32 s54, 16
    s_cbranch_scc1 k01_mod
    s_branch k01_b1
k01_setup:
    s_lshr_b32 s11, s3, 1
    s_and_b32 s12, s3, 1
    s_lshl_b32 s13, s11, 15
    v_lshl_add_u32 v11, v4, 9, s13
    v_or_b32 v12, 0, v4
    v_xor_b32 v12, v12, v5
    v_lshl_add_u32 v12, v12, 4, v11
    v_or_b32 v13, 2, v4
    v_xor_b32 v13, v13, v5
    v_lshl_add_u32 v13, v13, 4, v11
    v_or_b32 v14, 4, v4
    v_xor_b32 v14, v14, v5
    v_lshl_add_u32 v14, v14, 4, v11
    v_or_b32 v15, 6, v4
    v_xor_b32 v15, v15, v5
    v_lshl_add_u32 v15, v15, 4, v11
    v_bfe_u32 v8, v2, 2, 2
    v_lshl_add_u32 v9, v4, 3, v8
    v_lshlrev_b32 v9, 7, v9
    v_lshrrev_b32 v8, 1, v8
    v_lshlrev_b32 v8, 2, v8
    s_lshl_b32 s13, s12, 2
    v_xor_b32 v8, s13, v8
    v_bfe_u32 v10, v2, 4, 1
    v_lshl_add_u32 v8, v10, 1, v8
    v_and_b32 v10, 1, v2
    v_add_u32 v8, v8, v10
    v_lshl_add_u32 v9, v8, 4, v9
    v_bfe_u32 v10, v2, 1, 1
    v_lshl_add_u32 v9, v10, 3, v9
    v_add_u32 v8, 65536, v9
    v_add_u32 v9, 114688, v9
    s_cmp_lg_u32 s3, 0
    s_cbranch_scc1 k01_b1
    s_cmp_eq_u32 s8, 0
    s_cbranch_scc1 k01_nl2
    s_waitcnt vmcnt(0)
    s_mov_b32 s8, 0
    v_readfirstlane_b32 s52, v47
    s_nop 0
    s_cmp_lg_u32 s52, 63
    s_cbranch_scc1 k01_nl2
    v_mov_b32 v47, 1
    s_mov_b64 exec, 1
    buffer_store_dword v47, v46, s[56:59], 0 offen sc1
    s_mov_b64 exec, -1
k01_nl2:
    v_mov_b32 v10, 0
    s_mov_b32 s52, 0x1
    v_mov_b32 v17, 1
    v_and_b32 v19, 1, v2
    v_lshlrev_b32 v19, 9, v19
    v_lshrrev_b32 v20, 1, v2
    v_lshl_add_u32 v19, v20, 4, v19
    s_cmp_lg_u32 s9, 3
    s_cbranch_scc1 k01_p0
    s_sleep 40
k01_p0:
    s_mov_b32 s55, 0
    s_mov_b32 s60, 0x8000
    s_mov_b32 s61, 0x9000
    s_mov_b32 s62, 0xa000
    s_mov_b32 s63, 0xb000
k01_poll:
    buffer_load_dword v16, v10, s[56:59], 0 offen sc1
    s_add_u32 s55, s55, 1
    s_waitcnt vmcnt(0)
    v_cmp_ne_u32 vcc, s52, v16
    s_nop 4
    s_cbranch_vccz k01_got
k01_again:
    s_sleep 2
    s_cmp_lt_u32 s55, 2000
    s_nop 4
    s_cbranch_scc1 k01_poll
    ds_write_b32 v10, v17 offset:1032
    s_mov_b32 s53, 2
    s_mov_b32 s54, -1
    s_branch k01_fb0
k01_got:
    buffer_load_dwordx4 v[48:51], v3, s[40:43], s60 offen offset:0 sc1
    buffer_load_dwordx4 v[52:55], v3, s[40:43], s61 offen offset:0 sc1
    buffer_load_dwordx4 v[56:59], v3, s[40:43], s62 offen offset:0 sc1
    buffer_load_dwordx4 v[60:63], v3, s[40:43], s63 offen offset:0 sc1
    buffer_load_dwordx4 v[64:67], v3, s[40:43], s60 offen offset:1024 sc1
    buffer_load_dwordx4 v[68:71], v3, s[40:43], s61 offen offset:1024 sc1
    buffer_load_dwordx4 v[72:75], v3, s[40:43], s62 offen offset:1024 sc1
    buffer_load_dwordx4 v[76:79], v3, s[40:43], s63 offen offset:1024 sc1
    buffer_load_dwordx4 v[80:83], v3, s[40:43], s60 offen offset:2048 sc1
    buffer_load_dwordx4 v[84:87], v3, s[40:43], s61 offen offset:2048 sc1
    buffer_load_dwordx4 v[88:91], v3, s[40:43], s62 offen offset:2048 sc1
    buffer_load_dwordx4 v[92:95], v3, s[40:43], s63 offen offset:2048 sc1
    buffer_load_dwordx4 v[96:99], v3, s[40:43], s60 offen offset:3072 sc1
    buffer_load_dwordx4 v[100:103], v3, s[40:43], s61 offen offset:3072 sc1
    buffer_load_dwordx4 v[104:107], v3, s[40:43], s62 offen offset:3072 sc1
    buffer_load_dwordx4 v[108:111], v3, s[40:43], s63 offen offset:3072 sc1
    ds_write_b32 v10, v17 offset:1032
    s_waitcnt vmcnt(12)
    v_add_f32 v48, v48, v52
    v_add_f32 v56, v56, v60
    v_add_f32 v49, v49, v53
    v_add_f32 v57, v57, v61
    v_add_f32 v50, v50, v54
    v_add_f32 v58, v58, v62
    v_add_f32 v51, v51, v55
    v_add_f32 v59, v59, v63
    v_add_f32 v48, v48, v56
    v_add_f32 v49, v49, v57
    v_add_f32 v50, v50, v58
    v_add_f32 v51, v51, v59
    v_cvt_pk_bf16_f32 v52, v48, v49
    v_cvt_pk_bf16_f32 v53, v50, v51
    v_lshlrev_b32 v56, 16, v52
    v_and_b32 v57, 0xffff0000, v52
    v_lshlrev_b32 v58, 16, v53
    v_and_b32 v59, 0xffff0000, v53
    ds_write_b128 v19, v[56:59] offset:16384
    v_add_f32 v48, v48, v49
    v_add_f32 v50, v50, v51
    v_add_f32 v48, v48, v50
    s_waitcnt vmcnt(8)
    v_add_f32 v64, v64, v68
    v_add_f32 v72, v72, v76
    v_add_f32 v65, v65, v69
    v_add_f32 v73, v73, v77
    v_add_f32 v66, v66, v70
    v_add_f32 v74, v74, v78
    v_add_f32 v67, v67, v71
    v_add_f32 v75, v75, v79
    v_add_f32 v64, v64, v72
    v_add_f32 v65, v65, v73
    v_add_f32 v66, v66, v74
    v_add_f32 v67, v67, v75
    v_cvt_pk_bf16_f32 v68, v64, v65
    v_cvt_pk_bf16_f32 v69, v66, v67
    v_lshlrev_b32 v72, 16, v68
    v_and_b32 v73, 0xffff0000, v68
    v_lshlrev_b32 v74, 16, v69
    v_and_b32 v75, 0xffff0000, v69
    ds_write_b128 v19, v[72:75] offset:17408
    v_add_f32 v64, v64, v65
    v_add_f32 v66, v66, v67
    v_add_f32 v64, v64, v66
    v_add_f32 v48, v48, v64
    s_waitcnt vmcnt(4)
    v_add_f32 v80, v80, v84
    v_add_f32 v88, v88, v92
    v_add_f32 v81, v81, v85
    v_add_f32 v89, v89, v93
    v_add_f32 v82, v82, v86
    v_add_f32 v90, v90, v94
    v_add_f32 v83, v83, v87
    v_add_f32 v91, v91, v95
    v_add_f32 v80, v80, v88
    v_add_f32 v81, v81, v89
    v_add_f32 v82, v82, v90
    v_add_f32 v83, v83, v91
    v_cvt_pk_bf16_f32 v84, v80, v81
    v_cvt_pk_bf16_f32 v85, v82, v83
    v_lshlrev_b32 v88, 16, v84
    v_and_b32 v89, 0xffff0000, v84
    v_lshlrev_b32 v90, 16, v85
    v_and_b32 v91, 0xffff0000, v85
    v_add_f32 v88, 1.0, v88
    v_add_f32 v89, 1.0, v89
    v_add_f32 v90, 1.0, v90
    v_add_f32 v91, 1.0, v91
    v_cvt_pk_bf16_f32 v84, v88, v89
    v_cvt_pk_bf16_f32 v85, v90, v91
    v_lshlrev_b32 v88, 16, v84
    v_and_b32 v89, 0xffff0000, v84
    v_lshlrev_b32 v90, 16, v85
    v_and_b32 v91, 0xffff0000, v85
    ds_write_b128 v19, v[88:91] offset:18432
    v_add_f32 v80, v80, v81
    v_add_f32 v82, v82, v83
    v_add_f32 v80, v80, v82
    v_add_f32 v48, v48, v80
    s_waitcnt vmcnt(0)
    v_add_f32 v96, v96, v100
    v_add_f32 v104, v104, v108
    v_add_f32 v97, v97, v101
    v_add_f32 v105, v105, v109
    v_add_f32 v98, v98, v102
    v_add_f32 v106, v106, v110
    v_add_f32 v99, v99, v103
    v_add_f32 v107, v107, v111
    v_add_f32 v96, v96, v104
    v_add_f32 v97, v97, v105
    v_add_f32 v98, v98, v106
    v_add_f32 v99, v99, v107
    v_cvt_pk_bf16_f32 v100, v96, v97
    v_cvt_pk_bf16_f32 v101, v98, v99
    v_lshlrev_b32 v104, 16, v100
    v_and_b32 v105, 0xffff0000, v100
    v_lshlrev_b32 v106, 16, v101
    v_and_b32 v107, 0xffff0000, v101
    v_add_f32 v104, 1.0, v104
    v_add_f32 v105, 1.0, v105
    v_add_f32 v106, 1.0, v106
    v_add_f32 v107, 1.0, v107
    v_cvt_pk_bf16_f32 v100, v104, v105
    v_cvt_pk_bf16_f32 v101, v106, v107
    v_lshlrev_b32 v104, 16, v100
    v_and_b32 v105, 0xffff0000, v100
    v_lshlrev_b32 v106, 16, v101
    v_and_b32 v107, 0xffff0000, v101
    ds_write_b128 v19, v[104:107] offset:19456
    v_add_f32 v96, v96, v97
    v_add_f32 v98, v98, v99
    v_add_f32 v96, v96, v98
    v_add_f32 v48, v48, v96
    v_cmp_u_f32 vcc, v48, v48
    s_nop 4
    s_cbranch_vccz k01_b1
    s_add_u32 s55, s55, 1
    s_cmp_lt_u32 s55, 2000
    s_cbranch_scc1 k01_got
    s_branch k01_again
k01_b1:
    s_waitcnt lgkmcnt(0)
    s_barrier
    s_barrier
    ds_read_b128 v[16:19], v12 offset:0
    ds_read_b64_tr_b16 v[24:25], v8 offset:0
    ds_read_b64_tr_b16 v[26:27], v8 offset:512
    ds_read_b64_tr_b16 v[28:29], v8 offset:8192
    ds_read_b64_tr_b16 v[30:31], v8 offset:8704
    ds_read_b64_tr_b16 v[32:33], v8 offset:16384
    ds_read_b64_tr_b16 v[34:35], v8 offset:16896
    s_waitcnt lgkmcnt(4)
    v_mfma_f32_32x32x16_bf16 v[48:63], v[24:27], v[16:19], 0
    ds_read_b128 v[20:23], v13 offset:1024
    ds_read_b64_tr_b16 v[36:37], v8 offset:2048
    ds_read_b64_tr_b16 v[38:39], v8 offset:2560
    s_waitcnt lgkmcnt(5)
    v_mfma_f32_32x32x16_bf16 v[64:79], v[28:31], v[16:19], 0
    ds_read_b64_tr_b16 v[40:41], v8 offset:10240
    ds_read_b64_tr_b16 v[42:43], v8 offset:10752
    s_waitcnt lgkmcnt(5)
    v_mfma_f32_32x32x16_bf16 v[80:95], v[16:19], v[32:35], 0
    ds_read_b64_tr_b16 v[44:45], v8 offset:18432
    ds_read_b64_tr_b16 v[46:47], v8 offset:18944
    s_waitcnt lgkmcnt(4)
    v_mfma_f32_32x32x16_bf16 v[48:63], v[36:39], v[20:23], v[48:63]
    ds_read_b128 v[16:19], v14 offset:2048
    ds_read_b64_tr_b16 v[24:25], v8 offset:4096
    ds_read_b64_tr_b16 v[26:27], v8 offset:4608
    s_waitcnt lgkmcnt(5)
    v_mfma_f32_32x32x16_bf16 v[64:79], v[40:43], v[20:23], v[64:79]
    ds_read_b64_tr_b16 v[28:29], v8 offset:12288
    ds_read_b64_tr_b16 v[30:31], v8 offset:12800
    s_waitcnt lgkmcnt(5)
    v_mfma_f32_32x32x16_bf16 v[80:95], v[20:23], v[44:47], v[80:95]
    ds_read_b64_tr_b16 v[32:33], v8 offset:20480
    ds_read_b64_tr_b16 v[34:35], v8 offset:20992
    s_waitcnt lgkmcnt(4)
    v_mfma_f32_32x32x16_bf16 v[48:63], v[24:27], v[16:19], v[48:63]
    ds_read_b128 v[20:23], v15 offset:3072
    ds_read_b64_tr_b16 v[36:37], v8 offset:6144
    ds_read_b64_tr_b16 v[38:39], v8 offset:6656
    s_waitcnt lgkmcnt(5)
    v_mfma_f32_32x32x16_bf16 v[64:79], v[28:31], v[16:19], v[64:79]
    ds_read_b64_tr_b16 v[40:41], v8 offset:14336
    ds_read_b64_tr_b16 v[42:43], v8 offset:14848
    s_waitcnt lgkmcnt(5)
    v_mfma_f32_32x32x16_bf16 v[80:95], v[16:19], v[32:35], v[80:95]
    ds_read_b64_tr_b16 v[44:45], v8 offset:22528
    ds_read_b64_tr_b16 v[46:47], v8 offset:23040
    s_waitcnt lgkmcnt(4)
    v_mfma_f32_32x32x16_bf16 v[48:63], v[36:39], v[20:23], v[48:63]
    s_barrier
    ds_read_b128 v[16:19], v12 offset:4096
    ds_read_b64_tr_b16 v[24:25], v8 offset:24576
    ds_read_b64_tr_b16 v[26:27], v8 offset:25088
    s_waitcnt lgkmcnt(5)
    v_mfma_f32_32x32x16_bf16 v[64:79], v[40:43], v[20:23], v[64:79]
    ds_read_b64_tr_b16 v[28:29], v8 offset:32768
    ds_read_b64_tr_b16 v[30:31], v8 offset:33280
    s_waitcnt lgkmcnt(5)
    v_mfma_f32_32x32x16_bf16 v[80:95], v[20:23], v[44:47], v[80:95]
    ds_read_b64_tr_b16 v[32:33], v8 offset:40960
    ds_read_b64_tr_b16 v[34:35], v8 offset:41472
    s_waitcnt lgkmcnt(4)
    v_mfma_f32_32x32x16_bf16 v[48:63], v[24:27], v[16:19], v[48:63]
    ds_read_b128 v[20:23], v13 offset:5120
    ds_read_b64_tr_b16 v[36:37], v8 offset:26624
    ds_read_b64_tr_b16 v[38:39], v8 offset:27136
    s_waitcnt lgkmcnt(5)
    v_mfma_f32_32x32x16_bf16 v[64:79], v[28:31], v[16:19], v[64:79]
    ds_read_b64_tr_b16 v[40:41], v8 offset:34816
    ds_read_b64_tr_b16 v[42:43], v8 offset:35328
    s_waitcnt lgkmcnt(5)
    v_mfma_f32_32x32x16_bf16 v[80:95], v[16:19], v[32:35], v[80:95]
    ds_read_b64_tr_b16 v[44:45], v8 offset:43008
    ds_read_b64_tr_b16 v[46:47], v8 offset:43520
    s_waitcnt lgkmcnt(4)
    v_mfma_f32_32x32x16_bf16 v[48:63], v[36:39], v[20:23], v[48:63]
    ds_read_b128 v[16:19], v14 offset:6144
    ds_read_b64_tr_b16 v[24:25], v8 offset:28672
    ds_read_b64_tr_b16 v[26:27], v8 offset:29184
    s_waitcnt lgkmcnt(5)
    v_mfma_f32_32x32x16_bf16 v[64:79], v[40:43], v[20:23], v[64:79]
    ds_read_b64_tr_b16 v[28:29], v8 offset:36864
    ds_read_b64_tr_b16 v[30:31], v8 offset:37376
    s_waitcnt lgkmcnt(5)
    v_mfma_f32_32x32x16_bf16 v[80:95], v[20:23], v[44:47], v[80:95]
    ds_read_b64_tr_b16 v[32:33], v8 offset:45056
    ds_read_b64_tr_b16 v[34:35], v8 offset:45568
    s_waitcnt lgkmcnt(4)
    v_mfma_f32_32x32x16_bf16 v[48:63], v[24:27], v[16:19], v[48:63]
    ds_read_b128 v[20:23], v15 offset:7168
    ds_read_b64_tr_b16 v[36:37], v8 offset:30720
    ds_read_b64_tr_b16 v[38:39], v8 offset:31232
    s_waitcnt lgkmcnt(5)
    v_mfma_f32_32x32x16_bf16 v[64:79], v[28:31], v[16:19], v[64:79]
    ds_read_b64_tr_b16 v[40:41], v8 offset:38912
    ds_read_b64_tr_b16 v[42:43], v8 offset:39424
    s_waitcnt lgkmcnt(5)
    v_mfma_f32_32x32x16_bf16 v[80:95], v[16:19], v[32:35], v[80:95]
    ds_read_b64_tr_b16 v[44:45], v8 offset:47104
    ds_read_b64_tr_b16 v[46:47], v8 offset:47616
    s_waitcnt lgkmcnt(4)
    v_mfma_f32_32x32x16_bf16 v[48:63], v[36:39], v[20:23], v[48:63]
    s_barrier
    ds_read_b128 v[16:19], v12 offset:8192
    ds_read_b64_tr_b16 v[24:25], v9 offset:0
    ds_read_b64_tr_b16 v[26:27], v9 offset:512
    s_waitcnt lgkmcnt(5)
    v_mfma_f32_32x32x16_bf16 v[64:79], v[40:43], v[20:23], v[64:79]
    ds_read_b64_tr_b16 v[28:29], v9 offset:8192
    ds_read_b64_tr_b16 v[30:31], v9 offset:8704
    s_waitcnt lgkmcnt(5)
    v_mfma_f32_32x32x16_bf16 v[80:95], v[20:23], v[44:47], v[80:95]
    ds_read_b64_tr_b16 v[32:33], v9 offset:16384
    ds_read_b64_tr_b16 v[34:35], v9 offset:16896
    s_waitcnt lgkmcnt(4)
    v_mfma_f32_32x32x16_bf16 v[48:63], v[24:27], v[16:19], v[48:63]
    ds_read_b128 v[20:23], v13 offset:9216
    ds_read_b64_tr_b16 v[36:37], v9 offset:2048
    ds_read_b64_tr_b16 v[38:39], v9 offset:2560
    s_waitcnt lgkmcnt(5)
    v_mfma_f32_32x32x16_bf16 v[64:79], v[28:31], v[16:19], v[64:79]
    ds_read_b64_tr_b16 v[40:41], v9 offset:10240
    ds_read_b64_tr_b16 v[42:43], v9 offset:10752
    s_waitcnt lgkmcnt(5)
    v_mfma_f32_32x32x16_bf16 v[80:95], v[16:19], v[32:35], v[80:95]
    ds_read_b64_tr_b16 v[44:45], v9 offset:18432
    ds_read_b64_tr_b16 v[46:47], v9 offset:18944
    s_waitcnt lgkmcnt(4)
    v_mfma_f32_32x32x16_bf16 v[48:63], v[36:39], v[20:23], v[48:63]
    ds_read_b128 v[16:19], v14 offset:10240
    ds_read_b64_tr_b16 v[24:25], v9 offset:4096
    ds_read_b64_tr_b16 v[26:27], v9 offset:4608
    s_waitcnt lgkmcnt(5)
    v_mfma_f32_32x32x16_bf16 v[64:79], v[40:43], v[20:23], v[64:79]
    ds_read_b64_tr_b16 v[28:29], v9 offset:12288
    ds_read_b64_tr_b16 v[30:31], v9 offset:12800
    s_waitcnt lgkmcnt(5)
    v_mfma_f32_32x32x16_bf16 v[80:95], v[20:23], v[44:47], v[80:95]
    ds_read_b64_tr_b16 v[32:33], v9 offset:20480
    ds_read_b64_tr_b16 v[34:35], v9 offset:20992
    s_waitcnt lgkmcnt(4)
    v_mfma_f32_32x32x16_bf16 v[48:63], v[24:27], v[16:19], v[48:63]
    ds_read_b128 v[20:23], v15 offset:11264
    ds_read_b64_tr_b16 v[36:37], v9 offset:6144
    ds_read_b64_tr_b16 v[38:39], v9 offset:6656
    s_waitcnt lgkmcnt(5)
    v_mfma_f32_32x32x16_bf16 v[64:79], v[28:31], v[16:19], v[64:79]
    ds_read_b64_tr_b16 v[40:41], v9 offset:14336
    ds_read_b64_tr_b16 v[42:43], v9 offset:14848
    s_waitcnt lgkmcnt(5)
    v_mfma_f32_32x32x16_bf16 v[80:95], v[16:19], v[32:35], v[80:95]
    ds_read_b64_tr_b16 v[44:45], v9 offset:22528
    ds_read_b64_tr_b16 v[46:47], v9 offset:23040
    s_waitcnt lgkmcnt(4)
    v_mfma_f32_32x32x16_bf16 v[48:63], v[36:39], v[20:23], v[48:63]
    s_barrier
    ds_read_b128 v[16:19], v12 offset:12288
    ds_read_b64_tr_b16 v[24:25], v9 offset:24576
    ds_read_b64_tr_b16 v[26:27], v9 offset:25088
    s_waitcnt lgkmcnt(5)
    v_mfma_f32_32x32x16_bf16 v[64:79], v[40:43], v[20:23], v[64:79]
    ds_read_b64_tr_b16 v[28:29], v9 offset:32768
    ds_read_b64_tr_b16 v[30:31], v9 offset:33280
    s_waitcnt lgkmcnt(5)
    v_mfma_f32_32x32x16_bf16 v[80:95], v[20:23], v[44:47], v[80:95]
    ds_read_b64_tr_b16 v[32:33], v9 offset:40960
    ds_read_b64_tr_b16 v[34:35], v9 offset:41472
    s_waitcnt lgkmcnt(4)
    v_mfma_f32_32x32x16_bf16 v[48:63], v[24:27], v[16:19], v[48:63]
    ds_read_b128 v[20:23], v13 offset:13312
    ds_read_b64_tr_b16 v[36:37], v9 offset:26624
    ds_read_b64_tr_b16 v[38:39], v9 offset:27136
    s_waitcnt lgkmcnt(5)
    v_mfma_f32_32x32x16_bf16 v[64:79], v[28:31], v[16:19], v[64:79]
    ds_read_b64_tr_b16 v[40:41], v9 offset:34816
    ds_read_b64_tr_b16 v[42:43], v9 offset:35328
    s_waitcnt lgkmcnt(5)
    v_mfma_f32_32x32x16_bf16 v[80:95], v[16:19], v[32:35], v[80:95]
    ds_read_b64_tr_b16 v[44:45], v9 offset:43008
    ds_read_b64_tr_b16 v[46:47], v9 offset:43520
    s_waitcnt lgkmcnt(4)
    v_mfma_f32_32x32x16_bf16 v[48:63], v[36:39], v[20:23], v[48:63]
    ds_read_b128 v[16:19], v14 offset:14336
    ds_read_b64_tr_b16 v[24:25], v9 offset:28672
    ds_read_b64_tr_b16 v[26:27], v9 offset:29184
    s_waitcnt lgkmcnt(5)
    v_mfma_f32_32x32x16_bf16 v[64:79], v[40:43], v[20:23], v[64:79]
    ds_read_b64_tr_b16 v[28:29], v9 offset:36864
    ds_read_b64_tr_b16 v[30:31], v9 offset:37376
    s_waitcnt lgkmcnt(5)
    v_mfma_f32_32x32x16_bf16 v[80:95], v[20:23], v[44:47], v[80:95]
    ds_read_b64_tr_b16 v[32:33], v9 offset:45056
    ds_read_b64_tr_b16 v[34:35], v9 offset:45568
    s_waitcnt lgkmcnt(4)
    v_mfma_f32_32x32x16_bf16 v[48:63], v[24:27], v[16:19], v[48:63]
    ds_read_b128 v[20:23], v15 offset:15360
    ds_read_b64_tr_b16 v[36:37], v9 offset:30720
    ds_read_b64_tr_b16 v[38:39], v9 offset:31232
    s_waitcnt lgkmcnt(5)
    v_mfma_f32_32x32x16_bf16 v[64:79], v[28:31], v[16:19], v[64:79]
    ds_read_b64_tr_b16 v[40:41], v9 offset:38912
    ds_read_b64_tr_b16 v[42:43], v9 offset:39424
    s_waitcnt lgkmcnt(5)
    v_mfma_f32_32x32x16_bf16 v[80:95], v[16:19], v[32:35], v[80:95]
    ds_read_b64_tr_b16 v[44:45], v9 offset:47104
    ds_read_b64_tr_b16 v[46:47], v9 offset:47616
    s_waitcnt lgkmcnt(4)
    v_mfma_f32_32x32x16_bf16 v[48:63], v[36:39], v[20:23], v[48:63]
    s_barrier
    ds_read_b128 v[16:19], v12 offset:16384
    ds_read_b64_tr_b16 v[24:25], v8 offset:0
    ds_read_b64_tr_b16 v[26:27], v8 offset:512
    s_waitcnt lgkmcnt(5)
    v_mfma_f32_32x32x16_bf16 v[64:79], v[40:43], v[20:23], v[64:79]
    ds_read_b64_tr_b16 v[28:29], v8 offset:8192
    ds_read_b64_tr_b16 v[30:31], v8 offset:8704
    s_waitcnt lgkmcnt(5)
    v_mfma_f32_32x32x16_bf16 v[80:95], v[20:23], v[44:47], v[80:95]
    ds_read_b64_tr_b16 v[32:33], v8 offset:16384
    ds_read_b64_tr_b16 v[34:35], v8 offset:16896
    s_waitcnt lgkmcnt(4)
    v_mfma_f32_32x32x16_bf16 v[48:63], v[24:27], v[16:19], v[48:63]
    ds_read_b128 v[20:23], v13 offset:17408
    ds_read_b64_tr_b16 v[36:37], v8 offset:2048
    ds_read_b64_tr_b16 v[38:39], v8 offset:2560
    s_waitcnt lgkmcnt(5)
    v_mfma_f32_32x32x16_bf16 v[64:79], v[28:31], v[16:19], v[64:79]
    ds_read_b64_tr_b16 v[40:41], v8 offset:10240
    ds_read_b64_tr_b16 v[42:43], v8 offset:10752
    s_waitcnt lgkmcnt(5)
    v_mfma_f32_32x32x16_bf16 v[80:95], v[16:19], v[32:35], v[80:95]
    ds_read_b64_tr_b16 v[44:45], v8 offset:18432
    ds_read_b64_tr_b16 v[46:47], v8 offset:18944
    s_waitcnt lgkmcnt(4)
    v_mfma_f32_32x32x16_bf16 v[48:63], v[36:39], v[20:23], v[48:63]
    ds_read_b128 v[16:19], v14 offset:18432
    ds_read_b64_tr_b16 v[24:25], v8 offset:4096
    ds_read_b64_tr_b16 v[26:27], v8 offset:4608
    s_waitcnt lgkmcnt(5)
    v_mfma_f32_32x32x16_bf16 v[64:79], v[40:43], v[20:23], v[64:79]
    ds_read_b64_tr_b16 v[28:29], v8 offset:12288
    ds_read_b64_tr_b16 v[30:31], v8 offset:12800
    s_waitcnt lgkmcnt(5)
    v_mfma_f32_32x32x16_bf16 v[80:95], v[20:23], v[44:47], v[80:95]
    ds_read_b64_tr_b16 v[32:33], v8 offset:20480
    ds_read_b64_tr_b16 v[34:35], v8 offset:20992
    s_waitcnt lgkmcnt(4)
    v_mfma_f32_32x32x16_bf16 v[48:63], v[24:27], v[16:19], v[48:63]
    ds_read_b128 v[20:23], v15 offset:19456
    ds_read_b64_tr_b16 v[36:37], v8 offset:6144
    ds_read_b64_tr_b16 v[38:39], v8 offset:6656
    s_waitcnt lgkmcnt(5)
    v_mfma_f32_32x32x16_bf16 v[64:79], v[28:31], v[16:19], v[64:79]
    ds_read_b64_tr_b16 v[40:41], v8 offset:14336
    ds_read_b64_tr_b16 v[42:43], v8 offset:14848
    s_waitcnt lgkmcnt(5)
    v_mfma_f32_32x32x16_bf16 v[80:95], v[16:19], v[32:35], v[80:95]
    ds_read_b64_tr_b16 v[44:45], v8 offset:22528
    ds_read_b64_tr_b16 v[46:47], v8 offset:23040
    s_waitcnt lgkmcnt(4)
    v_mfma_f32_32x32x16_bf16 v[48:63], v[36:39], v[20:23], v[48:63]
    s_barrier
    ds_read_b128 v[16:19], v12 offset:20480
    ds_read_b64_tr_b16 v[24:25], v8 offset:24576
    ds_read_b64_tr_b16 v[26:27], v8 offset:25088
    s_waitcnt lgkmcnt(5)
    v_mfma_f32_32x32x16_bf16 v[64:79], v[40:43], v[20:23], v[64:79]
    ds_read_b64_tr_b16 v[28:29], v8 offset:32768
    ds_read_b64_tr_b16 v[30:31], v8 offset:33280
    s_waitcnt lgkmcnt(5)
    v_mfma_f32_32x32x16_bf16 v[80:95], v[20:23], v[44:47], v[80:95]
    ds_read_b64_tr_b16 v[32:33], v8 offset:40960
    ds_read_b64_tr_b16 v[34:35], v8 offset:41472
    s_waitcnt lgkmcnt(4)
    v_mfma_f32_32x32x16_bf16 v[48:63], v[24:27], v[16:19], v[48:63]
    ds_read_b128 v[20:23], v13 offset:21504
    ds_read_b64_tr_b16 v[36:37], v8 offset:26624
    ds_read_b64_tr_b16 v[38:39], v8 offset:27136
    s_waitcnt lgkmcnt(5)
    v_mfma_f32_32x32x16_bf16 v[64:79], v[28:31], v[16:19], v[64:79]
    ds_read_b64_tr_b16 v[40:41], v8 offset:34816
    ds_read_b64_tr_b16 v[42:43], v8 offset:35328
    s_waitcnt lgkmcnt(5)
    v_mfma_f32_32x32x16_bf16 v[80:95], v[16:19], v[32:35], v[80:95]
    ds_read_b64_tr_b16 v[44:45], v8 offset:43008
    ds_read_b64_tr_b16 v[46:47], v8 offset:43520
    s_waitcnt lgkmcnt(4)
    v_mfma_f32_32x32x16_bf16 v[48:63], v[36:39], v[20:23], v[48:63]
    ds_read_b128 v[16:19], v14 offset:22528
    ds_read_b64_tr_b16 v[24:25], v8 offset:28672
    ds_read_b64_tr_b16 v[26:27], v8 offset:29184
    s_waitcnt lgkmcnt(5)
    v_mfma_f32_32x32x16_bf16 v[64:79], v[40:43], v[20:23], v[64:79]
    ds_read_b64_tr_b16 v[28:29], v8 offset:36864
    ds_read_b64_tr_b16 v[30:31], v8 offset:37376
    s_waitcnt lgkmcnt(5)
    v_mfma_f32_32x32x16_bf16 v[80:95], v[20:23], v[44:47], v[80:95]
    ds_read_b64_tr_b16 v[32:33], v8 offset:45056
    ds_read_b64_tr_b16 v[34:35], v8 offset:45568
    s_waitcnt lgkmcnt(4)
    v_mfma_f32_32x32x16_bf16 v[48:63], v[24:27], v[16:19], v[48:63]
    ds_read_b128 v[20:23], v15 offset:23552
    ds_read_b64_tr_b16 v[36:37], v8 offset:30720
    ds_read_b64_tr_b16 v[38:39], v8 offset:31232
    s_waitcnt lgkmcnt(5)
    v_mfma_f32_32x32x16_bf16 v[64:79], v[28:31], v[16:19], v[64:79]
    ds_read_b64_tr_b16 v[40:41], v8 offset:38912
    ds_read_b64_tr_b16 v[42:43], v8 offset:39424
    s_waitcnt lgkmcnt(5)
    v_mfma_f32_32x32x16_bf16 v[80:95], v[16:19], v[32:35], v[80:95]
    ds_read_b64_tr_b16 v[44:45], v8 offset:47104
    ds_read_b64_tr_b16 v[46:47], v8 offset:47616
    s_waitcnt lgkmcnt(4)
    v_mfma_f32_32x32x16_bf16 v[48:63], v[36:39], v[20:23], v[48:63]
    s_barrier
    ds_read_b128 v[16:19], v12 offset:24576
    ds_read_b64_tr_b16 v[24:25], v9 offset:0
    ds_read_b64_tr_b16 v[26:27], v9 offset:512
    s_waitcnt lgkmcnt(5)
    v_mfma_f32_32x32x16_bf16 v[64:79], v[40:43], v[20:23], v[64:79]
    ds_read_b64_tr_b16 v[28:29], v9 offset:8192
    ds_read_b64_tr_b16 v[30:31], v9 offset:8704
    s_waitcnt lgkmcnt(5)
    v_mfma_f32_32x32x16_bf16 v[80:95], v[20:23], v[44:47], v[80:95]
    ds_read_b64_tr_b16 v[32:33], v9 offset:16384
    ds_read_b64_tr_b16 v[34:35], v9 offset:16896
    s_waitcnt lgkmcnt(4)
    v_mfma_f32_32x32x16_bf16 v[48:63], v[24:27], v[16:19], v[48:63]
    ds_read_b128 v[20:23], v13 offset:25600
    ds_read_b64_tr_b16 v[36:37], v9 offset:2048
    ds_read_b64_tr_b16 v[38:39], v9 offset:2560
    s_waitcnt lgkmcnt(5)
    v_mfma_f32_32x32x16_bf16 v[64:79], v[28:31], v[16:19], v[64:79]
    ds_read_b64_tr_b16 v[40:41], v9 offset:10240
    ds_read_b64_tr_b16 v[42:43], v9 offset:10752
    s_waitcnt lgkmcnt(5)
    v_mfma_f32_32x32x16_bf16 v[80:95], v[16:19], v[32:35], v[80:95]
    ds_read_b64_tr_b16 v[44:45], v9 offset:18432
    ds_read_b64_tr_b16 v[46:47], v9 offset:18944
    s_waitcnt lgkmcnt(4)
    v_mfma_f32_32x32x16_bf16 v[48:63], v[36:39], v[20:23], v[48:63]
    ds_read_b128 v[16:19], v14 offset:26624
    ds_read_b64_tr_b16 v[24:25], v9 offset:4096
    ds_read_b64_tr_b16 v[26:27], v9 offset:4608
    s_waitcnt lgkmcnt(5)
    v_mfma_f32_32x32x16_bf16 v[64:79], v[40:43], v[20:23], v[64:79]
    ds_read_b64_tr_b16 v[28:29], v9 offset:12288
    ds_read_b64_tr_b16 v[30:31], v9 offset:12800
    s_waitcnt lgkmcnt(5)
    v_mfma_f32_32x32x16_bf16 v[80:95], v[20:23], v[44:47], v[80:95]
    ds_read_b64_tr_b16 v[32:33], v9 offset:20480
    ds_read_b64_tr_b16 v[34:35], v9 offset:20992
    s_waitcnt lgkmcnt(4)
    v_mfma_f32_32x32x16_bf16 v[48:63], v[24:27], v[16:19], v[48:63]
    ds_read_b128 v[20:23], v15 offset:27648
    ds_read_b64_tr_b16 v[36:37], v9 offset:6144
    ds_read_b64_tr_b16 v[38:39], v9 offset:6656
    s_waitcnt lgkmcnt(5)
    v_mfma_f32_32x32x16_bf16 v[64:79], v[28:31], v[16:19], v[64:79]
    ds_read_b64_tr_b16 v[40:41], v9 offset:14336
    ds_read_b64_tr_b16 v[42:43], v9 offset:14848
    s_waitcnt lgkmcnt(5)
    v_mfma_f32_32x32x16_bf16 v[80:95], v[16:19], v[32:35], v[80:95]
    ds_read_b64_tr_b16 v[44:45], v9 offset:22528
    ds_read_b64_tr_b16 v[46:47], v9 offset:23040
    s_waitcnt lgkmcnt(4)
    v_mfma_f32_32x32x16_bf16 v[48:63], v[36:39], v[20:23], v[48:63]
    s_barrier
    ds_read_b128 v[16:19], v12 offset:28672
    ds_read_b64_tr_b16 v[24:25], v9 offset:24576
    ds_read_b64_tr_b16 v[26:27], v9 offset:25088
    s_waitcnt lgkmcnt(5)
    v_mfma_f32_32x32x16_bf16 v[64:79], v[40:43], v[20:23], v[64:79]
    ds_read_b64_tr_b16 v[28:29], v9 offset:32768
    ds_read_b64_tr_b16 v[30:31], v9 offset:33280
    s_waitcnt lgkmcnt(5)
    v_mfma_f32_32x32x16_bf16 v[80:95], v[20:23], v[44:47], v[80:95]
    ds_read_b64_tr_b16 v[32:33], v9 offset:40960
    ds_read_b64_tr_b16 v[34:35], v9 offset:41472
    s_waitcnt lgkmcnt(4)
    v_mfma_f32_32x32x16_bf16 v[48:63], v[24:27], v[16:19], v[48:63]
    ds_read_b128 v[20:23], v13 offset:29696
    ds_read_b64_tr_b16 v[36:37], v9 offset:26624
    ds_read_b64_tr_b16 v[38:39], v9 offset:27136
    s_waitcnt lgkmcnt(5)
    v_mfma_f32_32x32x16_bf16 v[64:79], v[28:31], v[16:19], v[64:79]
    ds_read_b64_tr_b16 v[40:41], v9 offset:34816
    ds_read_b64_tr_b16 v[42:43], v9 offset:35328
    s_waitcnt lgkmcnt(5)
    v_mfma_f32_32x32x16_bf16 v[80:95], v[16:19], v[32:35], v[80:95]
    ds_read_b64_tr_b16 v[44:45], v9 offset:43008
    ds_read_b64_tr_b16 v[46:47], v9 offset:43520
    s_waitcnt lgkmcnt(4)
    v_mfma_f32_32x32x16_bf16 v[48:63], v[36:39], v[20:23], v[48:63]
    ds_read_b128 v[16:19], v14 offset:30720
    ds_read_b64_tr_b16 v[24:25], v9 offset:28672
    ds_read_b64_tr_b16 v[26:27], v9 offset:29184
    s_waitcnt lgkmcnt(5)
    v_mfma_f32_32x32x16_bf16 v[64:79], v[40:43], v[20:23], v[64:79]
    ds_read_b64_tr_b16 v[28:29], v9 offset:36864
    ds_read_b64_tr_b16 v[30:31], v9 offset:37376
    s_waitcnt lgkmcnt(5)
    v_mfma_f32_32x32x16_bf16 v[80:95], v[20:23], v[44:47], v[80:95]
    ds_read_b64_tr_b16 v[32:33], v9 offset:45056
    ds_read_b64_tr_b16 v[34:35], v9 offset:45568
    s_waitcnt lgkmcnt(4)
    v_mfma_f32_32x32x16_bf16 v[48:63], v[24:27], v[16:19], v[48:63]
    ds_read_b128 v[20:23], v15 offset:31744
    ds_read_b64_tr_b16 v[36:37], v9 offset:30720
    ds_read_b64_tr_b16 v[38:39], v9 offset:31232
    s_waitcnt lgkmcnt(5)
    v_mfma_f32_32x32x16_bf16 v[64:79], v[28:31], v[16:19], v[64:79]
    ds_read_b64_tr_b16 v[40:41], v9 offset:38912
    ds_read_b64_tr_b16 v[42:43], v9 offset:39424
    s_waitcnt lgkmcnt(5)
    v_mfma_f32_32x32x16_bf16 v[80:95], v[16:19], v[32:35], v[80:95]
    ds_read_b64_tr_b16 v[44:45], v9 offset:47104
    ds_read_b64_tr_b16 v[46:47], v9 offset:47616
    s_waitcnt lgkmcnt(4)
    v_mfma_f32_32x32x16_bf16 v[48:63], v[36:39], v[20:23], v[48:63]
    s_waitcnt lgkmcnt(2)
    v_mfma_f32_32x32x16_bf16 v[64:79], v[40:43], v[20:23], v[64:79]
    s_waitcnt lgkmcnt(0)
    v_mfma_f32_32x32x16_bf16 v[80:95], v[20:23], v[44:47], v[80:95]
    s_lshl_b32 s6, s4, 2
    s_lshl_b32 s7, s12, 1
    s_add_u32 s6, s6, s7
    s_lshl_b32 s7, s5, 1
    s_add_u32 s7, s7, s11
    s_lshl_b32 s8, s7, 10
    s_lshl_b32 s9, s6, 16
    s_add_u32 s9, s9, s8
    s_add_u32 s9, s9, 0xa00000
    s_add_u32 s13, s9, 65536
    s_lshl_b32 s14, s6, 17
    s_add_u32 s15, s14, s8
    s_add_u32 s15, s15, 0xc00000
    s_add_u32 s44, s15, 131072
    s_add_u32 s45, s15, 65536
    v_bfe_u32 v6, v2, 4, 1
    v_lshlrev_b32 v6, 17, v6
    v_lshl_add_u32 v6, v4, 8, v6
    v_and_b32 v7, 15, v2
    v_lshl_add_u32 v6, v7, 4, v6
    v_mov_b32 v10, 0x3eb8aa3b
    v_mul_f32 v48, v10, v48
    v_mul_f32 v49, v10, v49
    v_mul_f32 v50, v10, v50
    v_mul_f32 v51, v10, v51
    v_mul_f32 v52, v10, v52
    v_mul_f32 v53, v10, v53
    v_mul_f32 v54, v10, v54
    v_mul_f32 v55, v10, v55
    v_mul_f32 v56, v10, v56
    v_mul_f32 v57, v10, v57
    v_mul_f32 v58, v10, v58
    v_mul_f32 v59, v10, v59
    v_mul_f32 v60, v10, v60
    v_mul_f32 v61, v10, v61
    v_mul_f32 v62, v10, v62
    v_mul_f32 v63, v10, v63
    v_cvt_pk_bf16_f32 v104, v64, v65
    v_cvt_pk_bf16_f32 v105, v66, v67
    v_cvt_pk_bf16_f32 v106, v68, v69
    v_cvt_pk_bf16_f32 v107, v70, v71
    v_cvt_pk_bf16_f32 v108, v72, v73
    v_cvt_pk_bf16_f32 v109, v74, v75
    v_cvt_pk_bf16_f32 v110, v76, v77
    v_cvt_pk_bf16_f32 v111, v78, v79
    buffer_store_dwordx4 v[104:107], v3, s[40:43], s15 offen sc1
    buffer_store_dwordx4 v[108:111], v3, s[40:43], s44 offen sc1
    v_cvt_pk_bf16_f32 v112, v80, v81
    v_cvt_pk_bf16_f32 v113, v82, v83
    v_cvt_pk_bf16_f32 v114, v84, v85
    v_cvt_pk_bf16_f32 v115, v86, v87
    v_cvt_pk_bf16_f32 v116, v88, v89
    v_cvt_pk_bf16_f32 v117, v90, v91
    v_cvt_pk_bf16_f32 v118, v92, v93
    v_cvt_pk_bf16_f32 v119, v94, v95
    buffer_store_dwordx4 v[112:115], v6, s[40:43], s45 offen sc1
    buffer_store_dwordx4 v[116:119], v6, s[40:43], s45 offen offset:512 sc1
    v_cvt_pk_bf16_f32 v96, v48, v49
    v_cvt_pk_bf16_f32 v97, v50, v51
    v_cvt_pk_bf16_f32 v98, v52, v53
    v_cvt_pk_bf16_f32 v99, v54, v55
    v_cvt_pk_bf16_f32 v100, v56, v57
    v_cvt_pk_bf16_f32 v101, v58, v59
    v_cvt_pk_bf16_f32 v102, v60, v61
    v_cvt_pk_bf16_f32 v103, v62, v63
    buffer_store_dwordx4 v[96:99], v3, s[40:43], s9 offen sc1
    buffer_store_dwordx4 v[100:103], v3, s[40:43], s13 offen sc1
    s_endpgm
k01_a:
    s_sub_u32 s11, s3, 8
    v_lshlrev_b32 v6, 4, v5
    v_lshl_add_u32 v7, v4, 10, v6
    s_lshl_b32 s6, s5, 16
    s_lshl_b32 s7, s11, 13
    s_add_u32 s7, s7, s6
    s_add_u32 s8, s7, 4096
    s_waitcnt lgkmcnt(0)
    s_mov_b32 s44, s16
    s_and_b32 s45, s17, 0xffff
    s_mov_b32 s46, 0x200000
    s_mov_b32 s47, 0x20000
    s_barrier
    buffer_load_dwordx4 v[16:19], v7, s[44:47], s7 offen offset:0
    buffer_load_dwordx4 v[20:23], v7, s[44:47], s7 offen offset:512
    buffer_load_dwordx4 v[24:27], v7, s[44:47], s7 offen offset:2048
    buffer_load_dwordx4 v[28:31], v7, s[44:47], s7 offen offset:2560
    buffer_load_dwordx4 v[32:35], v7, s[44:47], s8 offen offset:0
    buffer_load_dwordx4 v[36:39], v7, s[44:47], s8 offen offset:512
    buffer_load_dwordx4 v[40:43], v7, s[44:47], s8 offen offset:2048
    buffer_load_dwordx4 v[44:47], v7, s[44:47], s8 offen offset:2560
    v_mov_b32 v8, 0
    v_mov_b32 v9, 1
    s_mov_b64 exec, 1
    ds_add_u32 v8, v9 offset:1036
    s_mov_b64 exec, -1
    s_and_b32 s12, s11, 1
    s_lshl_b32 s12, s12, 2
    v_or_b32 v124, s12, v4
    v_and_b32 v1, 7, v2
    v_xor_b32 v124, v124, v1
    v_lshlrev_b32 v124, 4, v124
    v_lshl_add_u32 v124, v5, 9, v124
    s_lshr_b32 s12, s11, 2
    s_lshl_b32 s12, s12, 15
    s_bfe_u32 s13, s11, 0x10001
    s_lshl_b32 s13, s13, 8
    s_add_u32 s12, s12, s13
    v_add_u32 v124, s12, v124
    v_xor_b32 v125, 32, v124
    v_lshlrev_b32 v126, 4, v5
    v_mov_b32 v1, 0x3f803f80
    s_waitcnt vmcnt(6)
    v_dot2_f32_bf16 v8, v16, v1, 0
    v_dot2_f32_bf16 v12, v16, v16, 0
    v_dot2_f32_bf16 v8, v17, v1, v8
    v_dot2_f32_bf16 v12, v17, v17, v12
    v_dot2_f32_bf16 v8, v18, v1, v8
    v_dot2_f32_bf16 v12, v18, v18, v12
    v_dot2_f32_bf16 v8, v19, v1, v8
    v_dot2_f32_bf16 v12, v19, v19, v12
    v_dot2_f32_bf16 v8, v20, v1, v8
    v_dot2_f32_bf16 v12, v20, v20, v12
    v_dot2_f32_bf16 v8, v21, v1, v8
    v_dot2_f32_bf16 v12, v21, v21, v12
    v_dot2_f32_bf16 v8, v22, v1, v8
    v_dot2_f32_bf16 v12, v22, v22, v12
    v_dot2_f32_bf16 v8, v23, v1, v8
    v_dot2_f32_bf16 v12, v23, v23, v12
    v_lshlrev_b32 v48, 16, v16
    v_and_b32 v49, 0xffff0000, v16
    v_lshlrev_b32 v50, 16, v17
    v_and_b32 v51, 0xffff0000, v17
    v_lshlrev_b32 v52, 16, v18
    v_and_b32 v53, 0xffff0000, v18
    v_lshlrev_b32 v54, 16, v19
    v_and_b32 v55, 0xffff0000, v19
    v_lshlrev_b32 v56, 16, v20
    v_and_b32 v57, 0xffff0000, v20
    v_lshlrev_b32 v58, 16, v21
    v_and_b32 v59, 0xffff0000, v21
    v_lshlrev_b32 v60, 16, v22
    v_and_b32 v61, 0xffff0000, v22
    v_lshlrev_b32 v62, 16, v23
    v_and_b32 v63, 0xffff0000, v23
    s_waitcnt vmcnt(4)
    v_dot2_f32_bf16 v9, v24, v1, 0
    v_dot2_f32_bf16 v13, v24, v24, 0
    v_dot2_f32_bf16 v9, v25, v1, v9
    v_dot2_f32_bf16 v13, v25, v25, v13
    v_dot2_f32_bf16 v9, v26, v1, v9
    v_dot2_f32_bf16 v13, v26, v26, v13
    v_dot2_f32_bf16 v9, v27, v1, v9
    v_dot2_f32_bf16 v13, v27, v27, v13
    v_dot2_f32_bf16 v9, v28, v1, v9
    v_dot2_f32_bf16 v13, v28, v28, v13
    v_dot2_f32_bf16 v9, v29, v1, v9
    v_dot2_f32_bf16 v13, v29, v29, v13
    v_dot2_f32_bf16 v9, v30, v1, v9
    v_dot2_f32_bf16 v13, v30, v30, v13
    v_dot2_f32_bf16 v9, v31, v1, v9
    v_dot2_f32_bf16 v13, v31, v31, v13
    v_lshlrev_b32 v64, 16, v24
    v_and_b32 v65, 0xffff0000, v24
    v_lshlrev_b32 v66, 16, v25
    v_and_b32 v67, 0xffff0000, v25
    v_lshlrev_b32 v68, 16, v26
    v_and_b32 v69, 0xffff0000, v26
    v_lshlrev_b32 v70, 16, v27
    v_and_b32 v71, 0xffff0000, v27
    v_lshlrev_b32 v72, 16, v28
    v_and_b32 v73, 0xffff0000, v28
    v_lshlrev_b32 v74, 16, v29
    v_and_b32 v75, 0xffff0000, v29
    v_lshlrev_b32 v76, 16, v30
    v_and_b32 v77, 0xffff0000, v30
    v_lshlrev_b32 v78, 16, v31
    v_and_b32 v79, 0xffff0000, v31
    s_waitcnt vmcnt(2)
    v_dot2_f32_bf16 v10, v32, v1, 0
    v_dot2_f32_bf16 v14, v32, v32, 0
    v_dot2_f32_bf16 v10, v33, v1, v10
    v_dot2_f32_bf16 v14, v33, v33, v14
    v_dot2_f32_bf16 v10, v34, v1, v10
    v_dot2_f32_bf16 v14, v34, v34, v14
    v_dot2_f32_bf16 v10, v35, v1, v10
    v_dot2_f32_bf16 v14, v35, v35, v14
    v_dot2_f32_bf16 v10, v36, v1, v10
    v_dot2_f32_bf16 v14, v36, v36, v14
    v_dot2_f32_bf16 v10, v37, v1, v10
    v_dot2_f32_bf16 v14, v37, v37, v14
    v_dot2_f32_bf16 v10, v38, v1, v10
    v_dot2_f32_bf16 v14, v38, v38, v14
    v_dot2_f32_bf16 v10, v39, v1, v10
    v_dot2_f32_bf16 v14, v39, v39, v14
    v_lshlrev_b32 v80, 16, v32
    v_and_b32 v81, 0xffff0000, v32
    v_lshlrev_b32 v82, 16, v33
    v_and_b32 v83, 0xffff0000, v33
    v_lshlrev_b32 v84, 16, v34
    v_and_b32 v85, 0xffff0000, v34
    v_lshlrev_b32 v86, 16, v35
    v_and_b32 v87, 0xffff0000, v35
    v_lshlrev_b32 v88, 16, v36
    v_and_b32 v89, 0xffff0000, v36
    v_lshlrev_b32 v90, 16, v37
    v_and_b32 v91, 0xffff0000, v37
    v_lshlrev_b32 v92, 16, v38
    v_and_b32 v93, 0xffff0000, v38
    v_lshlrev_b32 v94, 16, v39
    v_and_b32 v95, 0xffff0000, v39
    s_waitcnt vmcnt(0)
    v_dot2_f32_bf16 v11, v40, v1, 0
    v_dot2_f32_bf16 v15, v40, v40, 0
    v_dot2_f32_bf16 v11, v41, v1, v11
    v_dot2_f32_bf16 v15, v41, v41, v15
    v_dot2_f32_bf16 v11, v42, v1, v11
    v_dot2_f32_bf16 v15, v42, v42, v15
    v_dot2_f32_bf16 v11, v43, v1, v11
    v_dot2_f32_bf16 v15, v43, v43, v15
    v_dot2_f32_bf16 v11, v44, v1, v11
    v_dot2_f32_bf16 v15, v44, v44, v15
    v_dot2_f32_bf16 v11, v45, v1, v11
    v_dot2_f32_bf16 v15, v45, v45, v15
    v_dot2_f32_bf16 v11, v46, v1, v11
    v_dot2_f32_bf16 v15, v46, v46, v15
    v_dot2_f32_bf16 v11, v47, v1, v11
    v_dot2_f32_bf16 v15, v47, v47, v15
    v_add_f32_dpp v8, v8, v8 row_ror:8 row_mask:0xf bank_mask:0xf
    v_add_f32_dpp v9, v9, v9 row_ror:8 row_mask:0xf bank_mask:0xf
    v_add_f32_dpp v10, v10, v10 row_ror:8 row_mask:0xf bank_mask:0xf
    v_add_f32_dpp v11, v11, v11 row_ror:8 row_mask:0xf bank_mask:0xf
    v_add_f32_dpp v12, v12, v12 row_ror:8 row_mask:0xf bank_mask:0xf
    v_add_f32_dpp v13, v13, v13 row_ror:8 row_mask:0xf bank_mask:0xf
    v_add_f32_dpp v14, v14, v14 row_ror:8 row_mask:0xf bank_mask:0xf
    v_add_f32_dpp v15, v15, v15 row_ror:8 row_mask:0xf bank_mask:0xf
    v_add_f32_dpp v8, v8, v8 row_ror:4 row_mask:0xf bank_mask:0xf
    v_add_f32_dpp v9, v9, v9 row_ror:4 row_mask:0xf bank_mask:0xf
    v_add_f32_dpp v10, v10, v10 row_ror:4 row_mask:0xf bank_mask:0xf
    v_add_f32_dpp v11, v11, v11 row_ror:4 row_mask:0xf bank_mask:0xf
    v_add_f32_dpp v12, v12, v12 row_ror:4 row_mask:0xf bank_mask:0xf
    v_add_f32_dpp v13, v13, v13 row_ror:4 row_mask:0xf bank_mask:0xf
    v_add_f32_dpp v14, v14, v14 row_ror:4 row_mask:0xf bank_mask:0xf
    v_add_f32_dpp v15, v15, v15 row_ror:4 row_mask:0xf bank_mask:0xf
    v_add_f32_dpp v8, v8, v8 row_ror:2 row_mask:0xf bank_mask:0xf
    v_add_f32_dpp v9, v9, v9 row_ror:2 row_mask:0xf bank_mask:0xf
    v_add_f32_dpp v10, v10, v10 row_ror:2 row_mask:0xf bank_mask:0xf
    v_add_f32_dpp v11, v11, v11 row_ror:2 row_mask:0xf bank_mask:0xf
    v_add_f32_dpp v12, v12, v12 row_ror:2 row_mask:0xf bank_mask:0xf
    v_add_f32_dpp v13, v13, v13 row_ror:2 row_mask:0xf bank_mask:0xf
    v_add_f32_dpp v14, v14, v14 row_ror:2 row_mask:0xf bank_mask:0xf
    v_add_f32_dpp v15, v15, v15 row_ror:2 row_mask:0xf bank_mask:0xf
    v_add_f32_dpp v8, v8, v8 row_ror:1 row_mask:0xf bank_mask:0xf
    v_add_f32_dpp v9, v9, v9 row_ror:1 row_mask:0xf bank_mask:0xf
    v_add_f32_dpp v10, v10, v10 row_ror:1 row_mask:0xf bank_mask:0xf
    v_add_f32_dpp v11, v11, v11 row_ror:1 row_mask:0xf bank_mask:0xf
    v_add_f32_dpp v12, v12, v12 row_ror:1 row_mask:0xf bank_mask:0xf
    v_add_f32_dpp v13, v13, v13 row_ror:1 row_mask:0xf bank_mask:0xf
    v_add_f32_dpp v14, v14, v14 row_ror:1 row_mask:0xf bank_mask:0xf
    v_add_f32_dpp v15, v15, v15 row_ror:1 row_mask:0xf bank_mask:0xf
    v_mov_b32 v112, v8
    v_mov_b32 v113, v9
    v_mov_b32 v114, v10
    v_mov_b32 v115, v11
    v_mov_b32 v116, v12
    v_mov_b32 v117, v13
    v_mov_b32 v118, v14
    v_mov_b32 v119, v15
    v_permlane16_swap_b32 v8, v112
    v_permlane16_swap_b32 v9, v113
    v_permlane16_swap_b32 v10, v114
    v_permlane16_swap_b32 v11, v115
    v_permlane16_swap_b32 v12, v116
    v_permlane16_swap_b32 v13, v117
    v_permlane16_swap_b32 v14, v118
    v_permlane16_swap_b32 v15, v119
    v_add_f32 v8, v8, v112
    v_add_f32 v9, v9, v113
    v_add_f32 v10, v10, v114
    v_add_f32 v11, v11, v115
    v_add_f32 v12, v12, v116
    v_add_f32 v13, v13, v117
    v_add_f32 v14, v14, v118
    v_add_f32 v15, v15, v119
    v_mul_f32 v8, 0x3b000000, v8
    v_mul_f32 v9, 0x3b000000, v9
    v_mul_f32 v10, 0x3b000000, v10
    v_mul_f32 v11, 0x3b000000, v11
    v_mul_f32 v12, 0x3b000000, v12
    v_mul_f32 v13, 0x3b000000, v13
    v_mul_f32 v14, 0x3b000000, v14
    v_mul_f32 v15, 0x3b000000, v15
    v_fma_f32 v12, -v8, v8, v12
    v_fma_f32 v13, -v9, v9, v13
    v_fma_f32 v14, -v10, v10, v14
    v_fma_f32 v15, -v11, v11, v15
    v_max_f32 v12, 0, v12
    v_max_f32 v13, 0, v13
    v_max_f32 v14, 0, v14
    v_max_f32 v15, 0, v15
    v_cvt_pk_bf16_f32 v8, v8, v8
    v_lshlrev_b32 v8, 16, v8
    v_cvt_pk_bf16_f32 v9, v9, v9
    v_lshlrev_b32 v9, 16, v9
    v_cvt_pk_bf16_f32 v10, v10, v10
    v_lshlrev_b32 v10, 16, v10
    v_cvt_pk_bf16_f32 v11, v11, v11
    v_lshlrev_b32 v11, 16, v11
    v_cvt_pk_bf16_f32 v12, v12, v12
    v_lshlrev_b32 v12, 16, v12
    v_cvt_pk_bf16_f32 v13, v13, v13
    v_lshlrev_b32 v13, 16, v13
    v_cvt_pk_bf16_f32 v14, v14, v14
    v_lshlrev_b32 v14, 16, v14
    v_cvt_pk_bf16_f32 v15, v15, v15
    v_lshlrev_b32 v15, 16, v15
    v_add_f32 v12, 0x3727c5ac, v12
    v_add_f32 v13, 0x3727c5ac, v13
    v_add_f32 v14, 0x3727c5ac, v14
    v_add_f32 v15, 0x3727c5ac, v15
    v_cvt_pk_bf16_f32 v12, v12, v12
    v_lshlrev_b32 v12, 16, v12
    v_cvt_pk_bf16_f32 v13, v13, v13
    v_lshlrev_b32 v13, 16, v13
    v_cvt_pk_bf16_f32 v14, v14, v14
    v_lshlrev_b32 v14, 16, v14
    v_cvt_pk_bf16_f32 v15, v15, v15
    v_lshlrev_b32 v15, 16, v15
    v_sqrt_f32 v12, v12
    v_sqrt_f32 v13, v13
    v_sqrt_f32 v14, v14
    v_sqrt_f32 v15, v15
    v_lshlrev_b32 v96, 16, v40
    v_and_b32 v97, 0xffff0000, v40
    v_lshlrev_b32 v98, 16, v41
    v_and_b32 v99, 0xffff0000, v41
    v_lshlrev_b32 v100, 16, v42
    v_and_b32 v101, 0xffff0000, v42
    v_lshlrev_b32 v102, 16, v43
    v_and_b32 v103, 0xffff0000, v43
    v_cvt_pk_bf16_f32 v12, v12, v12
    v_lshlrev_b32 v12, 16, v12
    v_cvt_pk_bf16_f32 v13, v13, v13
    v_lshlrev_b32 v13, 16, v13
    v_cvt_pk_bf16_f32 v14, v14, v14
    v_lshlrev_b32 v14, 16, v14
    v_cvt_pk_bf16_f32 v15, v15, v15
    v_lshlrev_b32 v15, 16, v15
    v_rcp_f32 v12, v12
    v_rcp_f32 v13, v13
    v_rcp_f32 v14, v14
    v_rcp_f32 v15, v15
    v_lshlrev_b32 v104, 16, v44
    v_and_b32 v105, 0xffff0000, v44
    v_lshlrev_b32 v106, 16, v45
    v_and_b32 v107, 0xffff0000, v45
    v_lshlrev_b32 v108, 16, v46
    v_and_b32 v109, 0xffff0000, v46
    v_lshlrev_b32 v110, 16, v47
    v_and_b32 v111, 0xffff0000, v47
    v_mul_f32 v8, -v8, v12
    v_mul_f32 v9, -v9, v13
    v_mul_f32 v10, -v10, v14
    v_mul_f32 v11, -v11, v15
    v_pk_fma_f32 v[48:49], v[48:49], v[12:13], v[8:9] op_sel:[0,0,0] op_sel_hi:[1,0,0]
    v_pk_fma_f32 v[50:51], v[50:51], v[12:13], v[8:9] op_sel:[0,0,0] op_sel_hi:[1,0,0]
    v_pk_fma_f32 v[52:53], v[52:53], v[12:13], v[8:9] op_sel:[0,0,0] op_sel_hi:[1,0,0]
    v_pk_fma_f32 v[54:55], v[54:55], v[12:13], v[8:9] op_sel:[0,0,0] op_sel_hi:[1,0,0]
    v_pk_fma_f32 v[56:57], v[56:57], v[12:13], v[8:9] op_sel:[0,0,0] op_sel_hi:[1,0,0]
    v_pk_fma_f32 v[58:59], v[58:59], v[12:13], v[8:9] op_sel:[0,0,0] op_sel_hi:[1,0,0]
    v_pk_fma_f32 v[60:61], v[60:61], v[12:13], v[8:9] op_sel:[0,0,0] op_sel_hi:[1,0,0]
    v_pk_fma_f32 v[62:63], v[62:63], v[12:13], v[8:9] op_sel:[0,0,0] op_sel_hi:[1,0,0]
    v_pk_fma_f32 v[64:65], v[64:65], v[12:13], v[8:9] op_sel:[0,1,1] op_sel_hi:[1,1,1]
    v_pk_fma_f32 v[66:67], v[66:67], v[12:13], v[8:9] op_sel:[0,1,1] op_sel_hi:[1,1,1]
    v_pk_fma_f32 v[68:69], v[68:69], v[12:13], v[8:9] op_sel:[0,1,1] op_sel_hi:[1,1,1]
    v_pk_fma_f32 v[70:71], v[70:71], v[12:13], v[8:9] op_sel:[0,1,1] op_sel_hi:[1,1,1]
    v_pk_fma_f32 v[72:73], v[72:73], v[12:13], v[8:9] op_sel:[0,1,1] op_sel_hi:[1,1,1]
    v_pk_fma_f32 v[74:75], v[74:75], v[12:13], v[8:9] op_sel:[0,1,1] op_sel_hi:[1,1,1]
    v_pk_fma_f32 v[76:77], v[76:77], v[12:13], v[8:9] op_sel:[0,1,1] op_sel_hi:[1,1,1]
    v_pk_fma_f32 v[78:79], v[78:79], v[12:13], v[8:9] op_sel:[0,1,1] op_sel_hi:[1,1,1]
    v_pk_fma_f32 v[80:81], v[80:81], v[14:15], v[10:11] op_sel:[0,0,0] op_sel_hi:[1,0,0]
    v_pk_fma_f32 v[82:83], v[82:83], v[14:15], v[10:11] op_sel:[0,0,0] op_sel_hi:[1,0,0]
    v_pk_fma_f32 v[84:85], v[84:85], v[14:15], v[10:11] op_sel:[0,0,0] op_sel_hi:[1,0,0]
    v_pk_fma_f32 v[86:87], v[86:87], v[14:15], v[10:11] op_sel:[0,0,0] op_sel_hi:[1,0,0]
    v_pk_fma_f32 v[88:89], v[88:89], v[14:15], v[10:11] op_sel:[0,0,0] op_sel_hi:[1,0,0]
    v_pk_fma_f32 v[90:91], v[90:91], v[14:15], v[10:11] op_sel:[0,0,0] op_sel_hi:[1,0,0]
    v_pk_fma_f32 v[92:93], v[92:93], v[14:15], v[10:11] op_sel:[0,0,0] op_sel_hi:[1,0,0]
    v_pk_fma_f32 v[94:95], v[94:95], v[14:15], v[10:11] op_sel:[0,0,0] op_sel_hi:[1,0,0]
    v_pk_fma_f32 v[96:97], v[96:97], v[14:15], v[10:11] op_sel:[0,1,1] op_sel_hi:[1,1,1]
    v_pk_fma_f32 v[98:99], v[98:99], v[14:15], v[10:11] op_sel:[0,1,1] op_sel_hi:[1,1,1]
    v_pk_fma_f32 v[100:101], v[100:101], v[14:15], v[10:11] op_sel:[0,1,1] op_sel_hi:[1,1,1]
    v_pk_fma_f32 v[102:103], v[102:103], v[14:15], v[10:11] op_sel:[0,1,1] op_sel_hi:[1,1,1]
    v_pk_fma_f32 v[104:105], v[104:105], v[14:15], v[10:11] op_sel:[0,1,1] op_sel_hi:[1,1,1]
    v_pk_fma_f32 v[106:107], v[106:107], v[14:15], v[10:11] op_sel:[0,1,1] op_sel_hi:[1,1,1]
    v_pk_fma_f32 v[108:109], v[108:109], v[14:15], v[10:11] op_sel:[0,1,1] op_sel_hi:[1,1,1]
    v_pk_fma_f32 v[110:111], v[110:111], v[14:15], v[10:11] op_sel:[0,1,1] op_sel_hi:[1,1,1]
    s_setprio 2
    s_barrier
    ds_read_b128 v[16:19], v126 offset:16384
    ds_read_b128 v[20:23], v126 offset:16896
    ds_read_b128 v[24:27], v126 offset:18432
    ds_read_b128 v[28:31], v126 offset:18944
    ds_read_b128 v[32:35], v126 offset:17408
    ds_read_b128 v[36:39], v126 offset:17920
    ds_read_b128 v[40:43], v126 offset:19456
    ds_read_b128 v[44:47], v126 offset:19968
    s_waitcnt lgkmcnt(4)
    v_pk_fma_f32 v[48:49], v[48:49], v[24:25], v[16:17]
    v_pk_fma_f32 v[50:51], v[50:51], v[26:27], v[18:19]
    v_pk_fma_f32 v[52:53], v[52:53], v[28:29], v[20:21]
    v_pk_fma_f32 v[54:55], v[54:55], v[30:31], v[22:23]
    v_cvt_pk_bf16_f32 v112, v48, v49
    v_cvt_pk_bf16_f32 v113, v50, v51
    v_cvt_pk_bf16_f32 v114, v52, v53
    v_cvt_pk_bf16_f32 v115, v54, v55
    ds_write_b128 v124, v[112:115] offset:0
    v_pk_fma_f32 v[64:65], v[64:65], v[24:25], v[16:17]
    v_pk_fma_f32 v[66:67], v[66:67], v[26:27], v[18:19]
    v_pk_fma_f32 v[68:69], v[68:69], v[28:29], v[20:21]
    v_pk_fma_f32 v[70:71], v[70:71], v[30:31], v[22:23]
    v_cvt_pk_bf16_f32 v116, v64, v65
    v_cvt_pk_bf16_f32 v117, v66, v67
    v_cvt_pk_bf16_f32 v118, v68, v69
    v_cvt_pk_bf16_f32 v119, v70, v71
    ds_write_b128 v125, v[116:119] offset:0
    v_pk_fma_f32 v[80:81], v[80:81], v[24:25], v[16:17]
    v_pk_fma_f32 v[82:83], v[82:83], v[26:27], v[18:19]
    v_pk_fma_f32 v[84:85], v[84:85], v[28:29], v[20:21]
    v_pk_fma_f32 v[86:87], v[86:87], v[30:31], v[22:23]
    v_cvt_pk_bf16_f32 v112, v80, v81
    v_cvt_pk_bf16_f32 v113, v82, v83
    v_cvt_pk_bf16_f32 v114, v84, v85
    v_cvt_pk_bf16_f32 v115, v86, v87
    ds_write_b128 v124, v[112:115] offset:128
    v_pk_fma_f32 v[96:97], v[96:97], v[24:25], v[16:17]
    v_pk_fma_f32 v[98:99], v[98:99], v[26:27], v[18:19]
    v_pk_fma_f32 v[100:101], v[100:101], v[28:29], v[20:21]
    v_pk_fma_f32 v[102:103], v[102:103], v[30:31], v[22:23]
    v_cvt_pk_bf16_f32 v116, v96, v97
    v_cvt_pk_bf16_f32 v117, v98, v99
    v_cvt_pk_bf16_f32 v118, v100, v101
    v_cvt_pk_bf16_f32 v119, v102, v103
    ds_write_b128 v125, v[116:119] offset:128
    s_waitcnt lgkmcnt(0)
    s_barrier
    s_setprio 0
    v_pk_fma_f32 v[56:57], v[56:57], v[40:41], v[32:33]
    v_pk_fma_f32 v[58:59], v[58:59], v[42:43], v[34:35]
    v_pk_fma_f32 v[60:61], v[60:61], v[44:45], v[36:37]
    v_pk_fma_f32 v[62:63], v[62:63], v[46:47], v[38:39]
    v_cvt_pk_bf16_f32 v112, v56, v57
    v_cvt_pk_bf16_f32 v113, v58, v59
    v_cvt_pk_bf16_f32 v114, v60, v61
    v_cvt_pk_bf16_f32 v115, v62, v63
    ds_write_b128 v124, v[112:115] offset:16384
    v_pk_fma_f32 v[72:73], v[72:73], v[40:41], v[32:33]
    v_pk_fma_f32 v[74:75], v[74:75], v[42:43], v[34:35]
    v_pk_fma_f32 v[76:77], v[76:77], v[44:45], v[36:37]
    v_pk_fma_f32 v[78:79], v[78:79], v[46:47], v[38:39]
    v_cvt_pk_bf16_f32 v116, v72, v73
    v_cvt_pk_bf16_f32 v117, v74, v75
    v_cvt_pk_bf16_f32 v118, v76, v77
    v_cvt_pk_bf16_f32 v119, v78, v79
    ds_write_b128 v125, v[116:119] offset:16384
    s_barrier
    v_pk_fma_f32 v[88:89], v[88:89], v[40:41], v[32:33]
    v_pk_fma_f32 v[90:91], v[90:91], v[42:43], v[34:35]
    v_pk_fma_f32 v[92:93], v[92:93], v[44:45], v[36:37]
    v_pk_fma_f32 v[94:95], v[94:95], v[46:47], v[38:39]
    v_cvt_pk_bf16_f32 v112, v88, v89
    v_cvt_pk_bf16_f32 v113, v90, v91
    v_cvt_pk_bf16_f32 v114, v92, v93
    v_cvt_pk_bf16_f32 v115, v94, v95
    ds_write_b128 v124, v[112:115] offset:16512
    v_pk_fma_f32 v[104:105], v[104:105], v[40:41], v[32:33]
    v_pk_fma_f32 v[106:107], v[106:107], v[42:43], v[34:35]
    v_pk_fma_f32 v[108:109], v[108:109], v[44:45], v[36:37]
    v_pk_fma_f32 v[110:111], v[110:111], v[46:47], v[38:39]
    v_cvt_pk_bf16_f32 v116, v104, v105
    v_cvt_pk_bf16_f32 v117, v106, v107
    v_cvt_pk_bf16_f32 v118, v108, v109
    v_cvt_pk_bf16_f32 v119, v110, v111
    ds_write_b128 v125, v[116:119] offset:16512
    s_waitcnt lgkmcnt(0)
    s_barrier
    s_endpgm
k01_dma:
    s_and_b32 s11, s3, 3
    v_and_b32 v9, 7, v2
    v_lshrrev_b32 v11, 3, v2
    v_bfe_u32 v12, v2, 4, 1
    v_lshlrev_b32 v12, 2, v12
    v_xor_b32 v12, v12, v9
    v_lshlrev_b32 v12, 4, v12
    v_mul_u32_u24 v11, 0xc00, v11
    v_add_u32 v11, v11, v12
    s_mul_i32 s12, s11, 49152
    s_lshl_b32 s13, s4, 7
    s_add_u32 s12, s12, s13
    s_sub_u32 s15, s9, 1
    s_lshl_b32 s15, s15, 1
    s_bfe_u32 s7, s2, 0x10005
    s_add_u32 s15, s15, s7
    s_lshl_b32 s15, s15, 2
    s_add_u32 s15, s15, s11
    s_mul_i32 s8, s15, 3
    s_add_u32 s15, s8, 8
    s_mul_i32 s15, s15, 24576
    s_lshr_b32 s15, s2, 5
    s_lshl_b32 s15, s15, 2
    s_add_u32 s15, s15, s11
    s_add_u32 s15, s15, 32
    s_mul_i32 s15, s15, 24576
    s_add_u32 s15, s15, s13
    s_lshl_b32 s13, s11, 11
    s_add_u32 s13, s13, 65536
    s_waitcnt lgkmcnt(0)
    s_mov_b32 s44, s18
    s_and_b32 s45, s19, 0xffff
    s_mov_b32 s46, 0x180000
    s_mov_b32 s47, 0x20000
    s_barrier
    s_cmp_lg_u32 s9, 0
    s_cbranch_scc1 k01_dw_go
    v_mov_b32 v13, 0
k01_dw_w:
    s_sleep 1
    ds_read_b32 v14, v13 offset:1028
    s_waitcnt lgkmcnt(0)
    v_readfirstlane_b32 s14, v14
    s_nop 0
    s_cmp_lt_u32 s14, 1
    s_nop 0
    s_cbranch_scc1 k01_dw_w
k01_dw_go:
    v_mov_b32 v13, 0
k01_xw_w:
    s_sleep 1
    ds_read_b32 v14, v13 offset:1036
    s_waitcnt lgkmcnt(0)
    v_readfirstlane_b32 s14, v14
    s_nop 0
    s_cmp_lt_u32 s14, 8
    s_nop 0
    s_cbranch_scc1 k01_xw_w
    s_add_u32 m0, s13, 0
    s_add_u32 s14, s12, 0
    buffer_load_dwordx4 v11, s[44:47], s14 offen lds
    s_add_u32 m0, s13, 8192
    s_add_u32 s14, s12, 1024
    buffer_load_dwordx4 v11, s[44:47], s14 offen lds
    s_add_u32 m0, s13, 16384
    s_add_u32 s14, s12, 2048
    buffer_load_dwordx4 v11, s[44:47], s14 offen lds
    s_add_u32 m0, s13, 1024
    s_add_u32 s14, s12, 24576
    buffer_load_dwordx4 v11, s[44:47], s14 offen lds
    s_add_u32 m0, s13, 9216
    s_add_u32 s14, s12, 25600
    buffer_load_dwordx4 v11, s[44:47], s14 offen lds
    s_add_u32 m0, s13, 17408
    s_add_u32 s14, s12, 26624
    buffer_load_dwordx4 v11, s[44:47], s14 offen lds
    s_add_u32 m0, s13, 24576
    s_add_u32 s14, s12, 196608
    buffer_load_dwordx4 v11, s[44:47], s14 offen lds
    s_add_u32 m0, s13, 32768
    s_add_u32 s14, s12, 197632
    buffer_load_dwordx4 v11, s[44:47], s14 offen lds
    s_add_u32 m0, s13, 40960
    s_add_u32 s14, s12, 198656
    buffer_load_dwordx4 v11, s[44:47], s14 offen lds
    s_add_u32 m0, s13, 25600
    s_add_u32 s14, s12, 221184
    buffer_load_dwordx4 v11, s[44:47], s14 offen lds
    s_add_u32 m0, s13, 33792
    s_add_u32 s14, s12, 222208
    buffer_load_dwordx4 v11, s[44:47], s14 offen lds
    s_add_u32 m0, s13, 41984
    s_add_u32 s14, s12, 223232
    buffer_load_dwordx4 v11, s[44:47], s14 offen lds
    v_mov_b32 v13, 0
k01_pw_w:
    s_sleep 1
    ds_read_b32 v14, v13 offset:1032
    s_waitcnt lgkmcnt(0)
    v_readfirstlane_b32 s14, v14
    s_nop 0
    s_cmp_lt_u32 s14, 1
    s_nop 0
    s_cbranch_scc1 k01_pw_w
    s_waitcnt vmcnt(0)
    s_add_u32 m0, s13, 49152
    s_add_u32 s14, s12, 393216
    buffer_load_dwordx4 v11, s[44:47], s14 offen lds
    s_add_u32 m0, s13, 57344
    s_add_u32 s14, s12, 394240
    buffer_load_dwordx4 v11, s[44:47], s14 offen lds
    s_add_u32 m0, s13, 65536
    s_add_u32 s14, s12, 395264
    buffer_load_dwordx4 v11, s[44:47], s14 offen lds
    s_add_u32 m0, s13, 50176
    s_add_u32 s14, s12, 417792
    buffer_load_dwordx4 v11, s[44:47], s14 offen lds
    s_add_u32 m0, s13, 58368
    s_add_u32 s14, s12, 418816
    buffer_load_dwordx4 v11, s[44:47], s14 offen lds
    s_add_u32 m0, s13, 66560
    s_add_u32 s14, s12, 419840
    buffer_load_dwordx4 v11, s[44:47], s14 offen lds
    s_barrier
    s_add_u32 m0, s13, 73728
    s_add_u32 s14, s12, 589824
    buffer_load_dwordx4 v11, s[44:47], s14 offen lds
    s_add_u32 m0, s13, 81920
    s_add_u32 s14, s12, 590848
    buffer_load_dwordx4 v11, s[44:47], s14 offen lds
    s_add_u32 m0, s13, 90112
    s_add_u32 s14, s12, 591872
    buffer_load_dwordx4 v11, s[44:47], s14 offen lds
    s_add_u32 m0, s13, 74752
    s_add_u32 s14, s12, 614400
    buffer_load_dwordx4 v11, s[44:47], s14 offen lds
    s_add_u32 m0, s13, 82944
    s_add_u32 s14, s12, 615424
    buffer_load_dwordx4 v11, s[44:47], s14 offen lds
    s_add_u32 m0, s13, 91136
    s_add_u32 s14, s12, 616448
    buffer_load_dwordx4 v11, s[44:47], s14 offen lds
    buffer_load_dwordx4 v[16:19], v11, s[44:47], s15 offen offset:0
    buffer_load_dwordx4 v[20:23], v11, s[44:47], s15 offen offset:1024
    buffer_load_dwordx4 v[24:27], v11, s[44:47], s15 offen offset:2048
    s_waitcnt vmcnt(15)
    s_barrier
    s_waitcnt vmcnt(16)
    s_barrier
    s_waitcnt vmcnt(9)
    s_barrier
    s_add_u32 m0, s13, 0
    s_add_u32 s14, s12, 786432
    buffer_load_dwordx4 v11, s[44:47], s14 offen lds
    s_add_u32 m0, s13, 8192
    s_add_u32 s14, s12, 787456
    buffer_load_dwordx4 v11, s[44:47], s14 offen lds
    s_add_u32 m0, s13, 16384
    s_add_u32 s14, s12, 788480
    buffer_load_dwordx4 v11, s[44:47], s14 offen lds
    s_add_u32 m0, s13, 1024
    s_add_u32 s14, s12, 811008
    buffer_load_dwordx4 v11, s[44:47], s14 offen lds
    s_add_u32 m0, s13, 9216
    s_add_u32 s14, s12, 812032
    buffer_load_dwordx4 v11, s[44:47], s14 offen lds
    s_add_u32 m0, s13, 17408
    s_add_u32 s14, s12, 813056
    buffer_load_dwordx4 v11, s[44:47], s14 offen lds
    s_waitcnt vmcnt(9)
    s_barrier
    s_add_u32 m0, s13, 24576
    s_add_u32 s14, s12, 983040
    buffer_load_dwordx4 v11, s[44:47], s14 offen lds
    s_add_u32 m0, s13, 32768
    s_add_u32 s14, s12, 984064
    buffer_load_dwordx4 v11, s[44:47], s14 offen lds
    s_add_u32 m0, s13, 40960
    s_add_u32 s14, s12, 985088
    buffer_load_dwordx4 v11, s[44:47], s14 offen lds
    s_add_u32 m0, s13, 25600
    s_add_u32 s14, s12, 1007616
    buffer_load_dwordx4 v11, s[44:47], s14 offen lds
    s_add_u32 m0, s13, 33792
    s_add_u32 s14, s12, 1008640
    buffer_load_dwordx4 v11, s[44:47], s14 offen lds
    s_add_u32 m0, s13, 41984
    s_add_u32 s14, s12, 1009664
    buffer_load_dwordx4 v11, s[44:47], s14 offen lds
    s_waitcnt vmcnt(6)
    s_barrier
    s_add_u32 m0, s13, 49152
    s_add_u32 s14, s12, 1179648
    buffer_load_dwordx4 v11, s[44:47], s14 offen lds
    s_add_u32 m0, s13, 57344
    s_add_u32 s14, s12, 1180672
    buffer_load_dwordx4 v11, s[44:47], s14 offen lds
    s_add_u32 m0, s13, 65536
    s_add_u32 s14, s12, 1181696
    buffer_load_dwordx4 v11, s[44:47], s14 offen lds
    s_add_u32 m0, s13, 50176
    s_add_u32 s14, s12, 1204224
    buffer_load_dwordx4 v11, s[44:47], s14 offen lds
    s_add_u32 m0, s13, 58368
    s_add_u32 s14, s12, 1205248
    buffer_load_dwordx4 v11, s[44:47], s14 offen lds
    s_add_u32 m0, s13, 66560
    s_add_u32 s14, s12, 1206272
    buffer_load_dwordx4 v11, s[44:47], s14 offen lds
    s_waitcnt vmcnt(6)
    s_barrier
    s_add_u32 m0, s13, 73728
    s_add_u32 s14, s12, 1376256
    buffer_load_dwordx4 v11, s[44:47], s14 offen lds
    s_add_u32 m0, s13, 81920
    s_add_u32 s14, s12, 1377280
    buffer_load_dwordx4 v11, s[44:47], s14 offen lds
    s_add_u32 m0, s13, 90112
    s_add_u32 s14, s12, 1378304
    buffer_load_dwordx4 v11, s[44:47], s14 offen lds
    s_add_u32 m0, s13, 74752
    s_add_u32 s14, s12, 1400832
    buffer_load_dwordx4 v11, s[44:47], s14 offen lds
    s_add_u32 m0, s13, 82944
    s_add_u32 s14, s12, 1401856
    buffer_load_dwordx4 v11, s[44:47], s14 offen lds
    s_add_u32 m0, s13, 91136
    s_add_u32 s14, s12, 1402880
    buffer_load_dwordx4 v11, s[44:47], s14 offen lds
    s_waitcnt vmcnt(6)
    s_barrier
    s_waitcnt vmcnt(0)
    s_barrier
    s_endpgm
k01_kernel_end:
    s_endpgm
.p2align 8
.globl k2_kernel
.type k2_kernel,@function
k2_kernel:
    s_cmp_ge_u32 s2, 256
    s_cbranch_scc1 k2_kernel_end
    s_load_dwordx16 s[16:31], s[0:1], 0
    s_load_dwordx8 s[32:39], s[0:1], 64
    v_lshrrev_b32 v1, 6, v0
    v_and_b32 v2, 63, v0
    s_and_b32 s4, s2, 7
    v_readfirstlane_b32 s3, v1
    s_lshl_b32 s4, s4, 2
    s_bfe_u32 s5, s2, 0x20003
    s_add_u32 s4, s4, s5
    s_lshr_b32 s5, s2, 5
    s_lshl_b32 s5, s5, 3
    s_add_u32 s5, s5, s3
    v_lshlrev_b32 v3, 4, v2
    s_waitcnt lgkmcnt(0)
    s_mov_b32 s40, s38
    s_and_b32 s41, s39, 0xffff
    s_mov_b32 s42, 0x2200000
    s_mov_b32 s43, 0x20000
    s_cmp_ge_u32 s3, 8
    s_cbranch_scc1 k2_side
    s_lshl_b32 s8, s4, 17
    s_add_u32 s8, s8, 0xc00000
    s_lshl_b32 s7, s3, 10
    s_add_u32 s8, s8, s7
    s_mov_b32 m0, s7
    s_lshl_b32 s6, s4, 16
    buffer_load_dwordx4 v3, s[40:43], s8 offen lds
    s_lshl_b32 s9, s5, 10
    s_add_u32 s6, s6, s9
    s_add_u32 s6, s6, 0xa00000
    buffer_load_dwordx4 v[8:11], v3, s[40:43], s6 offen
    s_add_u32 m0, s7, 65536
    s_add_u32 s8, s8, 65536
    buffer_load_dwordx4 v3, s[40:43], s8 offen lds
    v_lshrrev_b32 v5, 5, v2
    v_lshlrev_b32 v5, 8, v5
    v_and_b32 v6, 15, v2
    v_lshl_add_u32 v5, v6, 4, v5
    v_add_u32 v5, 0x10000, v5
    v_and_b32 v6, 27, v2
    v_cmp_eq_u32 vcc, 16, v6
    v_mov_b32 v7, 0x3f803f80
    s_nop 0
    v_cndmask_b32 v20, 0, v7, vcc
    v_cndmask_b32 v21, 0, v7, vcc
    v_cndmask_b32 v22, 0, v7, vcc
    v_cndmask_b32 v23, 0, v7, vcc
    v_cndmask_b32 v24, 0, v7, vcc
    v_cndmask_b32 v25, 0, v7, vcc
    v_cndmask_b32 v26, 0, v7, vcc
    v_cndmask_b32 v27, 0, v7, vcc
    v_cndmask_b32 v28, 0, v7, vcc
    v_cndmask_b32 v29, 0, v7, vcc
    v_cndmask_b32 v30, 0, v7, vcc
    v_cndmask_b32 v31, 0, v7, vcc
    v_cndmask_b32 v32, 0, v7, vcc
    v_cndmask_b32 v33, 0, v7, vcc
    v_cndmask_b32 v34, 0, v7, vcc
    v_cndmask_b32 v35, 0, v7, vcc
    s_mov_b32 s60, 0xffff
    s_mov_b32 s61, 0xffff
    v_mov_b32 v7, 0x24000
    s_setprio 1
    s_cmp_ge_u32 s3, 4
    s_cbranch_scc1 k2_lowp
    s_setprio 2
k2_lowp:
    v_mov_b32 v100, 0
    v_mov_b32 v101, 0
    v_mov_b32 v102, 0
    v_mov_b32 v103, 0
    v_mov_b32 v104, 0
    v_mov_b32 v105, 0
    v_mov_b32 v106, 0
    v_mov_b32 v107, 0
    v_mov_b32 v108, 0
    v_mov_b32 v109, 0
    v_mov_b32 v110, 0
    v_mov_b32 v111, 0
    v_mov_b32 v112, 0
    v_mov_b32 v113, 0
    v_mov_b32 v114, 0
    v_mov_b32 v115, 0
    s_waitcnt vmcnt(0)
    s_barrier
    ds_read_b128 v[12:15], v3
    ds_read_b128 v[16:19], v3 offset:1024
    s_waitcnt lgkmcnt(1)
    v_mfma_f32_32x32x16_bf16 v[52:67], v[12:15], v[8:11], 0
    s_waitcnt lgkmcnt(0)
    ds_read_b128 v[12:15], v3 offset:2048
    s_mov_b64 exec, s[60:61]
    ds_read_b128 v[20:23], v5 offset:0
    ds_read_b128 v[24:27], v5 offset:512
    s_mov_b64 exec, -1
    v_mfma_f32_32x32x16_bf16 v[68:83], v[16:19], v[8:11], 0
    s_nop 4
    v_exp_f32 v52, v52
    v_exp_f32 v53, v53
    v_exp_f32 v54, v54
    v_exp_f32 v55, v55
    v_exp_f32 v56, v56
    v_exp_f32 v57, v57
    v_exp_f32 v58, v58
    v_exp_f32 v59, v59
    v_exp_f32 v60, v60
    v_exp_f32 v61, v61
    v_exp_f32 v62, v62
    v_exp_f32 v63, v63
    v_exp_f32 v64, v64
    v_exp_f32 v65, v65
    v_exp_f32 v66, v66
    v_exp_f32 v67, v67
    v_cvt_pk_bf16_f32 v84, v52, v53
    v_cvt_pk_bf16_f32 v85, v54, v55
    v_cvt_pk_bf16_f32 v86, v56, v57
    v_cvt_pk_bf16_f32 v87, v58, v59
    v_cvt_pk_bf16_f32 v88, v60, v61
    v_cvt_pk_bf16_f32 v89, v62, v63
    v_cvt_pk_bf16_f32 v90, v64, v65
    v_cvt_pk_bf16_f32 v91, v66, v67
    s_waitcnt lgkmcnt(0)
    ds_read_b128 v[16:19], v3 offset:3072
    s_mov_b64 exec, s[60:61]
    ds_read_b128 v[28:31], v5 offset:1024
    ds_read_b128 v[32:35], v5 offset:1536
    s_mov_b64 exec, -1
    v_mfma_f32_32x32x16_bf16 v[52:67], v[12:15], v[8:11], 0
    v_exp_f32 v68, v68
    v_exp_f32 v69, v69
    v_exp_f32 v70, v70
    v_exp_f32 v71, v71
    v_exp_f32 v72, v72
    v_exp_f32 v73, v73
    v_exp_f32 v74, v74
    v_exp_f32 v75, v75
    v_mfma_f32_32x32x16_bf16 v[100:115], v[20:23], v[84:87], v[100:115]
    v_exp_f32 v76, v76
    v_exp_f32 v77, v77
    v_exp_f32 v78, v78
    v_exp_f32 v79, v79
    v_exp_f32 v80, v80
    v_exp_f32 v81, v81
    v_exp_f32 v82, v82
    v_exp_f32 v83, v83
    v_mfma_f32_32x32x16_bf16 v[100:115], v[24:27], v[88:91], v[100:115]
    v_cvt_pk_bf16_f32 v92, v68, v69
    v_cvt_pk_bf16_f32 v93, v70, v71
    v_cvt_pk_bf16_f32 v94, v72, v73
    v_cvt_pk_bf16_f32 v95, v74, v75
    v_cvt_pk_bf16_f32 v96, v76, v77
    v_cvt_pk_bf16_f32 v97, v78, v79
    v_cvt_pk_bf16_f32 v98, v80, v81
    v_cvt_pk_bf16_f32 v99, v82, v83
    s_waitcnt lgkmcnt(0)
    ds_read_b128 v[12:15], v3 offset:4096
    s_mov_b64 exec, s[60:61]
    ds_read_b128 v[20:23], v5 offset:2048
    ds_read_b128 v[24:27], v5 offset:2560
    s_mov_b64 exec, -1
    v_mfma_f32_32x32x16_bf16 v[68:83], v[16:19], v[8:11], 0
    v_exp_f32 v52, v52
    v_exp_f32 v53, v53
    v_exp_f32 v54, v54
    v_exp_f32 v55, v55
    v_exp_f32 v56, v56
    v_exp_f32 v57, v57
    v_exp_f32 v58, v58
    v_exp_f32 v59, v59
    v_mfma_f32_32x32x16_bf16 v[100:115], v[28:31], v[92:95], v[100:115]
    v_exp_f32 v60, v60
    v_exp_f32 v61, v61
    v_exp_f32 v62, v62
    v_exp_f32 v63, v63
    v_exp_f32 v64, v64
    v_exp_f32 v65, v65
    v_exp_f32 v66, v66
    v_exp_f32 v67, v67
    v_mfma_f32_32x32x16_bf16 v[100:115], v[32:35], v[96:99], v[100:115]
    v_cvt_pk_bf16_f32 v84, v52, v53
    v_cvt_pk_bf16_f32 v85, v54, v55
    v_cvt_pk_bf16_f32 v86, v56, v57
    v_cvt_pk_bf16_f32 v87, v58, v59
    v_cvt_pk_bf16_f32 v88, v60, v61
    v_cvt_pk_bf16_f32 v89, v62, v63
    v_cvt_pk_bf16_f32 v90, v64, v65
    v_cvt_pk_bf16_f32 v91, v66, v67
    s_waitcnt lgkmcnt(0)
    ds_read_b128 v[16:19], v3 offset:5120
    s_mov_b64 exec, s[60:61]
    ds_read_b128 v[28:31], v5 offset:3072
    ds_read_b128 v[32:35], v5 offset:3584
    s_mov_b64 exec, -1
    v_mfma_f32_32x32x16_bf16 v[52:67], v[12:15], v[8:11], 0
    v_exp_f32 v68, v68
    v_exp_f32 v69, v69
    v_exp_f32 v70, v70
    v_exp_f32 v71, v71
    v_exp_f32 v72, v72
    v_exp_f32 v73, v73
    v_exp_f32 v74, v74
    v_exp_f32 v75, v75
    v_mfma_f32_32x32x16_bf16 v[100:115], v[20:23], v[84:87], v[100:115]
    v_exp_f32 v76, v76
    v_exp_f32 v77, v77
    v_exp_f32 v78, v78
    v_exp_f32 v79, v79
    v_exp_f32 v80, v80
    v_exp_f32 v81, v81
    v_exp_f32 v82, v82
    v_exp_f32 v83, v83
    v_mfma_f32_32x32x16_bf16 v[100:115], v[24:27], v[88:91], v[100:115]
    v_cvt_pk_bf16_f32 v92, v68, v69
    v_cvt_pk_bf16_f32 v93, v70, v71
    v_cvt_pk_bf16_f32 v94, v72, v73
    v_cvt_pk_bf16_f32 v95, v74, v75
    v_cvt_pk_bf16_f32 v96, v76, v77
    v_cvt_pk_bf16_f32 v97, v78, v79
    v_cvt_pk_bf16_f32 v98, v80, v81
    v_cvt_pk_bf16_f32 v99, v82, v83
    s_waitcnt lgkmcnt(0)
    ds_read_b128 v[12:15], v3 offset:6144
    s_mov_b64 exec, s[60:61]
    ds_read_b128 v[20:23], v5 offset:4096
    ds_read_b128 v[24:27], v5 offset:4608
    s_mov_b64 exec, -1
    v_mfma_f32_32x32x16_bf16 v[68:83], v[16:19], v[8:11], 0
    v_exp_f32 v52, v52
    v_exp_f32 v53, v53
    v_exp_f32 v54, v54
    v_exp_f32 v55, v55
    v_exp_f32 v56, v56
    v_exp_f32 v57, v57
    v_exp_f32 v58, v58
    v_exp_f32 v59, v59
    v_mfma_f32_32x32x16_bf16 v[100:115], v[28:31], v[92:95], v[100:115]
    v_exp_f32 v60, v60
    v_exp_f32 v61, v61
    v_exp_f32 v62, v62
    v_exp_f32 v63, v63
    v_exp_f32 v64, v64
    v_exp_f32 v65, v65
    v_exp_f32 v66, v66
    v_exp_f32 v67, v67
    v_mfma_f32_32x32x16_bf16 v[100:115], v[32:35], v[96:99], v[100:115]
    v_cvt_pk_bf16_f32 v84, v52, v53
    v_cvt_pk_bf16_f32 v85, v54, v55
    v_cvt_pk_bf16_f32 v86, v56, v57
    v_cvt_pk_bf16_f32 v87, v58, v59
    v_cvt_pk_bf16_f32 v88, v60, v61
    v_cvt_pk_bf16_f32 v89, v62, v63
    v_cvt_pk_bf16_f32 v90, v64, v65
    v_cvt_pk_bf16_f32 v91, v66, v67
    s_waitcnt lgkmcnt(0)
    ds_read_b64 v[116:117], v7
    ds_read_b128 v[16:19], v3 offset:7168
    s_mov_b64 exec, s[60:61]
    ds_read_b128 v[28:31], v5 offset:5120
    ds_read_b128 v[32:35], v5 offset:5632
    s_mov_b64 exec, -1
    v_mfma_f32_32x32x16_bf16 v[52:67], v[12:15], v[8:11], 0
    v_exp_f32 v68, v68
    v_exp_f32 v69, v69
    v_exp_f32 v70, v70
    v_exp_f32 v71, v71
    v_exp_f32 v72, v72
    v_exp_f32 v73, v73
    v_exp_f32 v74, v74
    v_exp_f32 v75, v75
    v_mfma_f32_32x32x16_bf16 v[100:115], v[20:23], v[84:87], v[100:115]
    v_exp_f32 v76, v76
    v_exp_f32 v77, v77
    v_exp_f32 v78, v78
    v_exp_f32 v79, v79
    v_exp_f32 v80, v80
    v_exp_f32 v81, v81
    v_exp_f32 v82, v82
    v_exp_f32 v83, v83
    v_mfma_f32_32x32x16_bf16 v[100:115], v[24:27], v[88:91], v[100:115]
    v_cvt_pk_bf16_f32 v92, v68, v69
    v_cvt_pk_bf16_f32 v93, v70, v71
    v_cvt_pk_bf16_f32 v94, v72, v73
    v_cvt_pk_bf16_f32 v95, v74, v75
    v_cvt_pk_bf16_f32 v96, v76, v77
    v_cvt_pk_bf16_f32 v97, v78, v79
    v_cvt_pk_bf16_f32 v98, v80, v81
    v_cvt_pk_bf16_f32 v99, v82, v83
    s_waitcnt lgkmcnt(0)
k2_poll1:
    v_min_u32 v116, v116, v117
    s_nop 0
    v_readfirstlane_b32 s63, v116
    s_nop 0
    s_cmp_ge_u32 s63, 1
    s_cbranch_scc1 k2_go1
    s_sleep 1
    ds_read_b64 v[116:117], v7
    s_waitcnt lgkmcnt(0)
    s_nop 0
    s_branch k2_poll1
k2_go1:
    ds_read_b128 v[12:15], v3 offset:8192
    s_mov_b64 exec, s[60:61]
    ds_read_b128 v[20:23], v5 offset:6144
    ds_read_b128 v[24:27], v5 offset:6656
    s_mov_b64 exec, -1
    v_mfma_f32_32x32x16_bf16 v[68:83], v[16:19], v[8:11], 0
    v_exp_f32 v52, v52
    v_exp_f32 v53, v53
    v_exp_f32 v54, v54
    v_exp_f32 v55, v55
    v_exp_f32 v56, v56
    v_exp_f32 v57, v57
    v_exp_f32 v58, v58
    v_exp_f32 v59, v59
    v_mfma_f32_32x32x16_bf16 v[100:115], v[28:31], v[92:95], v[100:115]
    v_exp_f32 v60, v60
    v_exp_f32 v61, v61
    v_exp_f32 v62, v62
    v_exp_f32 v63, v63
    v_exp_f32 v64, v64
    v_exp_f32 v65, v65
    v_exp_f32 v66, v66
    v_exp_f32 v67, v67
    v_mfma_f32_32x32x16_bf16 v[100:115], v[32:35], v[96:99], v[100:115]
    v_cvt_pk_bf16_f32 v84, v52, v53
    v_cvt_pk_bf16_f32 v85, v54, v55
    v_cvt_pk_bf16_f32 v86, v56, v57
    v_cvt_pk_bf16_f32 v87, v58, v59
    v_cvt_pk_bf16_f32 v88, v60, v61
    v_cvt_pk_bf16_f32 v89, v62, v63
    v_cvt_pk_bf16_f32 v90, v64, v65
    v_cvt_pk_bf16_f32 v91, v66, v67
    s_waitcnt lgkmcnt(0)
    ds_read_b128 v[16:19], v3 offset:9216
    s_mov_b64 exec, s[60:61]
    ds_read_b128 v[28:31], v5 offset:7168
    ds_read_b128 v[32:35], v5 offset:7680
    s_mov_b64 exec, -1
    v_mfma_f32_32x32x16_bf16 v[52:67], v[12:15], v[8:11], 0
    v_exp_f32 v68, v68
    v_exp_f32 v69, v69
    v_exp_f32 v70, v70
    v_exp_f32 v71, v71
    v_exp_f32 v72, v72
    v_exp_f32 v73, v73
    v_exp_f32 v74, v74
    v_exp_f32 v75, v75
    v_mfma_f32_32x32x16_bf16 v[100:115], v[20:23], v[84:87], v[100:115]
    v_exp_f32 v76, v76
    v_exp_f32 v77, v77
    v_exp_f32 v78, v78
    v_exp_f32 v79, v79
    v_exp_f32 v80, v80
    v_exp_f32 v81, v81
    v_exp_f32 v82, v82
    v_exp_f32 v83, v83
    v_mfma_f32_32x32x16_bf16 v[100:115], v[24:27], v[88:91], v[100:115]
    v_cvt_pk_bf16_f32 v92, v68, v69
    v_cvt_pk_bf16_f32 v93, v70, v71
    v_cvt_pk_bf16_f32 v94, v72, v73
    v_cvt_pk_bf16_f32 v95, v74, v75
    v_cvt_pk_bf16_f32 v96, v76, v77
    v_cvt_pk_bf16_f32 v97, v78, v79
    v_cvt_pk_bf16_f32 v98, v80, v81
    v_cvt_pk_bf16_f32 v99, v82, v83
    s_waitcnt lgkmcnt(0)
    ds_read_b128 v[12:15], v3 offset:10240
    s_mov_b64 exec, s[60:61]
    ds_read_b128 v[20:23], v5 offset:8192
    ds_read_b128 v[24:27], v5 offset:8704
    s_mov_b64 exec, -1
    v_mfma_f32_32x32x16_bf16 v[68:83], v[16:19], v[8:11], 0
    v_exp_f32 v52, v52
    v_exp_f32 v53, v53
    v_exp_f32 v54, v54
    v_exp_f32 v55, v55
    v_exp_f32 v56, v56
    v_exp_f32 v57, v57
    v_exp_f32 v58, v58
    v_exp_f32 v59, v59
    v_mfma_f32_32x32x16_bf16 v[100:115], v[28:31], v[92:95], v[100:115]
    v_exp_f32 v60, v60
    v_exp_f32 v61, v61
    v_exp_f32 v62, v62
    v_exp_f32 v63, v63
    v_exp_f32 v64, v64
    v_exp_f32 v65, v65
    v_exp_f32 v66, v66
    v_exp_f32 v67, v67
    v_mfma_f32_32x32x16_bf16 v[100:115], v[32:35], v[96:99], v[100:115]
    v_cvt_pk_bf16_f32 v84, v52, v53
    v_cvt_pk_bf16_f32 v85, v54, v55
    v_cvt_pk_bf16_f32 v86, v56, v57
    v_cvt_pk_bf16_f32 v87, v58, v59
    v_cvt_pk_bf16_f32 v88, v60, v61
    v_cvt_pk_bf16_f32 v89, v62, v63
    v_cvt_pk_bf16_f32 v90, v64, v65
    v_cvt_pk_bf16_f32 v91, v66, v67
    s_waitcnt lgkmcnt(0)
    ds_read_b128 v[16:19], v3 offset:11264
    s_mov_b64 exec, s[60:61]
    ds_read_b128 v[28:31], v5 offset:9216
    ds_read_b128 v[32:35], v5 offset:9728
    s_mov_b64 exec, -1
    v_mfma_f32_32x32x16_bf16 v[52:67], v[12:15], v[8:11], 0
    v_exp_f32 v68, v68
    v_exp_f32 v69, v69
    v_exp_f32 v70, v70
    v_exp_f32 v71, v71
    v_exp_f32 v72, v72
    v_exp_f32 v73, v73
    v_exp_f32 v74, v74
    v_exp_f32 v75, v75
    v_mfma_f32_32x32x16_bf16 v[100:115], v[20:23], v[84:87], v[100:115]
    v_exp_f32 v76, v76
    v_exp_f32 v77, v77
    v_exp_f32 v78, v78
    v_exp_f32 v79, v79
    v_exp_f32 v80, v80
    v_exp_f32 v81, v81
    v_exp_f32 v82, v82
    v_exp_f32 v83, v83
    v_mfma_f32_32x32x16_bf16 v[100:115], v[24:27], v[88:91], v[100:115]
    v_cvt_pk_bf16_f32 v92, v68, v69
    v_cvt_pk_bf16_f32 v93, v70, v71
    v_cvt_pk_bf16_f32 v94, v72, v73
    v_cvt_pk_bf16_f32 v95, v74, v75
    v_cvt_pk_bf16_f32 v96, v76, v77
    v_cvt_pk_bf16_f32 v97, v78, v79
    v_cvt_pk_bf16_f32 v98, v80, v81
    v_cvt_pk_bf16_f32 v99, v82, v83
    s_waitcnt lgkmcnt(0)
    ds_read_b128 v[12:15], v3 offset:12288
    s_mov_b64 exec, s[60:61]
    ds_read_b128 v[20:23], v5 offset:10240
    ds_read_b128 v[24:27], v5 offset:10752
    s_mov_b64 exec, -1
    v_mfma_f32_32x32x16_bf16 v[68:83], v[16:19], v[8:11], 0
    v_exp_f32 v52, v52
    v_exp_f32 v53, v53
    v_exp_f32 v54, v54
    v_exp_f32 v55, v55
    v_exp_f32 v56, v56
    v_exp_f32 v57, v57
    v_exp_f32 v58, v58
    v_exp_f32 v59, v59
    v_mfma_f32_32x32x16_bf16 v[100:115], v[28:31], v[92:95], v[100:115]
    v_exp_f32 v60, v60
    v_exp_f32 v61, v61
    v_exp_f32 v62, v62
    v_exp_f32 v63, v63
    v_exp_f32 v64, v64
    v_exp_f32 v65, v65
    v_exp_f32 v66, v66
    v_exp_f32 v67, v67
    v_mfma_f32_32x32x16_bf16 v[100:115], v[32:35], v[96:99], v[100:115]
    v_cvt_pk_bf16_f32 v84, v52, v53
    v_cvt_pk_bf16_f32 v85, v54, v55
    v_cvt_pk_bf16_f32 v86, v56, v57
    v_cvt_pk_bf16_f32 v87, v58, v59
    v_cvt_pk_bf16_f32 v88, v60, v61
    v_cvt_pk_bf16_f32 v89, v62, v63
    v_cvt_pk_bf16_f32 v90, v64, v65
    v_cvt_pk_bf16_f32 v91, v66, v67
    s_waitcnt lgkmcnt(0)
    ds_read_b128 v[16:19], v3 offset:13312
    s_mov_b64 exec, s[60:61]
    ds_read_b128 v[28:31], v5 offset:11264
    ds_read_b128 v[32:35], v5 offset:11776
    s_mov_b64 exec, -1
    v_mfma_f32_32x32x16_bf16 v[52:67], v[12:15], v[8:11], 0
    v_exp_f32 v68, v68
    v_exp_f32 v69, v69
    v_exp_f32 v70, v70
    v_exp_f32 v71, v71
    v_exp_f32 v72, v72
    v_exp_f32 v73, v73
    v_exp_f32 v74, v74
    v_exp_f32 v75, v75
    v_mfma_f32_32x32x16_bf16 v[100:115], v[20:23], v[84:87], v[100:115]
    v_exp_f32 v76, v76
    v_exp_f32 v77, v77
    v_exp_f32 v78, v78
    v_exp_f32 v79, v79
    v_exp_f32 v80, v80
    v_exp_f32 v81, v81
    v_exp_f32 v82, v82
    v_exp_f32 v83, v83
    v_mfma_f32_32x32x16_bf16 v[100:115], v[24:27], v[88:91], v[100:115]
    v_cvt_pk_bf16_f32 v92, v68, v69
    v_cvt_pk_bf16_f32 v93, v70, v71
    v_cvt_pk_bf16_f32 v94, v72, v73
    v_cvt_pk_bf16_f32 v95, v74, v75
    v_cvt_pk_bf16_f32 v96, v76, v77
    v_cvt_pk_bf16_f32 v97, v78, v79
    v_cvt_pk_bf16_f32 v98, v80, v81
    v_cvt_pk_bf16_f32 v99, v82, v83
    s_waitcnt lgkmcnt(0)
    ds_read_b128 v[12:15], v3 offset:14336
    s_mov_b64 exec, s[60:61]
    ds_read_b128 v[20:23], v5 offset:12288
    ds_read_b128 v[24:27], v5 offset:12800
    s_mov_b64 exec, -1
    v_mfma_f32_32x32x16_bf16 v[68:83], v[16:19], v[8:11], 0
    v_exp_f32 v52, v52
    v_exp_f32 v53, v53
    v_exp_f32 v54, v54
    v_exp_f32 v55, v55
    v_exp_f32 v56, v56
    v_exp_f32 v57, v57
    v_exp_f32 v58, v58
    v_exp_f32 v59, v59
    v_mfma_f32_32x32x16_bf16 v[100:115], v[28:31], v[92:95], v[100:115]
    v_exp_f32 v60, v60
    v_exp_f32 v61, v61
    v_exp_f32 v62, v62
    v_exp_f32 v63, v63
    v_exp_f32 v64, v64
    v_exp_f32 v65, v65
    v_exp_f32 v66, v66
    v_exp_f32 v67, v67
    v_mfma_f32_32x32x16_bf16 v[100:115], v[32:35], v[96:99], v[100:115]
    v_cvt_pk_bf16_f32 v84, v52, v53
    v_cvt_pk_bf16_f32 v85, v54, v55
    v_cvt_pk_bf16_f32 v86, v56, v57
    v_cvt_pk_bf16_f32 v87, v58, v59
    v_cvt_pk_bf16_f32 v88, v60, v61
    v_cvt_pk_bf16_f32 v89, v62, v63
    v_cvt_pk_bf16_f32 v90, v64, v65
    v_cvt_pk_bf16_f32 v91, v66, v67
    s_waitcnt lgkmcnt(0)
    ds_read_b128 v[16:19], v3 offset:15360
    s_mov_b64 exec, s[60:61]
    ds_read_b128 v[28:31], v5 offset:13312
    ds_read_b128 v[32:35], v5 offset:13824
    s_mov_b64 exec, -1
    v_mfma_f32_32x32x16_bf16 v[52:67], v[12:15], v[8:11], 0
    v_exp_f32 v68, v68
    v_exp_f32 v69, v69
    v_exp_f32 v70, v70
    v_exp_f32 v71, v71
    v_exp_f32 v72, v72
    v_exp_f32 v73, v73
    v_exp_f32 v74, v74
    v_exp_f32 v75, v75
    v_mfma_f32_32x32x16_bf16 v[100:115], v[20:23], v[84:87], v[100:115]
    v_exp_f32 v76, v76
    v_exp_f32 v77, v77
    v_exp_f32 v78, v78
    v_exp_f32 v79, v79
    v_exp_f32 v80, v80
    v_exp_f32 v81, v81
    v_exp_f32 v82, v82
    v_exp_f32 v83, v83
    v_mfma_f32_32x32x16_bf16 v[100:115], v[24:27], v[88:91], v[100:115]
    v_cvt_pk_bf16_f32 v92, v68, v69
    v_cvt_pk_bf16_f32 v93, v70, v71
    v_cvt_pk_bf16_f32 v94, v72, v73
    v_cvt_pk_bf16_f32 v95, v74, v75
    v_cvt_pk_bf16_f32 v96, v76, v77
    v_cvt_pk_bf16_f32 v97, v78, v79
    v_cvt_pk_bf16_f32 v98, v80, v81
    v_cvt_pk_bf16_f32 v99, v82, v83
    s_waitcnt lgkmcnt(0)
    ds_read_b128 v[12:15], v3 offset:16384
    s_mov_b64 exec, s[60:61]
    ds_read_b128 v[20:23], v5 offset:14336
    ds_read_b128 v[24:27], v5 offset:14848
    s_mov_b64 exec, -1
    v_mfma_f32_32x32x16_bf16 v[68:83], v[16:19], v[8:11], 0
    v_exp_f32 v52, v52
    v_exp_f32 v53, v53
    v_exp_f32 v54, v54
    v_exp_f32 v55, v55
    v_exp_f32 v56, v56
    v_exp_f32 v57, v57
    v_exp_f32 v58, v58
    v_exp_f32 v59, v59
    v_mfma_f32_32x32x16_bf16 v[100:115], v[28:31], v[92:95], v[100:115]
    v_exp_f32 v60, v60
    v_exp_f32 v61, v61
    v_exp_f32 v62, v62
    v_exp_f32 v63, v63
    v_exp_f32 v64, v64
    v_exp_f32 v65, v65
    v_exp_f32 v66, v66
    v_exp_f32 v67, v67
    v_mfma_f32_32x32x16_bf16 v[100:115], v[32:35], v[96:99], v[100:115]
    v_cvt_pk_bf16_f32 v84, v52, v53
    v_cvt_pk_bf16_f32 v85, v54, v55
    v_cvt_pk_bf16_f32 v86, v56, v57
    v_cvt_pk_bf16_f32 v87, v58, v59
    v_cvt_pk_bf16_f32 v88, v60, v61
    v_cvt_pk_bf16_f32 v89, v62, v63
    v_cvt_pk_bf16_f32 v90, v64, v65
    v_cvt_pk_bf16_f32 v91, v66, v67
    s_waitcnt lgkmcnt(0)
    ds_read_b128 v[16:19], v3 offset:17408
    s_mov_b64 exec, s[60:61]
    ds_read_b128 v[28:31], v5 offset:15360
    ds_read_b128 v[32:35], v5 offset:15872
    s_mov_b64 exec, -1
    v_mfma_f32_32x32x16_bf16 v[52:67], v[12:15], v[8:11], 0
    v_exp_f32 v68, v68
    v_exp_f32 v69, v69
    v_exp_f32 v70, v70
    v_exp_f32 v71, v71
    v_exp_f32 v72, v72
    v_exp_f32 v73, v73
    v_exp_f32 v74, v74
    v_exp_f32 v75, v75
    v_mfma_f32_32x32x16_bf16 v[100:115], v[20:23], v[84:87], v[100:115]
    v_exp_f32 v76, v76
    v_exp_f32 v77, v77
    v_exp_f32 v78, v78
    v_exp_f32 v79, v79
    v_exp_f32 v80, v80
    v_exp_f32 v81, v81
    v_exp_f32 v82, v82
    v_exp_f32 v83, v83
    v_mfma_f32_32x32x16_bf16 v[100:115], v[24:27], v[88:91], v[100:115]
    v_cvt_pk_bf16_f32 v92, v68, v69
    v_cvt_pk_bf16_f32 v93, v70, v71
    v_cvt_pk_bf16_f32 v94, v72, v73
    v_cvt_pk_bf16_f32 v95, v74, v75
    v_cvt_pk_bf16_f32 v96, v76, v77
    v_cvt_pk_bf16_f32 v97, v78, v79
    v_cvt_pk_bf16_f32 v98, v80, v81
    v_cvt_pk_bf16_f32 v99, v82, v83
    s_waitcnt lgkmcnt(0)
    ds_read_b128 v[12:15], v3 offset:18432
    s_mov_b64 exec, s[60:61]
    ds_read_b128 v[20:23], v5 offset:16384
    ds_read_b128 v[24:27], v5 offset:16896
    s_mov_b64 exec, -1
    v_mfma_f32_32x32x16_bf16 v[68:83], v[16:19], v[8:11], 0
    v_exp_f32 v52, v52
    v_exp_f32 v53, v53
    v_exp_f32 v54, v54
    v_exp_f32 v55, v55
    v_exp_f32 v56, v56
    v_exp_f32 v57, v57
    v_exp_f32 v58, v58
    v_exp_f32 v59, v59
    v_mfma_f32_32x32x16_bf16 v[100:115], v[28:31], v[92:95], v[100:115]
    v_exp_f32 v60, v60
    v_exp_f32 v61, v61
    v_exp_f32 v62, v62
    v_exp_f32 v63, v63
    v_exp_f32 v64, v64
    v_exp_f32 v65, v65
    v_exp_f32 v66, v66
    v_exp_f32 v67, v67
    v_mfma_f32_32x32x16_bf16 v[100:115], v[32:35], v[96:99], v[100:115]
    v_cvt_pk_bf16_f32 v84, v52, v53
    v_cvt_pk_bf16_f32 v85, v54, v55
    v_cvt_pk_bf16_f32 v86, v56, v57
    v_cvt_pk_bf16_f32 v87, v58, v59
    v_cvt_pk_bf16_f32 v88, v60, v61
    v_cvt_pk_bf16_f32 v89, v62, v63
    v_cvt_pk_bf16_f32 v90, v64, v65
    v_cvt_pk_bf16_f32 v91, v66, v67
    s_waitcnt lgkmcnt(0)
    ds_read_b128 v[16:19], v3 offset:19456
    s_mov_b64 exec, s[60:61]
    ds_read_b128 v[28:31], v5 offset:17408
    ds_read_b128 v[32:35], v5 offset:17920
    s_mov_b64 exec, -1
    v_mfma_f32_32x32x16_bf16 v[52:67], v[12:15], v[8:11], 0
    v_exp_f32 v68, v68
    v_exp_f32 v69, v69
    v_exp_f32 v70, v70
    v_exp_f32 v71, v71
    v_exp_f32 v72, v72
    v_exp_f32 v73, v73
    v_exp_f32 v74, v74
    v_exp_f32 v75, v75
    v_mfma_f32_32x32x16_bf16 v[100:115], v[20:23], v[84:87], v[100:115]
    v_exp_f32 v76, v76
    v_exp_f32 v77, v77
    v_exp_f32 v78, v78
    v_exp_f32 v79, v79
    v_exp_f32 v80, v80
    v_exp_f32 v81, v81
    v_exp_f32 v82, v82
    v_exp_f32 v83, v83
    v_mfma_f32_32x32x16_bf16 v[100:115], v[24:27], v[88:91], v[100:115]
    v_cvt_pk_bf16_f32 v92, v68, v69
    v_cvt_pk_bf16_f32 v93, v70, v71
    v_cvt_pk_bf16_f32 v94, v72, v73
    v_cvt_pk_bf16_f32 v95, v74, v75
    v_cvt_pk_bf16_f32 v96, v76, v77
    v_cvt_pk_bf16_f32 v97, v78, v79
    v_cvt_pk_bf16_f32 v98, v80, v81
    v_cvt_pk_bf16_f32 v99, v82, v83
    s_waitcnt lgkmcnt(0)
    ds_read_b128 v[12:15], v3 offset:20480
    s_mov_b64 exec, s[60:61]
    ds_read_b128 v[20:23], v5 offset:18432
    ds_read_b128 v[24:27], v5 offset:18944
    s_mov_b64 exec, -1
    v_mfma_f32_32x32x16_bf16 v[68:83], v[16:19], v[8:11], 0
    v_exp_f32 v52, v52
    v_exp_f32 v53, v53
    v_exp_f32 v54, v54
    v_exp_f32 v55, v55
    v_exp_f32 v56, v56
    v_exp_f32 v57, v57
    v_exp_f32 v58, v58
    v_exp_f32 v59, v59
    v_mfma_f32_32x32x16_bf16 v[100:115], v[28:31], v[92:95], v[100:115]
    v_exp_f32 v60, v60
    v_exp_f32 v61, v61
    v_exp_f32 v62, v62
    v_exp_f32 v63, v63
    v_exp_f32 v64, v64
    v_exp_f32 v65, v65
    v_exp_f32 v66, v66
    v_exp_f32 v67, v67
    v_mfma_f32_32x32x16_bf16 v[100:115], v[32:35], v[96:99], v[100:115]
    v_cvt_pk_bf16_f32 v84, v52, v53
    v_cvt_pk_bf16_f32 v85, v54, v55
    v_cvt_pk_bf16_f32 v86, v56, v57
    v_cvt_pk_bf16_f32 v87, v58, v59
    v_cvt_pk_bf16_f32 v88, v60, v61
    v_cvt_pk_bf16_f32 v89, v62, v63
    v_cvt_pk_bf16_f32 v90, v64, v65
    v_cvt_pk_bf16_f32 v91, v66, v67
    s_waitcnt lgkmcnt(0)
    ds_read_b128 v[16:19], v3 offset:21504
    s_mov_b64 exec, s[60:61]
    ds_read_b128 v[28:31], v5 offset:19456
    ds_read_b128 v[32:35], v5 offset:19968
    s_mov_b64 exec, -1
    v_mfma_f32_32x32x16_bf16 v[52:67], v[12:15], v[8:11], 0
    v_exp_f32 v68, v68
    v_exp_f32 v69, v69
    v_exp_f32 v70, v70
    v_exp_f32 v71, v71
    v_exp_f32 v72, v72
    v_exp_f32 v73, v73
    v_exp_f32 v74, v74
    v_exp_f32 v75, v75
    v_mfma_f32_32x32x16_bf16 v[100:115], v[20:23], v[84:87], v[100:115]
    v_exp_f32 v76, v76
    v_exp_f32 v77, v77
    v_exp_f32 v78, v78
    v_exp_f32 v79, v79
    v_exp_f32 v80, v80
    v_exp_f32 v81, v81
    v_exp_f32 v82, v82
    v_exp_f32 v83, v83
    v_mfma_f32_32x32x16_bf16 v[100:115], v[24:27], v[88:91], v[100:115]
    v_cvt_pk_bf16_f32 v92, v68, v69
    v_cvt_pk_bf16_f32 v93, v70, v71
    v_cvt_pk_bf16_f32 v94, v72, v73
    v_cvt_pk_bf16_f32 v95, v74, v75
    v_cvt_pk_bf16_f32 v96, v76, v77
    v_cvt_pk_bf16_f32 v97, v78, v79
    v_cvt_pk_bf16_f32 v98, v80, v81
    v_cvt_pk_bf16_f32 v99, v82, v83
    s_waitcnt lgkmcnt(0)
    ds_read_b128 v[12:15], v3 offset:22528
    s_mov_b64 exec, s[60:61]
    ds_read_b128 v[20:23], v5 offset:20480
    ds_read_b128 v[24:27], v5 offset:20992
    s_mov_b64 exec, -1
    v_mfma_f32_32x32x16_bf16 v[68:83], v[16:19], v[8:11], 0
    v_exp_f32 v52, v52
    v_exp_f32 v53, v53
    v_exp_f32 v54, v54
    v_exp_f32 v55, v55
    v_exp_f32 v56, v56
    v_exp_f32 v57, v57
    v_exp_f32 v58, v58
    v_exp_f32 v59, v59
    v_mfma_f32_32x32x16_bf16 v[100:115], v[28:31], v[92:95], v[100:115]
    v_exp_f32 v60, v60
    v_exp_f32 v61, v61
    v_exp_f32 v62, v62
    v_exp_f32 v63, v63
    v_exp_f32 v64, v64
    v_exp_f32 v65, v65
    v_exp_f32 v66, v66
    v_exp_f32 v67, v67
    v_mfma_f32_32x32x16_bf16 v[100:115], v[32:35], v[96:99], v[100:115]
    v_cvt_pk_bf16_f32 v84, v52, v53
    v_cvt_pk_bf16_f32 v85, v54, v55
    v_cvt_pk_bf16_f32 v86, v56, v57
    v_cvt_pk_bf16_f32 v87, v58, v59
    v_cvt_pk_bf16_f32 v88, v60, v61
    v_cvt_pk_bf16_f32 v89, v62, v63
    v_cvt_pk_bf16_f32 v90, v64, v65
    v_cvt_pk_bf16_f32 v91, v66, v67
    s_waitcnt lgkmcnt(0)
    ds_read_b64 v[116:117], v7
    ds_read_b128 v[16:19], v3 offset:23552
    s_mov_b64 exec, s[60:61]
    ds_read_b128 v[28:31], v5 offset:21504
    ds_read_b128 v[32:35], v5 offset:22016
    s_mov_b64 exec, -1
    v_mfma_f32_32x32x16_bf16 v[52:67], v[12:15], v[8:11], 0
    v_exp_f32 v68, v68
    v_exp_f32 v69, v69
    v_exp_f32 v70, v70
    v_exp_f32 v71, v71
    v_exp_f32 v72, v72
    v_exp_f32 v73, v73
    v_exp_f32 v74, v74
    v_exp_f32 v75, v75
    v_mfma_f32_32x32x16_bf16 v[100:115], v[20:23], v[84:87], v[100:115]
    v_exp_f32 v76, v76
    v_exp_f32 v77, v77
    v_exp_f32 v78, v78
    v_exp_f32 v79, v79
    v_exp_f32 v80, v80
    v_exp_f32 v81, v81
    v_exp_f32 v82, v82
    v_exp_f32 v83, v83
    v_mfma_f32_32x32x16_bf16 v[100:115], v[24:27], v[88:91], v[100:115]
    v_cvt_pk_bf16_f32 v92, v68, v69
    v_cvt_pk_bf16_f32 v93, v70, v71
    v_cvt_pk_bf16_f32 v94, v72, v73
    v_cvt_pk_bf16_f32 v95, v74, v75
    v_cvt_pk_bf16_f32 v96, v76, v77
    v_cvt_pk_bf16_f32 v97, v78, v79
    v_cvt_pk_bf16_f32 v98, v80, v81
    v_cvt_pk_bf16_f32 v99, v82, v83
    s_waitcnt lgkmcnt(0)
k2_poll2:
    v_min_u32 v116, v116, v117
    s_nop 0
    v_readfirstlane_b32 s63, v116
    s_nop 0
    s_cmp_ge_u32 s63, 2
    s_cbranch_scc1 k2_go2
    s_sleep 1
    ds_read_b64 v[116:117], v7
    s_waitcnt lgkmcnt(0)
    s_nop 0
    s_branch k2_poll2
k2_go2:
    ds_read_b128 v[12:15], v3 offset:24576
    s_mov_b64 exec, s[60:61]
    ds_read_b128 v[20:23], v5 offset:22528
    ds_read_b128 v[24:27], v5 offset:23040
    s_mov_b64 exec, -1
    v_mfma_f32_32x32x16_bf16 v[68:83], v[16:19], v[8:11], 0
    v_exp_f32 v52, v52
    v_exp_f32 v53, v53
    v_exp_f32 v54, v54
    v_exp_f32 v55, v55
    v_exp_f32 v56, v56
    v_exp_f32 v57, v57
    v_exp_f32 v58, v58
    v_exp_f32 v59, v59
    v_mfma_f32_32x32x16_bf16 v[100:115], v[28:31], v[92:95], v[100:115]
    v_exp_f32 v60, v60
    v_exp_f32 v61, v61
    v_exp_f32 v62, v62
    v_exp_f32 v63, v63
    v_exp_f32 v64, v64
    v_exp_f32 v65, v65
    v_exp_f32 v66, v66
    v_exp_f32 v67, v67
    v_mfma_f32_32x32x16_bf16 v[100:115], v[32:35], v[96:99], v[100:115]
    v_cvt_pk_bf16_f32 v84, v52, v53
    v_cvt_pk_bf16_f32 v85, v54, v55
    v_cvt_pk_bf16_f32 v86, v56, v57
    v_cvt_pk_bf16_f32 v87, v58, v59
    v_cvt_pk_bf16_f32 v88, v60, v61
    v_cvt_pk_bf16_f32 v89, v62, v63
    v_cvt_pk_bf16_f32 v90, v64, v65
    v_cvt_pk_bf16_f32 v91, v66, v67
    s_waitcnt lgkmcnt(0)
    ds_read_b128 v[16:19], v3 offset:25600
    s_mov_b64 exec, s[60:61]
    ds_read_b128 v[28:31], v5 offset:23552
    ds_read_b128 v[32:35], v5 offset:24064
    s_mov_b64 exec, -1
    v_mfma_f32_32x32x16_bf16 v[52:67], v[12:15], v[8:11], 0
    v_exp_f32 v68, v68
    v_exp_f32 v69, v69
    v_exp_f32 v70, v70
    v_exp_f32 v71, v71
    v_exp_f32 v72, v72
    v_exp_f32 v73, v73
    v_exp_f32 v74, v74
    v_exp_f32 v75, v75
    v_mfma_f32_32x32x16_bf16 v[100:115], v[20:23], v[84:87], v[100:115]
    v_exp_f32 v76, v76
    v_exp_f32 v77, v77
    v_exp_f32 v78, v78
    v_exp_f32 v79, v79
    v_exp_f32 v80, v80
    v_exp_f32 v81, v81
    v_exp_f32 v82, v82
    v_exp_f32 v83, v83
    v_mfma_f32_32x32x16_bf16 v[100:115], v[24:27], v[88:91], v[100:115]
    v_cvt_pk_bf16_f32 v92, v68, v69
    v_cvt_pk_bf16_f32 v93, v70, v71
    v_cvt_pk_bf16_f32 v94, v72, v73
    v_cvt_pk_bf16_f32 v95, v74, v75
    v_cvt_pk_bf16_f32 v96, v76, v77
    v_cvt_pk_bf16_f32 v97, v78, v79
    v_cvt_pk_bf16_f32 v98, v80, v81
    v_cvt_pk_bf16_f32 v99, v82, v83
    s_waitcnt lgkmcnt(0)
    ds_read_b128 v[12:15], v3 offset:26624
    s_mov_b64 exec, s[60:61]
    ds_read_b128 v[20:23], v5 offset:24576
    ds_read_b128 v[24:27], v5 offset:25088
    s_mov_b64 exec, -1
    v_mfma_f32_32x32x16_bf16 v[68:83], v[16:19], v[8:11], 0
    v_exp_f32 v52, v52
    v_exp_f32 v53, v53
    v_exp_f32 v54, v54
    v_exp_f32 v55, v55
    v_exp_f32 v56, v56
    v_exp_f32 v57, v57
    v_exp_f32 v58, v58
    v_exp_f32 v59, v59
    v_mfma_f32_32x32x16_bf16 v[100:115], v[28:31], v[92:95], v[100:115]
    v_exp_f32 v60, v60
    v_exp_f32 v61, v61
    v_exp_f32 v62, v62
    v_exp_f32 v63, v63
    v_exp_f32 v64, v64
    v_exp_f32 v65, v65
    v_exp_f32 v66, v66
    v_exp_f32 v67, v67
    v_mfma_f32_32x32x16_bf16 v[100:115], v[32:35], v[96:99], v[100:115]
    v_cvt_pk_bf16_f32 v84, v52, v53
    v_cvt_pk_bf16_f32 v85, v54, v55
    v_cvt_pk_bf16_f32 v86, v56, v57
    v_cvt_pk_bf16_f32 v87, v58, v59
    v_cvt_pk_bf16_f32 v88, v60, v61
    v_cvt_pk_bf16_f32 v89, v62, v63
    v_cvt_pk_bf16_f32 v90, v64, v65
    v_cvt_pk_bf16_f32 v91, v66, v67
    s_waitcnt lgkmcnt(0)
    ds_read_b128 v[16:19], v3 offset:27648
    s_mov_b64 exec, s[60:61]
    ds_read_b128 v[28:31], v5 offset:25600
    ds_read_b128 v[32:35], v5 offset:26112
    s_mov_b64 exec, -1
    v_mfma_f32_32x32x16_bf16 v[52:67], v[12:15], v[8:11], 0
    v_exp_f32 v68, v68
    v_exp_f32 v69, v69
    v_exp_f32 v70, v70
    v_exp_f32 v71, v71
    v_exp_f32 v72, v72
    v_exp_f32 v73, v73
    v_exp_f32 v74, v74
    v_exp_f32 v75, v75
    v_mfma_f32_32x32x16_bf16 v[100:115], v[20:23], v[84:87], v[100:115]
    v_exp_f32 v76, v76
    v_exp_f32 v77, v77
    v_exp_f32 v78, v78
    v_exp_f32 v79, v79
    v_exp_f32 v80, v80
    v_exp_f32 v81, v81
    v_exp_f32 v82, v82
    v_exp_f32 v83, v83
    v_mfma_f32_32x32x16_bf16 v[100:115], v[24:27], v[88:91], v[100:115]
    v_cvt_pk_bf16_f32 v92, v68, v69
    v_cvt_pk_bf16_f32 v93, v70, v71
    v_cvt_pk_bf16_f32 v94, v72, v73
    v_cvt_pk_bf16_f32 v95, v74, v75
    v_cvt_pk_bf16_f32 v96, v76, v77
    v_cvt_pk_bf16_f32 v97, v78, v79
    v_cvt_pk_bf16_f32 v98, v80, v81
    v_cvt_pk_bf16_f32 v99, v82, v83
    s_waitcnt lgkmcnt(0)
    ds_read_b128 v[12:15], v3 offset:28672
    s_mov_b64 exec, s[60:61]
    ds_read_b128 v[20:23], v5 offset:26624
    ds_read_b128 v[24:27], v5 offset:27136
    s_mov_b64 exec, -1
    v_mfma_f32_32x32x16_bf16 v[68:83], v[16:19], v[8:11], 0
    v_exp_f32 v52, v52
    v_exp_f32 v53, v53
    v_exp_f32 v54, v54
    v_exp_f32 v55, v55
    v_exp_f32 v56, v56
    v_exp_f32 v57, v57
    v_exp_f32 v58, v58
    v_exp_f32 v59, v59
    v_mfma_f32_32x32x16_bf16 v[100:115], v[28:31], v[92:95], v[100:115]
    v_exp_f32 v60, v60
    v_exp_f32 v61, v61
    v_exp_f32 v62, v62
    v_exp_f32 v63, v63
    v_exp_f32 v64, v64
    v_exp_f32 v65, v65
    v_exp_f32 v66, v66
    v_exp_f32 v67, v67
    v_mfma_f32_32x32x16_bf16 v[100:115], v[32:35], v[96:99], v[100:115]
    v_cvt_pk_bf16_f32 v84, v52, v53
    v_cvt_pk_bf16_f32 v85, v54, v55
    v_cvt_pk_bf16_f32 v86, v56, v57
    v_cvt_pk_bf16_f32 v87, v58, v59
    v_cvt_pk_bf16_f32 v88, v60, v61
    v_cvt_pk_bf16_f32 v89, v62, v63
    v_cvt_pk_bf16_f32 v90, v64, v65
    v_cvt_pk_bf16_f32 v91, v66, v67
    s_waitcnt lgkmcnt(0)
    ds_read_b128 v[16:19], v3 offset:29696
    s_mov_b64 exec, s[60:61]
    ds_read_b128 v[28:31], v5 offset:27648
    ds_read_b128 v[32:35], v5 offset:28160
    s_mov_b64 exec, -1
    v_mfma_f32_32x32x16_bf16 v[52:67], v[12:15], v[8:11], 0
    v_exp_f32 v68, v68
    v_exp_f32 v69, v69
    v_exp_f32 v70, v70
    v_exp_f32 v71, v71
    v_exp_f32 v72, v72
    v_exp_f32 v73, v73
    v_exp_f32 v74, v74
    v_exp_f32 v75, v75
    v_mfma_f32_32x32x16_bf16 v[100:115], v[20:23], v[84:87], v[100:115]
    v_exp_f32 v76, v76
    v_exp_f32 v77, v77
    v_exp_f32 v78, v78
    v_exp_f32 v79, v79
    v_exp_f32 v80, v80
    v_exp_f32 v81, v81
    v_exp_f32 v82, v82
    v_exp_f32 v83, v83
    v_mfma_f32_32x32x16_bf16 v[100:115], v[24:27], v[88:91], v[100:115]
    v_cvt_pk_bf16_f32 v92, v68, v69
    v_cvt_pk_bf16_f32 v93, v70, v71
    v_cvt_pk_bf16_f32 v94, v72, v73
    v_cvt_pk_bf16_f32 v95, v74, v75
    v_cvt_pk_bf16_f32 v96, v76, v77
    v_cvt_pk_bf16_f32 v97, v78, v79
    v_cvt_pk_bf16_f32 v98, v80, v81
    v_cvt_pk_bf16_f32 v99, v82, v83
    s_waitcnt lgkmcnt(0)
    ds_read_b128 v[12:15], v3 offset:30720
    s_mov_b64 exec, s[60:61]
    ds_read_b128 v[20:23], v5 offset:28672
    ds_read_b128 v[24:27], v5 offset:29184
    s_mov_b64 exec, -1
    v_mfma_f32_32x32x16_bf16 v[68:83], v[16:19], v[8:11], 0
    v_exp_f32 v52, v52
    v_exp_f32 v53, v53
    v_exp_f32 v54, v54
    v_exp_f32 v55, v55
    v_exp_f32 v56, v56
    v_exp_f32 v57, v57
    v_exp_f32 v58, v58
    v_exp_f32 v59, v59
    v_mfma_f32_32x32x16_bf16 v[100:115], v[28:31], v[92:95], v[100:115]
    v_exp_f32 v60, v60
    v_exp_f32 v61, v61
    v_exp_f32 v62, v62
    v_exp_f32 v63, v63
    v_exp_f32 v64, v64
    v_exp_f32 v65, v65
    v_exp_f32 v66, v66
    v_exp_f32 v67, v67
    v_mfma_f32_32x32x16_bf16 v[100:115], v[32:35], v[96:99], v[100:115]
    v_cvt_pk_bf16_f32 v84, v52, v53
    v_cvt_pk_bf16_f32 v85, v54, v55
    v_cvt_pk_bf16_f32 v86, v56, v57
    v_cvt_pk_bf16_f32 v87, v58, v59
    v_cvt_pk_bf16_f32 v88, v60, v61
    v_cvt_pk_bf16_f32 v89, v62, v63
    v_cvt_pk_bf16_f32 v90, v64, v65
    v_cvt_pk_bf16_f32 v91, v66, v67
    s_waitcnt lgkmcnt(0)
    ds_read_b128 v[16:19], v3 offset:31744
    s_mov_b64 exec, s[60:61]
    ds_read_b128 v[28:31], v5 offset:29696
    ds_read_b128 v[32:35], v5 offset:30208
    s_mov_b64 exec, -1
    v_mfma_f32_32x32x16_bf16 v[52:67], v[12:15], v[8:11], 0
    v_exp_f32 v68, v68
    v_exp_f32 v69, v69
    v_exp_f32 v70, v70
    v_exp_f32 v71, v71
    v_exp_f32 v72, v72
    v_exp_f32 v73, v73
    v_exp_f32 v74, v74
    v_exp_f32 v75, v75
    v_mfma_f32_32x32x16_bf16 v[100:115], v[20:23], v[84:87], v[100:115]
    v_exp_f32 v76, v76
    v_exp_f32 v77, v77
    v_exp_f32 v78, v78
    v_exp_f32 v79, v79
    v_exp_f32 v80, v80
    v_exp_f32 v81, v81
    v_exp_f32 v82, v82
    v_exp_f32 v83, v83
    v_mfma_f32_32x32x16_bf16 v[100:115], v[24:27], v[88:91], v[100:115]
    v_cvt_pk_bf16_f32 v92, v68, v69
    v_cvt_pk_bf16_f32 v93, v70, v71
    v_cvt_pk_bf16_f32 v94, v72, v73
    v_cvt_pk_bf16_f32 v95, v74, v75
    v_cvt_pk_bf16_f32 v96, v76, v77
    v_cvt_pk_bf16_f32 v97, v78, v79
    v_cvt_pk_bf16_f32 v98, v80, v81
    v_cvt_pk_bf16_f32 v99, v82, v83
    s_waitcnt lgkmcnt(0)
    ds_read_b128 v[12:15], v3 offset:32768
    s_mov_b64 exec, s[60:61]
    ds_read_b128 v[20:23], v5 offset:30720
    ds_read_b128 v[24:27], v5 offset:31232
    s_mov_b64 exec, -1
    v_mfma_f32_32x32x16_bf16 v[68:83], v[16:19], v[8:11], 0
    v_exp_f32 v52, v52
    v_exp_f32 v53, v53
    v_exp_f32 v54, v54
    v_exp_f32 v55, v55
    v_exp_f32 v56, v56
    v_exp_f32 v57, v57
    v_exp_f32 v58, v58
    v_exp_f32 v59, v59
    v_mfma_f32_32x32x16_bf16 v[100:115], v[28:31], v[92:95], v[100:115]
    v_exp_f32 v60, v60
    v_exp_f32 v61, v61
    v_exp_f32 v62, v62
    v_exp_f32 v63, v63
    v_exp_f32 v64, v64
    v_exp_f32 v65, v65
    v_exp_f32 v66, v66
    v_exp_f32 v67, v67
    v_mfma_f32_32x32x16_bf16 v[100:115], v[32:35], v[96:99], v[100:115]
    v_cvt_pk_bf16_f32 v84, v52, v53
    v_cvt_pk_bf16_f32 v85, v54, v55
    v_cvt_pk_bf16_f32 v86, v56, v57
    v_cvt_pk_bf16_f32 v87, v58, v59
    v_cvt_pk_bf16_f32 v88, v60, v61
    v_cvt_pk_bf16_f32 v89, v62, v63
    v_cvt_pk_bf16_f32 v90, v64, v65
    v_cvt_pk_bf16_f32 v91, v66, v67
    s_waitcnt lgkmcnt(0)
    ds_read_b128 v[16:19], v3 offset:33792
    s_mov_b64 exec, s[60:61]
    ds_read_b128 v[28:31], v5 offset:31744
    ds_read_b128 v[32:35], v5 offset:32256
    s_mov_b64 exec, -1
    v_mfma_f32_32x32x16_bf16 v[52:67], v[12:15], v[8:11], 0
    v_exp_f32 v68, v68
    v_exp_f32 v69, v69
    v_exp_f32 v70, v70
    v_exp_f32 v71, v71
    v_exp_f32 v72, v72
    v_exp_f32 v73, v73
    v_exp_f32 v74, v74
    v_exp_f32 v75, v75
    v_mfma_f32_32x32x16_bf16 v[100:115], v[20:23], v[84:87], v[100:115]
    v_exp_f32 v76, v76
    v_exp_f32 v77, v77
    v_exp_f32 v78, v78
    v_exp_f32 v79, v79
    v_exp_f32 v80, v80
    v_exp_f32 v81, v81
    v_exp_f32 v82, v82
    v_exp_f32 v83, v83
    v_mfma_f32_32x32x16_bf16 v[100:115], v[24:27], v[88:91], v[100:115]
    v_cvt_pk_bf16_f32 v92, v68, v69
    v_cvt_pk_bf16_f32 v93, v70, v71
    v_cvt_pk_bf16_f32 v94, v72, v73
    v_cvt_pk_bf16_f32 v95, v74, v75
    v_cvt_pk_bf16_f32 v96, v76, v77
    v_cvt_pk_bf16_f32 v97, v78, v79
    v_cvt_pk_bf16_f32 v98, v80, v81
    v_cvt_pk_bf16_f32 v99, v82, v83
    s_waitcnt lgkmcnt(0)
    ds_read_b128 v[12:15], v3 offset:34816
    s_mov_b64 exec, s[60:61]
    ds_read_b128 v[20:23], v5 offset:32768
    ds_read_b128 v[24:27], v5 offset:33280
    s_mov_b64 exec, -1
    v_mfma_f32_32x32x16_bf16 v[68:83], v[16:19], v[8:11], 0
    v_exp_f32 v52, v52
    v_exp_f32 v53, v53
    v_exp_f32 v54, v54
    v_exp_f32 v55, v55
    v_exp_f32 v56, v56
    v_exp_f32 v57, v57
    v_exp_f32 v58, v58
    v_exp_f32 v59, v59
    v_mfma_f32_32x32x16_bf16 v[100:115], v[28:31], v[92:95], v[100:115]
    v_exp_f32 v60, v60
    v_exp_f32 v61, v61
    v_exp_f32 v62, v62
    v_exp_f32 v63, v63
    v_exp_f32 v64, v64
    v_exp_f32 v65, v65
    v_exp_f32 v66, v66
    v_exp_f32 v67, v67
    v_mfma_f32_32x32x16_bf16 v[100:115], v[32:35], v[96:99], v[100:115]
    v_cvt_pk_bf16_f32 v84, v52, v53
    v_cvt_pk_bf16_f32 v85, v54, v55
    v_cvt_pk_bf16_f32 v86, v56, v57
    v_cvt_pk_bf16_f32 v87, v58, v59
    v_cvt_pk_bf16_f32 v88, v60, v61
    v_cvt_pk_bf16_f32 v89, v62, v63
    v_cvt_pk_bf16_f32 v90, v64, v65
    v_cvt_pk_bf16_f32 v91, v66, v67
    s_waitcnt lgkmcnt(0)
    ds_read_b128 v[16:19], v3 offset:35840
    s_mov_b64 exec, s[60:61]
    ds_read_b128 v[28:31], v5 offset:33792
    ds_read_b128 v[32:35], v5 offset:34304
    s_mov_b64 exec, -1
    v_mfma_f32_32x32x16_bf16 v[52:67], v[12:15], v[8:11], 0
    v_exp_f32 v68, v68
    v_exp_f32 v69, v69
    v_exp_f32 v70, v70
    v_exp_f32 v71, v71
    v_exp_f32 v72, v72
    v_exp_f32 v73, v73
    v_exp_f32 v74, v74
    v_exp_f32 v75, v75
    v_mfma_f32_32x32x16_bf16 v[100:115], v[20:23], v[84:87], v[100:115]
    v_exp_f32 v76, v76
    v_exp_f32 v77, v77
    v_exp_f32 v78, v78
    v_exp_f32 v79, v79
    v_exp_f32 v80, v80
    v_exp_f32 v81, v81
    v_exp_f32 v82, v82
    v_exp_f32 v83, v83
    v_mfma_f32_32x32x16_bf16 v[100:115], v[24:27], v[88:91], v[100:115]
    v_cvt_pk_bf16_f32 v92, v68, v69
    v_cvt_pk_bf16_f32 v93, v70, v71
    v_cvt_pk_bf16_f32 v94, v72, v73
    v_cvt_pk_bf16_f32 v95, v74, v75
    v_cvt_pk_bf16_f32 v96, v76, v77
    v_cvt_pk_bf16_f32 v97, v78, v79
    v_cvt_pk_bf16_f32 v98, v80, v81
    v_cvt_pk_bf16_f32 v99, v82, v83
    s_waitcnt lgkmcnt(0)
    ds_read_b128 v[12:15], v3 offset:36864
    s_mov_b64 exec, s[60:61]
    ds_read_b128 v[20:23], v5 offset:34816
    ds_read_b128 v[24:27], v5 offset:35328
    s_mov_b64 exec, -1
    v_mfma_f32_32x32x16_bf16 v[68:83], v[16:19], v[8:11], 0
    v_exp_f32 v52, v52
    v_exp_f32 v53, v53
    v_exp_f32 v54, v54
    v_exp_f32 v55, v55
    v_exp_f32 v56, v56
    v_exp_f32 v57, v57
    v_exp_f32 v58, v58
    v_exp_f32 v59, v59
    v_mfma_f32_32x32x16_bf16 v[100:115], v[28:31], v[92:95], v[100:115]
    v_exp_f32 v60, v60
    v_exp_f32 v61, v61
    v_exp_f32 v62, v62
    v_exp_f32 v63, v63
    v_exp_f32 v64, v64
    v_exp_f32 v65, v65
    v_exp_f32 v66, v66
    v_exp_f32 v67, v67
    v_mfma_f32_32x32x16_bf16 v[100:115], v[32:35], v[96:99], v[100:115]
    v_cvt_pk_bf16_f32 v84, v52, v53
    v_cvt_pk_bf16_f32 v85, v54, v55
    v_cvt_pk_bf16_f32 v86, v56, v57
    v_cvt_pk_bf16_f32 v87, v58, v59
    v_cvt_pk_bf16_f32 v88, v60, v61
    v_cvt_pk_bf16_f32 v89, v62, v63
    v_cvt_pk_bf16_f32 v90, v64, v65
    v_cvt_pk_bf16_f32 v91, v66, v67
    s_waitcnt lgkmcnt(0)
    ds_read_b128 v[16:19], v3 offset:37888
    s_mov_b64 exec, s[60:61]
    ds_read_b128 v[28:31], v5 offset:35840
    ds_read_b128 v[32:35], v5 offset:36352
    s_mov_b64 exec, -1
    v_mfma_f32_32x32x16_bf16 v[52:67], v[12:15], v[8:11], 0
    v_exp_f32 v68, v68
    v_exp_f32 v69, v69
    v_exp_f32 v70, v70
    v_exp_f32 v71, v71
    v_exp_f32 v72, v72
    v_exp_f32 v73, v73
    v_exp_f32 v74, v74
    v_exp_f32 v75, v75
    v_mfma_f32_32x32x16_bf16 v[100:115], v[20:23], v[84:87], v[100:115]
    v_exp_f32 v76, v76
    v_exp_f32 v77, v77
    v_exp_f32 v78, v78
    v_exp_f32 v79, v79
    v_exp_f32 v80, v80
    v_exp_f32 v81, v81
    v_exp_f32 v82, v82
    v_exp_f32 v83, v83
    v_mfma_f32_32x32x16_bf16 v[100:115], v[24:27], v[88:91], v[100:115]
    v_cvt_pk_bf16_f32 v92, v68, v69
    v_cvt_pk_bf16_f32 v93, v70, v71
    v_cvt_pk_bf16_f32 v94, v72, v73
    v_cvt_pk_bf16_f32 v95, v74, v75
    v_cvt_pk_bf16_f32 v96, v76, v77
    v_cvt_pk_bf16_f32 v97, v78, v79
    v_cvt_pk_bf16_f32 v98, v80, v81
    v_cvt_pk_bf16_f32 v99, v82, v83
    s_waitcnt lgkmcnt(0)
    ds_read_b128 v[12:15], v3 offset:38912
    s_mov_b64 exec, s[60:61]
    ds_read_b128 v[20:23], v5 offset:36864
    ds_read_b128 v[24:27], v5 offset:37376
    s_mov_b64 exec, -1
    v_mfma_f32_32x32x16_bf16 v[68:83], v[16:19], v[8:11], 0
    v_exp_f32 v52, v52
    v_exp_f32 v53, v53
    v_exp_f32 v54, v54
    v_exp_f32 v55, v55
    v_exp_f32 v56, v56
    v_exp_f32 v57, v57
    v_exp_f32 v58, v58
    v_exp_f32 v59, v59
    v_mfma_f32_32x32x16_bf16 v[100:115], v[28:31], v[92:95], v[100:115]
    v_exp_f32 v60, v60
    v_exp_f32 v61, v61
    v_exp_f32 v62, v62
    v_exp_f32 v63, v63
    v_exp_f32 v64, v64
    v_exp_f32 v65, v65
    v_exp_f32 v66, v66
    v_exp_f32 v67, v67
    v_mfma_f32_32x32x16_bf16 v[100:115], v[32:35], v[96:99], v[100:115]
    v_cvt_pk_bf16_f32 v84, v52, v53
    v_cvt_pk_bf16_f32 v85, v54, v55
    v_cvt_pk_bf16_f32 v86, v56, v57
    v_cvt_pk_bf16_f32 v87, v58, v59
    v_cvt_pk_bf16_f32 v88, v60, v61
    v_cvt_pk_bf16_f32 v89, v62, v63
    v_cvt_pk_bf16_f32 v90, v64, v65
    v_cvt_pk_bf16_f32 v91, v66, v67
    s_waitcnt lgkmcnt(0)
    ds_read_b128 v[16:19], v3 offset:39936
    s_mov_b64 exec, s[60:61]
    ds_read_b128 v[28:31], v5 offset:37888
    ds_read_b128 v[32:35], v5 offset:38400
    s_mov_b64 exec, -1
    v_mfma_f32_32x32x16_bf16 v[52:67], v[12:15], v[8:11], 0
    v_exp_f32 v68, v68
    v_exp_f32 v69, v69
    v_exp_f32 v70, v70
    v_exp_f32 v71, v71
    v_exp_f32 v72, v72
    v_exp_f32 v73, v73
    v_exp_f32 v74, v74
    v_exp_f32 v75, v75
    v_mfma_f32_32x32x16_bf16 v[100:115], v[20:23], v[84:87], v[100:115]
    v_exp_f32 v76, v76
    v_exp_f32 v77, v77
    v_exp_f32 v78, v78
    v_exp_f32 v79, v79
    v_exp_f32 v80, v80
    v_exp_f32 v81, v81
    v_exp_f32 v82, v82
    v_exp_f32 v83, v83
    v_mfma_f32_32x32x16_bf16 v[100:115], v[24:27], v[88:91], v[100:115]
    v_cvt_pk_bf16_f32 v92, v68, v69
    v_cvt_pk_bf16_f32 v93, v70, v71
    v_cvt_pk_bf16_f32 v94, v72, v73
    v_cvt_pk_bf16_f32 v95, v74, v75
    v_cvt_pk_bf16_f32 v96, v76, v77
    v_cvt_pk_bf16_f32 v97, v78, v79
    v_cvt_pk_bf16_f32 v98, v80, v81
    v_cvt_pk_bf16_f32 v99, v82, v83
    s_waitcnt lgkmcnt(0)
    ds_read_b128 v[12:15], v3 offset:40960
    s_mov_b64 exec, s[60:61]
    ds_read_b128 v[20:23], v5 offset:38912
    ds_read_b128 v[24:27], v5 offset:39424
    s_mov_b64 exec, -1
    v_mfma_f32_32x32x16_bf16 v[68:83], v[16:19], v[8:11], 0
    v_exp_f32 v52, v52
    v_exp_f32 v53, v53
    v_exp_f32 v54, v54
    v_exp_f32 v55, v55
    v_exp_f32 v56, v56
    v_exp_f32 v57, v57
    v_exp_f32 v58, v58
    v_exp_f32 v59, v59
    v_mfma_f32_32x32x16_bf16 v[100:115], v[28:31], v[92:95], v[100:115]
    v_exp_f32 v60, v60
    v_exp_f32 v61, v61
    v_exp_f32 v62, v62
    v_exp_f32 v63, v63
    v_exp_f32 v64, v64
    v_exp_f32 v65, v65
    v_exp_f32 v66, v66
    v_exp_f32 v67, v67
    v_mfma_f32_32x32x16_bf16 v[100:115], v[32:35], v[96:99], v[100:115]
    v_cvt_pk_bf16_f32 v84, v52, v53
    v_cvt_pk_bf16_f32 v85, v54, v55
    v_cvt_pk_bf16_f32 v86, v56, v57
    v_cvt_pk_bf16_f32 v87, v58, v59
    v_cvt_pk_bf16_f32 v88, v60, v61
    v_cvt_pk_bf16_f32 v89, v62, v63
    v_cvt_pk_bf16_f32 v90, v64, v65
    v_cvt_pk_bf16_f32 v91, v66, v67
    s_waitcnt lgkmcnt(0)
    ds_read_b128 v[16:19], v3 offset:41984
    s_mov_b64 exec, s[60:61]
    ds_read_b128 v[28:31], v5 offset:39936
    ds_read_b128 v[32:35], v5 offset:40448
    s_mov_b64 exec, -1
    v_mfma_f32_32x32x16_bf16 v[52:67], v[12:15], v[8:11], 0
    v_exp_f32 v68, v68
    v_exp_f32 v69, v69
    v_exp_f32 v70, v70
    v_exp_f32 v71, v71
    v_exp_f32 v72, v72
    v_exp_f32 v73, v73
    v_exp_f32 v74, v74
    v_exp_f32 v75, v75
    v_mfma_f32_32x32x16_bf16 v[100:115], v[20:23], v[84:87], v[100:115]
    v_exp_f32 v76, v76
    v_exp_f32 v77, v77
    v_exp_f32 v78, v78
    v_exp_f32 v79, v79
    v_exp_f32 v80, v80
    v_exp_f32 v81, v81
    v_exp_f32 v82, v82
    v_exp_f32 v83, v83
    v_mfma_f32_32x32x16_bf16 v[100:115], v[24:27], v[88:91], v[100:115]
    v_cvt_pk_bf16_f32 v92, v68, v69
    v_cvt_pk_bf16_f32 v93, v70, v71
    v_cvt_pk_bf16_f32 v94, v72, v73
    v_cvt_pk_bf16_f32 v95, v74, v75
    v_cvt_pk_bf16_f32 v96, v76, v77
    v_cvt_pk_bf16_f32 v97, v78, v79
    v_cvt_pk_bf16_f32 v98, v80, v81
    v_cvt_pk_bf16_f32 v99, v82, v83
    s_waitcnt lgkmcnt(0)
    ds_read_b128 v[12:15], v3 offset:43008
    s_mov_b64 exec, s[60:61]
    ds_read_b128 v[20:23], v5 offset:40960
    ds_read_b128 v[24:27], v5 offset:41472
    s_mov_b64 exec, -1
    v_mfma_f32_32x32x16_bf16 v[68:83], v[16:19], v[8:11], 0
    v_exp_f32 v52, v52
    v_exp_f32 v53, v53
    v_exp_f32 v54, v54
    v_exp_f32 v55, v55
    v_exp_f32 v56, v56
    v_exp_f32 v57, v57
    v_exp_f32 v58, v58
    v_exp_f32 v59, v59
    v_mfma_f32_32x32x16_bf16 v[100:115], v[28:31], v[92:95], v[100:115]
    v_exp_f32 v60, v60
    v_exp_f32 v61, v61
    v_exp_f32 v62, v62
    v_exp_f32 v63, v63
    v_exp_f32 v64, v64
    v_exp_f32 v65, v65
    v_exp_f32 v66, v66
    v_exp_f32 v67, v67
    v_mfma_f32_32x32x16_bf16 v[100:115], v[32:35], v[96:99], v[100:115]
    v_cvt_pk_bf16_f32 v84, v52, v53
    v_cvt_pk_bf16_f32 v85, v54, v55
    v_cvt_pk_bf16_f32 v86, v56, v57
    v_cvt_pk_bf16_f32 v87, v58, v59
    v_cvt_pk_bf16_f32 v88, v60, v61
    v_cvt_pk_bf16_f32 v89, v62, v63
    v_cvt_pk_bf16_f32 v90, v64, v65
    v_cvt_pk_bf16_f32 v91, v66, v67
    s_waitcnt lgkmcnt(0)
    ds_read_b128 v[16:19], v3 offset:44032
    s_mov_b64 exec, s[60:61]
    ds_read_b128 v[28:31], v5 offset:41984
    ds_read_b128 v[32:35], v5 offset:42496
    s_mov_b64 exec, -1
    v_mfma_f32_32x32x16_bf16 v[52:67], v[12:15], v[8:11], 0
    v_exp_f32 v68, v68
    v_exp_f32 v69, v69
    v_exp_f32 v70, v70
    v_exp_f32 v71, v71
    v_exp_f32 v72, v72
    v_exp_f32 v73, v73
    v_exp_f32 v74, v74
    v_exp_f32 v75, v75
    v_mfma_f32_32x32x16_bf16 v[100:115], v[20:23], v[84:87], v[100:115]
    v_exp_f32 v76, v76
    v_exp_f32 v77, v77
    v_exp_f32 v78, v78
    v_exp_f32 v79, v79
    v_exp_f32 v80, v80
    v_exp_f32 v81, v81
    v_exp_f32 v82, v82
    v_exp_f32 v83, v83
    v_mfma_f32_32x32x16_bf16 v[100:115], v[24:27], v[88:91], v[100:115]
    v_cvt_pk_bf16_f32 v92, v68, v69
    v_cvt_pk_bf16_f32 v93, v70, v71
    v_cvt_pk_bf16_f32 v94, v72, v73
    v_cvt_pk_bf16_f32 v95, v74, v75
    v_cvt_pk_bf16_f32 v96, v76, v77
    v_cvt_pk_bf16_f32 v97, v78, v79
    v_cvt_pk_bf16_f32 v98, v80, v81
    v_cvt_pk_bf16_f32 v99, v82, v83
    s_waitcnt lgkmcnt(0)
    ds_read_b128 v[12:15], v3 offset:45056
    s_mov_b64 exec, s[60:61]
    ds_read_b128 v[20:23], v5 offset:43008
    ds_read_b128 v[24:27], v5 offset:43520
    s_mov_b64 exec, -1
    v_mfma_f32_32x32x16_bf16 v[68:83], v[16:19], v[8:11], 0
    v_exp_f32 v52, v52
    v_exp_f32 v53, v53
    v_exp_f32 v54, v54
    v_exp_f32 v55, v55
    v_exp_f32 v56, v56
    v_exp_f32 v57, v57
    v_exp_f32 v58, v58
    v_exp_f32 v59, v59
    v_mfma_f32_32x32x16_bf16 v[100:115], v[28:31], v[92:95], v[100:115]
    v_exp_f32 v60, v60
    v_exp_f32 v61, v61
    v_exp_f32 v62, v62
    v_exp_f32 v63, v63
    v_exp_f32 v64, v64
    v_exp_f32 v65, v65
    v_exp_f32 v66, v66
    v_exp_f32 v67, v67
    v_mfma_f32_32x32x16_bf16 v[100:115], v[32:35], v[96:99], v[100:115]
    v_cvt_pk_bf16_f32 v84, v52, v53
    v_cvt_pk_bf16_f32 v85, v54, v55
    v_cvt_pk_bf16_f32 v86, v56, v57
    v_cvt_pk_bf16_f32 v87, v58, v59
    v_cvt_pk_bf16_f32 v88, v60, v61
    v_cvt_pk_bf16_f32 v89, v62, v63
    v_cvt_pk_bf16_f32 v90, v64, v65
    v_cvt_pk_bf16_f32 v91, v66, v67
    s_waitcnt lgkmcnt(0)
    ds_read_b128 v[16:19], v3 offset:46080
    s_mov_b64 exec, s[60:61]
    ds_read_b128 v[28:31], v5 offset:44032
    ds_read_b128 v[32:35], v5 offset:44544
    s_mov_b64 exec, -1
    v_mfma_f32_32x32x16_bf16 v[52:67], v[12:15], v[8:11], 0
    v_exp_f32 v68, v68
    v_exp_f32 v69, v69
    v_exp_f32 v70, v70
    v_exp_f32 v71, v71
    v_exp_f32 v72, v72
    v_exp_f32 v73, v73
    v_exp_f32 v74, v74
    v_exp_f32 v75, v75
    v_mfma_f32_32x32x16_bf16 v[100:115], v[20:23], v[84:87], v[100:115]
    v_exp_f32 v76, v76
    v_exp_f32 v77, v77
    v_exp_f32 v78, v78
    v_exp_f32 v79, v79
    v_exp_f32 v80, v80
    v_exp_f32 v81, v81
    v_exp_f32 v82, v82
    v_exp_f32 v83, v83
    v_mfma_f32_32x32x16_bf16 v[100:115], v[24:27], v[88:91], v[100:115]
    v_cvt_pk_bf16_f32 v92, v68, v69
    v_cvt_pk_bf16_f32 v93, v70, v71
    v_cvt_pk_bf16_f32 v94, v72, v73
    v_cvt_pk_bf16_f32 v95, v74, v75
    v_cvt_pk_bf16_f32 v96, v76, v77
    v_cvt_pk_bf16_f32 v97, v78, v79
    v_cvt_pk_bf16_f32 v98, v80, v81
    v_cvt_pk_bf16_f32 v99, v82, v83
    s_waitcnt lgkmcnt(0)
    ds_read_b128 v[12:15], v3 offset:47104
    s_mov_b64 exec, s[60:61]
    ds_read_b128 v[20:23], v5 offset:45056
    ds_read_b128 v[24:27], v5 offset:45568
    s_mov_b64 exec, -1
    v_mfma_f32_32x32x16_bf16 v[68:83], v[16:19], v[8:11], 0
    v_exp_f32 v52, v52
    v_exp_f32 v53, v53
    v_exp_f32 v54, v54
    v_exp_f32 v55, v55
    v_exp_f32 v56, v56
    v_exp_f32 v57, v57
    v_exp_f32 v58, v58
    v_exp_f32 v59, v59
    v_mfma_f32_32x32x16_bf16 v[100:115], v[28:31], v[92:95], v[100:115]
    v_exp_f32 v60, v60
    v_exp_f32 v61, v61
    v_exp_f32 v62, v62
    v_exp_f32 v63, v63
    v_exp_f32 v64, v64
    v_exp_f32 v65, v65
    v_exp_f32 v66, v66
    v_exp_f32 v67, v67
    v_mfma_f32_32x32x16_bf16 v[100:115], v[32:35], v[96:99], v[100:115]
    v_cvt_pk_bf16_f32 v84, v52, v53
    v_cvt_pk_bf16_f32 v85, v54, v55
    v_cvt_pk_bf16_f32 v86, v56, v57
    v_cvt_pk_bf16_f32 v87, v58, v59
    v_cvt_pk_bf16_f32 v88, v60, v61
    v_cvt_pk_bf16_f32 v89, v62, v63
    v_cvt_pk_bf16_f32 v90, v64, v65
    v_cvt_pk_bf16_f32 v91, v66, v67
    s_waitcnt lgkmcnt(0)
    ds_read_b128 v[16:19], v3 offset:48128
    s_mov_b64 exec, s[60:61]
    ds_read_b128 v[28:31], v5 offset:46080
    ds_read_b128 v[32:35], v5 offset:46592
    s_mov_b64 exec, -1
    v_mfma_f32_32x32x16_bf16 v[52:67], v[12:15], v[8:11], 0
    v_exp_f32 v68, v68
    v_exp_f32 v69, v69
    v_exp_f32 v70, v70
    v_exp_f32 v71, v71
    v_exp_f32 v72, v72
    v_exp_f32 v73, v73
    v_exp_f32 v74, v74
    v_exp_f32 v75, v75
    v_mfma_f32_32x32x16_bf16 v[100:115], v[20:23], v[84:87], v[100:115]
    v_exp_f32 v76, v76
    v_exp_f32 v77, v77
    v_exp_f32 v78, v78
    v_exp_f32 v79, v79
    v_exp_f32 v80, v80
    v_exp_f32 v81, v81
    v_exp_f32 v82, v82
    v_exp_f32 v83, v83
    v_mfma_f32_32x32x16_bf16 v[100:115], v[24:27], v[88:91], v[100:115]
    v_cvt_pk_bf16_f32 v92, v68, v69
    v_cvt_pk_bf16_f32 v93, v70, v71
    v_cvt_pk_bf16_f32 v94, v72, v73
    v_cvt_pk_bf16_f32 v95, v74, v75
    v_cvt_pk_bf16_f32 v96, v76, v77
    v_cvt_pk_bf16_f32 v97, v78, v79
    v_cvt_pk_bf16_f32 v98, v80, v81
    v_cvt_pk_bf16_f32 v99, v82, v83
    s_waitcnt lgkmcnt(0)
    ds_read_b128 v[12:15], v3 offset:49152
    s_mov_b64 exec, s[60:61]
    ds_read_b128 v[20:23], v5 offset:47104
    ds_read_b128 v[24:27], v5 offset:47616
    s_mov_b64 exec, -1
    v_mfma_f32_32x32x16_bf16 v[68:83], v[16:19], v[8:11], 0
    v_exp_f32 v52, v52
    v_exp_f32 v53, v53
    v_exp_f32 v54, v54
    v_exp_f32 v55, v55
    v_exp_f32 v56, v56
    v_exp_f32 v57, v57
    v_exp_f32 v58, v58
    v_exp_f32 v59, v59
    v_mfma_f32_32x32x16_bf16 v[100:115], v[28:31], v[92:95], v[100:115]
    v_exp_f32 v60, v60
    v_exp_f32 v61, v61
    v_exp_f32 v62, v62
    v_exp_f32 v63, v63
    v_exp_f32 v64, v64
    v_exp_f32 v65, v65
    v_exp_f32 v66, v66
    v_exp_f32 v67, v67
    v_mfma_f32_32x32x16_bf16 v[100:115], v[32:35], v[96:99], v[100:115]
    v_cvt_pk_bf16_f32 v84, v52, v53
    v_cvt_pk_bf16_f32 v85, v54, v55
    v_cvt_pk_bf16_f32 v86, v56, v57
    v_cvt_pk_bf16_f32 v87, v58, v59
    v_cvt_pk_bf16_f32 v88, v60, v61
    v_cvt_pk_bf16_f32 v89, v62, v63
    v_cvt_pk_bf16_f32 v90, v64, v65
    v_cvt_pk_bf16_f32 v91, v66, v67
    s_waitcnt lgkmcnt(0)
    ds_read_b128 v[16:19], v3 offset:50176
    s_mov_b64 exec, s[60:61]
    ds_read_b128 v[28:31], v5 offset:48128
    ds_read_b128 v[32:35], v5 offset:48640
    s_mov_b64 exec, -1
    v_mfma_f32_32x32x16_bf16 v[52:67], v[12:15], v[8:11], 0
    v_exp_f32 v68, v68
    v_exp_f32 v69, v69
    v_exp_f32 v70, v70
    v_exp_f32 v71, v71
    v_exp_f32 v72, v72
    v_exp_f32 v73, v73
    v_exp_f32 v74, v74
    v_exp_f32 v75, v75
    v_mfma_f32_32x32x16_bf16 v[100:115], v[20:23], v[84:87], v[100:115]
    v_exp_f32 v76, v76
    v_exp_f32 v77, v77
    v_exp_f32 v78, v78
    v_exp_f32 v79, v79
    v_exp_f32 v80, v80
    v_exp_f32 v81, v81
    v_exp_f32 v82, v82
    v_exp_f32 v83, v83
    v_mfma_f32_32x32x16_bf16 v[100:115], v[24:27], v[88:91], v[100:115]
    v_cvt_pk_bf16_f32 v92, v68, v69
    v_cvt_pk_bf16_f32 v93, v70, v71
    v_cvt_pk_bf16_f32 v94, v72, v73
    v_cvt_pk_bf16_f32 v95, v74, v75
    v_cvt_pk_bf16_f32 v96, v76, v77
    v_cvt_pk_bf16_f32 v97, v78, v79
    v_cvt_pk_bf16_f32 v98, v80, v81
    v_cvt_pk_bf16_f32 v99, v82, v83
    s_waitcnt lgkmcnt(0)
    ds_read_b128 v[12:15], v3 offset:51200
    s_mov_b64 exec, s[60:61]
    ds_read_b128 v[20:23], v5 offset:49152
    ds_read_b128 v[24:27], v5 offset:49664
    s_mov_b64 exec, -1
    v_mfma_f32_32x32x16_bf16 v[68:83], v[16:19], v[8:11], 0
    v_exp_f32 v52, v52
    v_exp_f32 v53, v53
    v_exp_f32 v54, v54
    v_exp_f32 v55, v55
    v_exp_f32 v56, v56
    v_exp_f32 v57, v57
    v_exp_f32 v58, v58
    v_exp_f32 v59, v59
    v_mfma_f32_32x32x16_bf16 v[100:115], v[28:31], v[92:95], v[100:115]
    v_exp_f32 v60, v60
    v_exp_f32 v61, v61
    v_exp_f32 v62, v62
    v_exp_f32 v63, v63
    v_exp_f32 v64, v64
    v_exp_f32 v65, v65
    v_exp_f32 v66, v66
    v_exp_f32 v67, v67
    v_mfma_f32_32x32x16_bf16 v[100:115], v[32:35], v[96:99], v[100:115]
    v_cvt_pk_bf16_f32 v84, v52, v53
    v_cvt_pk_bf16_f32 v85, v54, v55
    v_cvt_pk_bf16_f32 v86, v56, v57
    v_cvt_pk_bf16_f32 v87, v58, v59
    v_cvt_pk_bf16_f32 v88, v60, v61
    v_cvt_pk_bf16_f32 v89, v62, v63
    v_cvt_pk_bf16_f32 v90, v64, v65
    v_cvt_pk_bf16_f32 v91, v66, v67
    s_waitcnt lgkmcnt(0)
    ds_read_b128 v[16:19], v3 offset:52224
    s_mov_b64 exec, s[60:61]
    ds_read_b128 v[28:31], v5 offset:50176
    ds_read_b128 v[32:35], v5 offset:50688
    s_mov_b64 exec, -1
    v_mfma_f32_32x32x16_bf16 v[52:67], v[12:15], v[8:11], 0
    v_exp_f32 v68, v68
    v_exp_f32 v69, v69
    v_exp_f32 v70, v70
    v_exp_f32 v71, v71
    v_exp_f32 v72, v72
    v_exp_f32 v73, v73
    v_exp_f32 v74, v74
    v_exp_f32 v75, v75
    v_mfma_f32_32x32x16_bf16 v[100:115], v[20:23], v[84:87], v[100:115]
    v_exp_f32 v76, v76
    v_exp_f32 v77, v77
    v_exp_f32 v78, v78
    v_exp_f32 v79, v79
    v_exp_f32 v80, v80
    v_exp_f32 v81, v81
    v_exp_f32 v82, v82
    v_exp_f32 v83, v83
    v_mfma_f32_32x32x16_bf16 v[100:115], v[24:27], v[88:91], v[100:115]
    v_cvt_pk_bf16_f32 v92, v68, v69
    v_cvt_pk_bf16_f32 v93, v70, v71
    v_cvt_pk_bf16_f32 v94, v72, v73
    v_cvt_pk_bf16_f32 v95, v74, v75
    v_cvt_pk_bf16_f32 v96, v76, v77
    v_cvt_pk_bf16_f32 v97, v78, v79
    v_cvt_pk_bf16_f32 v98, v80, v81
    v_cvt_pk_bf16_f32 v99, v82, v83
    s_waitcnt lgkmcnt(0)
    ds_read_b128 v[12:15], v3 offset:53248
    s_mov_b64 exec, s[60:61]
    ds_read_b128 v[20:23], v5 offset:51200
    ds_read_b128 v[24:27], v5 offset:51712
    s_mov_b64 exec, -1
    v_mfma_f32_32x32x16_bf16 v[68:83], v[16:19], v[8:11], 0
    v_exp_f32 v52, v52
    v_exp_f32 v53, v53
    v_exp_f32 v54, v54
    v_exp_f32 v55, v55
    v_exp_f32 v56, v56
    v_exp_f32 v57, v57
    v_exp_f32 v58, v58
    v_exp_f32 v59, v59
    v_mfma_f32_32x32x16_bf16 v[100:115], v[28:31], v[92:95], v[100:115]
    v_exp_f32 v60, v60
    v_exp_f32 v61, v61
    v_exp_f32 v62, v62
    v_exp_f32 v63, v63
    v_exp_f32 v64, v64
    v_exp_f32 v65, v65
    v_exp_f32 v66, v66
    v_exp_f32 v67, v67
    v_mfma_f32_32x32x16_bf16 v[100:115], v[32:35], v[96:99], v[100:115]
    v_cvt_pk_bf16_f32 v84, v52, v53
    v_cvt_pk_bf16_f32 v85, v54, v55
    v_cvt_pk_bf16_f32 v86, v56, v57
    v_cvt_pk_bf16_f32 v87, v58, v59
    v_cvt_pk_bf16_f32 v88, v60, v61
    v_cvt_pk_bf16_f32 v89, v62, v63
    v_cvt_pk_bf16_f32 v90, v64, v65
    v_cvt_pk_bf16_f32 v91, v66, v67
    s_waitcnt lgkmcnt(0)
    ds_read_b128 v[16:19], v3 offset:54272
    s_mov_b64 exec, s[60:61]
    ds_read_b128 v[28:31], v5 offset:52224
    ds_read_b128 v[32:35], v5 offset:52736
    s_mov_b64 exec, -1
    v_mfma_f32_32x32x16_bf16 v[52:67], v[12:15], v[8:11], 0
    v_exp_f32 v68, v68
    v_exp_f32 v69, v69
    v_exp_f32 v70, v70
    v_exp_f32 v71, v71
    v_exp_f32 v72, v72
    v_exp_f32 v73, v73
    v_exp_f32 v74, v74
    v_exp_f32 v75, v75
    v_mfma_f32_32x32x16_bf16 v[100:115], v[20:23], v[84:87], v[100:115]
    v_exp_f32 v76, v76
    v_exp_f32 v77, v77
    v_exp_f32 v78, v78
    v_exp_f32 v79, v79
    v_exp_f32 v80, v80
    v_exp_f32 v81, v81
    v_exp_f32 v82, v82
    v_exp_f32 v83, v83
    v_mfma_f32_32x32x16_bf16 v[100:115], v[24:27], v[88:91], v[100:115]
    v_cvt_pk_bf16_f32 v92, v68, v69
    v_cvt_pk_bf16_f32 v93, v70, v71
    v_cvt_pk_bf16_f32 v94, v72, v73
    v_cvt_pk_bf16_f32 v95, v74, v75
    v_cvt_pk_bf16_f32 v96, v76, v77
    v_cvt_pk_bf16_f32 v97, v78, v79
    v_cvt_pk_bf16_f32 v98, v80, v81
    v_cvt_pk_bf16_f32 v99, v82, v83
    s_waitcnt lgkmcnt(0)
    ds_read_b128 v[12:15], v3 offset:55296
    s_mov_b64 exec, s[60:61]
    ds_read_b128 v[20:23], v5 offset:53248
    ds_read_b128 v[24:27], v5 offset:53760
    s_mov_b64 exec, -1
    v_mfma_f32_32x32x16_bf16 v[68:83], v[16:19], v[8:11], 0
    v_exp_f32 v52, v52
    v_exp_f32 v53, v53
    v_exp_f32 v54, v54
    v_exp_f32 v55, v55
    v_exp_f32 v56, v56
    v_exp_f32 v57, v57
    v_exp_f32 v58, v58
    v_exp_f32 v59, v59
    v_mfma_f32_32x32x16_bf16 v[100:115], v[28:31], v[92:95], v[100:115]
    v_exp_f32 v60, v60
    v_exp_f32 v61, v61
    v_exp_f32 v62, v62
    v_exp_f32 v63, v63
    v_exp_f32 v64, v64
    v_exp_f32 v65, v65
    v_exp_f32 v66, v66
    v_exp_f32 v67, v67
    v_mfma_f32_32x32x16_bf16 v[100:115], v[32:35], v[96:99], v[100:115]
    v_cvt_pk_bf16_f32 v84, v52, v53
    v_cvt_pk_bf16_f32 v85, v54, v55
    v_cvt_pk_bf16_f32 v86, v56, v57
    v_cvt_pk_bf16_f32 v87, v58, v59
    v_cvt_pk_bf16_f32 v88, v60, v61
    v_cvt_pk_bf16_f32 v89, v62, v63
    v_cvt_pk_bf16_f32 v90, v64, v65
    v_cvt_pk_bf16_f32 v91, v66, v67
    s_waitcnt lgkmcnt(0)
    ds_read_b128 v[16:19], v3 offset:56320
    s_mov_b64 exec, s[60:61]
    ds_read_b128 v[28:31], v5 offset:54272
    ds_read_b128 v[32:35], v5 offset:54784
    s_mov_b64 exec, -1
    v_mfma_f32_32x32x16_bf16 v[52:67], v[12:15], v[8:11], 0
    v_exp_f32 v68, v68
    v_exp_f32 v69, v69
    v_exp_f32 v70, v70
    v_exp_f32 v71, v71
    v_exp_f32 v72, v72
    v_exp_f32 v73, v73
    v_exp_f32 v74, v74
    v_exp_f32 v75, v75
    v_mfma_f32_32x32x16_bf16 v[100:115], v[20:23], v[84:87], v[100:115]
    v_exp_f32 v76, v76
    v_exp_f32 v77, v77
    v_exp_f32 v78, v78
    v_exp_f32 v79, v79
    v_exp_f32 v80, v80
    v_exp_f32 v81, v81
    v_exp_f32 v82, v82
    v_exp_f32 v83, v83
    v_mfma_f32_32x32x16_bf16 v[100:115], v[24:27], v[88:91], v[100:115]
    v_cvt_pk_bf16_f32 v92, v68, v69
    v_cvt_pk_bf16_f32 v93, v70, v71
    v_cvt_pk_bf16_f32 v94, v72, v73
    v_cvt_pk_bf16_f32 v95, v74, v75
    v_cvt_pk_bf16_f32 v96, v76, v77
    v_cvt_pk_bf16_f32 v97, v78, v79
    v_cvt_pk_bf16_f32 v98, v80, v81
    v_cvt_pk_bf16_f32 v99, v82, v83
    s_cmp_ge_u32 s3, 4
    s_cbranch_scc1 k2_keepp
    s_setprio 0
k2_keepp:
    s_waitcnt lgkmcnt(0)
    ds_read_b128 v[12:15], v3 offset:57344
    s_mov_b64 exec, s[60:61]
    ds_read_b128 v[20:23], v5 offset:55296
    ds_read_b128 v[24:27], v5 offset:55808
    s_mov_b64 exec, -1
    v_mfma_f32_32x32x16_bf16 v[68:83], v[16:19], v[8:11], 0
    v_exp_f32 v52, v52
    v_exp_f32 v53, v53
    v_exp_f32 v54, v54
    v_exp_f32 v55, v55
    v_exp_f32 v56, v56
    v_exp_f32 v57, v57
    v_exp_f32 v58, v58
    v_exp_f32 v59, v59
    v_mfma_f32_32x32x16_bf16 v[100:115], v[28:31], v[92:95], v[100:115]
    v_exp_f32 v60, v60
    v_exp_f32 v61, v61
    v_exp_f32 v62, v62
    v_exp_f32 v63, v63
    v_exp_f32 v64, v64
    v_exp_f32 v65, v65
    v_exp_f32 v66, v66
    v_exp_f32 v67, v67
    v_mfma_f32_32x32x16_bf16 v[100:115], v[32:35], v[96:99], v[100:115]
    v_cvt_pk_bf16_f32 v84, v52, v53
    v_cvt_pk_bf16_f32 v85, v54, v55
    v_cvt_pk_bf16_f32 v86, v56, v57
    v_cvt_pk_bf16_f32 v87, v58, v59
    v_cvt_pk_bf16_f32 v88, v60, v61
    v_cvt_pk_bf16_f32 v89, v62, v63
    v_cvt_pk_bf16_f32 v90, v64, v65
    v_cvt_pk_bf16_f32 v91, v66, v67
    s_waitcnt lgkmcnt(0)
    ds_read_b128 v[16:19], v3 offset:58368
    s_mov_b64 exec, s[60:61]
    ds_read_b128 v[28:31], v5 offset:56320
    ds_read_b128 v[32:35], v5 offset:56832
    s_mov_b64 exec, -1
    v_mfma_f32_32x32x16_bf16 v[52:67], v[12:15], v[8:11], 0
    v_exp_f32 v68, v68
    v_exp_f32 v69, v69
    v_exp_f32 v70, v70
    v_exp_f32 v71, v71
    v_exp_f32 v72, v72
    v_exp_f32 v73, v73
    v_exp_f32 v74, v74
    v_exp_f32 v75, v75
    v_mfma_f32_32x32x16_bf16 v[100:115], v[20:23], v[84:87], v[100:115]
    v_exp_f32 v76, v76
    v_exp_f32 v77, v77
    v_exp_f32 v78, v78
    v_exp_f32 v79, v79
    v_exp_f32 v80, v80
    v_exp_f32 v81, v81
    v_exp_f32 v82, v82
    v_exp_f32 v83, v83
    v_mfma_f32_32x32x16_bf16 v[100:115], v[24:27], v[88:91], v[100:115]
    v_cvt_pk_bf16_f32 v92, v68, v69
    v_cvt_pk_bf16_f32 v93, v70, v71
    v_cvt_pk_bf16_f32 v94, v72, v73
    v_cvt_pk_bf16_f32 v95, v74, v75
    v_cvt_pk_bf16_f32 v96, v76, v77
    v_cvt_pk_bf16_f32 v97, v78, v79
    v_cvt_pk_bf16_f32 v98, v80, v81
    v_cvt_pk_bf16_f32 v99, v82, v83
    s_waitcnt lgkmcnt(0)
    ds_read_b128 v[12:15], v3 offset:59392
    s_mov_b64 exec, s[60:61]
    ds_read_b128 v[20:23], v5 offset:57344
    ds_read_b128 v[24:27], v5 offset:57856
    s_mov_b64 exec, -1
    v_mfma_f32_32x32x16_bf16 v[68:83], v[16:19], v[8:11], 0
    v_exp_f32 v52, v52
    v_exp_f32 v53, v53
    v_exp_f32 v54, v54
    v_exp_f32 v55, v55
    v_exp_f32 v56, v56
    v_exp_f32 v57, v57
    v_exp_f32 v58, v58
    v_exp_f32 v59, v59
    v_mfma_f32_32x32x16_bf16 v[100:115], v[28:31], v[92:95], v[100:115]
    v_exp_f32 v60, v60
    v_exp_f32 v61, v61
    v_exp_f32 v62, v62
    v_exp_f32 v63, v63
    v_exp_f32 v64, v64
    v_exp_f32 v65, v65
    v_exp_f32 v66, v66
    v_exp_f32 v67, v67
    v_mfma_f32_32x32x16_bf16 v[100:115], v[32:35], v[96:99], v[100:115]
    v_cvt_pk_bf16_f32 v84, v52, v53
    v_cvt_pk_bf16_f32 v85, v54, v55
    v_cvt_pk_bf16_f32 v86, v56, v57
    v_cvt_pk_bf16_f32 v87, v58, v59
    v_cvt_pk_bf16_f32 v88, v60, v61
    v_cvt_pk_bf16_f32 v89, v62, v63
    v_cvt_pk_bf16_f32 v90, v64, v65
    v_cvt_pk_bf16_f32 v91, v66, v67
    s_waitcnt lgkmcnt(0)
    ds_read_b128 v[16:19], v3 offset:60416
    s_mov_b64 exec, s[60:61]
    ds_read_b128 v[28:31], v5 offset:58368
    ds_read_b128 v[32:35], v5 offset:58880
    s_mov_b64 exec, -1
    v_mfma_f32_32x32x16_bf16 v[52:67], v[12:15], v[8:11], 0
    v_exp_f32 v68, v68
    v_exp_f32 v69, v69
    v_exp_f32 v70, v70
    v_exp_f32 v71, v71
    v_exp_f32 v72, v72
    v_exp_f32 v73, v73
    v_exp_f32 v74, v74
    v_exp_f32 v75, v75
    v_mfma_f32_32x32x16_bf16 v[100:115], v[20:23], v[84:87], v[100:115]
    v_exp_f32 v76, v76
    v_exp_f32 v77, v77
    v_exp_f32 v78, v78
    v_exp_f32 v79, v79
    v_exp_f32 v80, v80
    v_exp_f32 v81, v81
    v_exp_f32 v82, v82
    v_exp_f32 v83, v83
    v_mfma_f32_32x32x16_bf16 v[100:115], v[24:27], v[88:91], v[100:115]
    v_cvt_pk_bf16_f32 v92, v68, v69
    v_cvt_pk_bf16_f32 v93, v70, v71
    v_cvt_pk_bf16_f32 v94, v72, v73
    v_cvt_pk_bf16_f32 v95, v74, v75
    v_cvt_pk_bf16_f32 v96, v76, v77
    v_cvt_pk_bf16_f32 v97, v78, v79
    v_cvt_pk_bf16_f32 v98, v80, v81
    v_cvt_pk_bf16_f32 v99, v82, v83
    s_waitcnt lgkmcnt(0)
    ds_read_b128 v[12:15], v3 offset:61440
    s_mov_b64 exec, s[60:61]
    ds_read_b128 v[20:23], v5 offset:59392
    ds_read_b128 v[24:27], v5 offset:59904
    s_mov_b64 exec, -1
    v_mfma_f32_32x32x16_bf16 v[68:83], v[16:19], v[8:11], 0
    v_exp_f32 v52, v52
    v_exp_f32 v53, v53
    v_exp_f32 v54, v54
    v_exp_f32 v55, v55
    v_exp_f32 v56, v56
    v_exp_f32 v57, v57
    v_exp_f32 v58, v58
    v_exp_f32 v59, v59
    v_mfma_f32_32x32x16_bf16 v[100:115], v[28:31], v[92:95], v[100:115]
    v_exp_f32 v60, v60
    v_exp_f32 v61, v61
    v_exp_f32 v62, v62
    v_exp_f32 v63, v63
    v_exp_f32 v64, v64
    v_exp_f32 v65, v65
    v_exp_f32 v66, v66
    v_exp_f32 v67, v67
    v_mfma_f32_32x32x16_bf16 v[100:115], v[32:35], v[96:99], v[100:115]
    v_cvt_pk_bf16_f32 v84, v52, v53
    v_cvt_pk_bf16_f32 v85, v54, v55
    v_cvt_pk_bf16_f32 v86, v56, v57
    v_cvt_pk_bf16_f32 v87, v58, v59
    v_cvt_pk_bf16_f32 v88, v60, v61
    v_cvt_pk_bf16_f32 v89, v62, v63
    v_cvt_pk_bf16_f32 v90, v64, v65
    v_cvt_pk_bf16_f32 v91, v66, v67
    s_waitcnt lgkmcnt(0)
    ds_read_b128 v[16:19], v3 offset:62464
    s_mov_b64 exec, s[60:61]
    ds_read_b128 v[28:31], v5 offset:60416
    ds_read_b128 v[32:35], v5 offset:60928
    s_mov_b64 exec, -1
    v_mfma_f32_32x32x16_bf16 v[52:67], v[12:15], v[8:11], 0
    v_exp_f32 v68, v68
    v_exp_f32 v69, v69
    v_exp_f32 v70, v70
    v_exp_f32 v71, v71
    v_exp_f32 v72, v72
    v_exp_f32 v73, v73
    v_exp_f32 v74, v74
    v_exp_f32 v75, v75
    v_mfma_f32_32x32x16_bf16 v[100:115], v[20:23], v[84:87], v[100:115]
    v_exp_f32 v76, v76
    v_exp_f32 v77, v77
    v_exp_f32 v78, v78
    v_exp_f32 v79, v79
    v_exp_f32 v80, v80
    v_exp_f32 v81, v81
    v_exp_f32 v82, v82
    v_exp_f32 v83, v83
    v_mfma_f32_32x32x16_bf16 v[100:115], v[24:27], v[88:91], v[100:115]
    v_cvt_pk_bf16_f32 v92, v68, v69
    v_cvt_pk_bf16_f32 v93, v70, v71
    v_cvt_pk_bf16_f32 v94, v72, v73
    v_cvt_pk_bf16_f32 v95, v74, v75
    v_cvt_pk_bf16_f32 v96, v76, v77
    v_cvt_pk_bf16_f32 v97, v78, v79
    v_cvt_pk_bf16_f32 v98, v80, v81
    v_cvt_pk_bf16_f32 v99, v82, v83
    s_waitcnt lgkmcnt(0)
    ds_read_b128 v[12:15], v3 offset:63488
    s_mov_b64 exec, s[60:61]
    ds_read_b128 v[20:23], v5 offset:61440
    ds_read_b128 v[24:27], v5 offset:61952
    s_mov_b64 exec, -1
    v_mfma_f32_32x32x16_bf16 v[68:83], v[16:19], v[8:11], 0
    v_exp_f32 v52, v52
    v_exp_f32 v53, v53
    v_exp_f32 v54, v54
    v_exp_f32 v55, v55
    v_exp_f32 v56, v56
    v_exp_f32 v57, v57
    v_exp_f32 v58, v58
    v_exp_f32 v59, v59
    v_mfma_f32_32x32x16_bf16 v[100:115], v[28:31], v[92:95], v[100:115]
    v_exp_f32 v60, v60
    v_exp_f32 v61, v61
    v_exp_f32 v62, v62
    v_exp_f32 v63, v63
    v_exp_f32 v64, v64
    v_exp_f32 v65, v65
    v_exp_f32 v66, v66
    v_exp_f32 v67, v67
    v_mfma_f32_32x32x16_bf16 v[100:115], v[32:35], v[96:99], v[100:115]
    v_cvt_pk_bf16_f32 v84, v52, v53
    v_cvt_pk_bf16_f32 v85, v54, v55
    v_cvt_pk_bf16_f32 v86, v56, v57
    v_cvt_pk_bf16_f32 v87, v58, v59
    v_cvt_pk_bf16_f32 v88, v60, v61
    v_cvt_pk_bf16_f32 v89, v62, v63
    v_cvt_pk_bf16_f32 v90, v64, v65
    v_cvt_pk_bf16_f32 v91, v66, v67
    s_waitcnt lgkmcnt(0)
    ds_read_b128 v[16:19], v3 offset:64512
    s_mov_b64 exec, s[60:61]
    ds_read_b128 v[28:31], v5 offset:62464
    ds_read_b128 v[32:35], v5 offset:62976
    s_mov_b64 exec, -1
    v_mfma_f32_32x32x16_bf16 v[52:67], v[12:15], v[8:11], 0
    v_exp_f32 v68, v68
    v_exp_f32 v69, v69
    v_exp_f32 v70, v70
    v_exp_f32 v71, v71
    v_exp_f32 v72, v72
    v_exp_f32 v73, v73
    v_exp_f32 v74, v74
    v_exp_f32 v75, v75
    v_mfma_f32_32x32x16_bf16 v[100:115], v[20:23], v[84:87], v[100:115]
    v_exp_f32 v76, v76
    v_exp_f32 v77, v77
    v_exp_f32 v78, v78
    v_exp_f32 v79, v79
    v_exp_f32 v80, v80
    v_exp_f32 v81, v81
    v_exp_f32 v82, v82
    v_exp_f32 v83, v83
    v_mfma_f32_32x32x16_bf16 v[100:115], v[24:27], v[88:91], v[100:115]
    v_cvt_pk_bf16_f32 v92, v68, v69
    v_cvt_pk_bf16_f32 v93, v70, v71
    v_cvt_pk_bf16_f32 v94, v72, v73
    v_cvt_pk_bf16_f32 v95, v74, v75
    v_cvt_pk_bf16_f32 v96, v76, v77
    v_cvt_pk_bf16_f32 v97, v78, v79
    v_cvt_pk_bf16_f32 v98, v80, v81
    v_cvt_pk_bf16_f32 v99, v82, v83
    s_waitcnt lgkmcnt(0)
    s_mov_b64 exec, s[60:61]
    ds_read_b128 v[20:23], v5 offset:63488
    ds_read_b128 v[24:27], v5 offset:64000
    s_mov_b64 exec, -1
    v_mfma_f32_32x32x16_bf16 v[68:83], v[16:19], v[8:11], 0
    v_exp_f32 v52, v52
    v_exp_f32 v53, v53
    v_exp_f32 v54, v54
    v_exp_f32 v55, v55
    v_exp_f32 v56, v56
    v_exp_f32 v57, v57
    v_exp_f32 v58, v58
    v_exp_f32 v59, v59
    v_mfma_f32_32x32x16_bf16 v[100:115], v[28:31], v[92:95], v[100:115]
    v_exp_f32 v60, v60
    v_exp_f32 v61, v61
    v_exp_f32 v62, v62
    v_exp_f32 v63, v63
    v_exp_f32 v64, v64
    v_exp_f32 v65, v65
    v_exp_f32 v66, v66
    v_exp_f32 v67, v67
    v_mfma_f32_32x32x16_bf16 v[100:115], v[32:35], v[96:99], v[100:115]
    v_cvt_pk_bf16_f32 v84, v52, v53
    v_cvt_pk_bf16_f32 v85, v54, v55
    v_cvt_pk_bf16_f32 v86, v56, v57
    v_cvt_pk_bf16_f32 v87, v58, v59
    v_cvt_pk_bf16_f32 v88, v60, v61
    v_cvt_pk_bf16_f32 v89, v62, v63
    v_cvt_pk_bf16_f32 v90, v64, v65
    v_cvt_pk_bf16_f32 v91, v66, v67
    s_waitcnt lgkmcnt(0)
    s_mov_b64 exec, s[60:61]
    ds_read_b128 v[28:31], v5 offset:64512
    ds_read_b128 v[32:35], v5 offset:65024
    s_mov_b64 exec, -1
    v_exp_f32 v68, v68
    v_exp_f32 v69, v69
    v_exp_f32 v70, v70
    v_exp_f32 v71, v71
    v_exp_f32 v72, v72
    v_exp_f32 v73, v73
    v_exp_f32 v74, v74
    v_exp_f32 v75, v75
    v_mfma_f32_32x32x16_bf16 v[100:115], v[20:23], v[84:87], v[100:115]
    v_exp_f32 v76, v76
    v_exp_f32 v77, v77
    v_exp_f32 v78, v78
    v_exp_f32 v79, v79
    v_exp_f32 v80, v80
    v_exp_f32 v81, v81
    v_exp_f32 v82, v82
    v_exp_f32 v83, v83
    v_mfma_f32_32x32x16_bf16 v[100:115], v[24:27], v[88:91], v[100:115]
    v_cvt_pk_bf16_f32 v92, v68, v69
    v_cvt_pk_bf16_f32 v93, v70, v71
    v_cvt_pk_bf16_f32 v94, v72, v73
    v_cvt_pk_bf16_f32 v95, v74, v75
    v_cvt_pk_bf16_f32 v96, v76, v77
    v_cvt_pk_bf16_f32 v97, v78, v79
    v_cvt_pk_bf16_f32 v98, v80, v81
    v_cvt_pk_bf16_f32 v99, v82, v83
    s_waitcnt lgkmcnt(0)
    v_mfma_f32_32x32x16_bf16 v[100:115], v[28:31], v[92:95], v[100:115]
    v_mfma_f32_32x32x16_bf16 v[100:115], v[32:35], v[96:99], v[100:115]
    v_mov_b32 v118, 0x53800000
    v_mov_b32 v119, 0x2b800000
    s_nop 9
    v_cmp_nle_f32 vcc, v108, v118
    v_cmp_nge_f32 s[62:63], v108, v119
    s_nop 0
    s_or_b64 vcc, vcc, s[62:63]
    s_cmp_eq_u64 vcc, 0
    s_cbranch_scc1 k2_fin
    s_mov_b32 s63, 0
    v_mov_b32 v6, v3
    v_mov_b32 v116, 0xff800000
k2_mx:
    ds_read_b128 v[12:15], v6
    v_add_u32 v6, 0x400, v6
    s_waitcnt lgkmcnt(0)
    v_mfma_f32_32x32x16_bf16 v[52:67], v[12:15], v[8:11], 0
    s_nop 11
    v_max3_f32 v116, v116, v52, v53
    v_max3_f32 v116, v116, v54, v55
    v_max3_f32 v116, v116, v56, v57
    v_max3_f32 v116, v116, v58, v59
    v_max3_f32 v116, v116, v60, v61
    v_max3_f32 v116, v116, v62, v63
    v_max3_f32 v116, v116, v64, v65
    v_max3_f32 v116, v116, v66, v67
    s_add_u32 s63, s63, 1
    s_cmp_lt_u32 s63, 64
    s_nop 11
    s_cbranch_scc1 k2_mx
    v_mov_b32 v117, v116
    s_nop 1
    v_permlane32_swap_b32 v116, v117
    v_max_f32 v116, v116, v117
    v_sub_f32 v36, 0, v116
    v_sub_f32 v37, 0, v116
    v_sub_f32 v38, 0, v116
    v_sub_f32 v39, 0, v116
    v_sub_f32 v40, 0, v116
    v_sub_f32 v41, 0, v116
    v_sub_f32 v42, 0, v116
    v_sub_f32 v43, 0, v116
    v_sub_f32 v44, 0, v116
    v_sub_f32 v45, 0, v116
    v_sub_f32 v46, 0, v116
    v_sub_f32 v47, 0, v116
    v_sub_f32 v48, 0, v116
    v_sub_f32 v49, 0, v116
    v_sub_f32 v50, 0, v116
    v_sub_f32 v51, 0, v116
    v_mov_b32 v100, 0
    v_mov_b32 v101, 0
    v_mov_b32 v102, 0
    v_mov_b32 v103, 0
    v_mov_b32 v104, 0
    v_mov_b32 v105, 0
    v_mov_b32 v106, 0
    v_mov_b32 v107, 0
    v_mov_b32 v108, 0
    v_mov_b32 v109, 0
    v_mov_b32 v110, 0
    v_mov_b32 v111, 0
    v_mov_b32 v112, 0
    v_mov_b32 v113, 0
    v_mov_b32 v114, 0
    v_mov_b32 v115, 0
    s_mov_b32 s63, 0
    v_mov_b32 v6, v3
    v_mov_b32 v7, v5
k2_sl:
    ds_read_b128 v[12:15], v6
    s_mov_b64 exec, s[60:61]
    ds_read_b128 v[20:23], v7
    ds_read_b128 v[24:27], v7 offset:512
    s_mov_b64 exec, -1
    v_add_u32 v6, 0x400, v6
    v_add_u32 v7, 0x400, v7
    s_waitcnt lgkmcnt(0)
    v_mfma_f32_32x32x16_bf16 v[52:67], v[12:15], v[8:11], v[36:51]
    s_nop 11
    v_exp_f32 v52, v52
    v_exp_f32 v53, v53
    v_exp_f32 v54, v54
    v_exp_f32 v55, v55
    v_exp_f32 v56, v56
    v_exp_f32 v57, v57
    v_exp_f32 v58, v58
    v_exp_f32 v59, v59
    v_exp_f32 v60, v60
    v_exp_f32 v61, v61
    v_exp_f32 v62, v62
    v_exp_f32 v63, v63
    v_exp_f32 v64, v64
    v_exp_f32 v65, v65
    v_exp_f32 v66, v66
    v_exp_f32 v67, v67
    v_cvt_pk_bf16_f32 v84, v52, v53
    v_cvt_pk_bf16_f32 v85, v54, v55
    v_cvt_pk_bf16_f32 v86, v56, v57
    v_cvt_pk_bf16_f32 v87, v58, v59
    v_cvt_pk_bf16_f32 v88, v60, v61
    v_cvt_pk_bf16_f32 v89, v62, v63
    v_cvt_pk_bf16_f32 v90, v64, v65
    v_cvt_pk_bf16_f32 v91, v66, v67
    v_mfma_f32_32x32x16_bf16 v[100:115], v[20:23], v[84:87], v[100:115]
    s_nop 0
    v_mfma_f32_32x32x16_bf16 v[100:115], v[24:27], v[88:91], v[100:115]
    s_add_u32 s63, s63, 1
    s_cmp_lt_u32 s63, 64
    s_nop 15
    s_cbranch_scc1 k2_sl
k2_fin:
    v_rcp_f32 v116, v108
    s_lshl_b32 s6, s5, 5
    s_add_u32 s6, s6, s4
    s_lshl_b32 s6, s6, 10
    s_add_u32 s6, s6, 0x1000000
    v_mul_f32 v100, v100, v116
    v_mul_f32 v101, v101, v116
    v_mul_f32 v102, v102, v116
    v_mul_f32 v103, v103, v116
    v_mul_f32 v104, v104, v116
    v_mul_f32 v105, v105, v116
    v_mul_f32 v106, v106, v116
    v_mul_f32 v107, v107, v116
    v_cvt_pk_bf16_f32 v120, v100, v101
    v_cvt_pk_bf16_f32 v121, v102, v103
    v_cvt_pk_bf16_f32 v122, v104, v105
    v_cvt_pk_bf16_f32 v123, v106, v107
    buffer_store_dwordx4 v[120:123], v3, s[40:43], s6 offen sc1
    s_endpgm
k2_side:
    s_sub_u32 s9, s3, 8
    s_lshl_b32 s7, s9, 16
    s_lshl_b32 s6, s4, 17
    s_add_u32 s6, s6, 0xc00000
    s_add_u32 s6, s6, s7
    s_setprio 3
    s_lshl_b32 s10, s9, 2
    s_add_u32 s10, s10, 0x24000
    v_mov_b32 v10, s10
    v_mov_b32 v11, 0
    ds_write_b32 v10, v11
    s_add_u32 m0, s7, 8192
    s_add_u32 s8, s6, 8192
    buffer_load_dwordx4 v3, s[40:43], s8 offen offset:0 lds
    buffer_load_dwordx4 v3, s[40:43], s8 offen offset:1024 lds
    buffer_load_dwordx4 v3, s[40:43], s8 offen offset:2048 lds
    buffer_load_dwordx4 v3, s[40:43], s8 offen offset:3072 lds
    s_add_u32 m0, s7, 12288
    s_add_u32 s8, s6, 12288
    buffer_load_dwordx4 v3, s[40:43], s8 offen offset:0 lds
    buffer_load_dwordx4 v3, s[40:43], s8 offen offset:1024 lds
    buffer_load_dwordx4 v3, s[40:43], s8 offen offset:2048 lds
    buffer_load_dwordx4 v3, s[40:43], s8 offen offset:3072 lds
    s_add_u32 m0, s7, 16384
    s_add_u32 s8, s6, 16384
    buffer_load_dwordx4 v3, s[40:43], s8 offen offset:0 lds
    buffer_load_dwordx4 v3, s[40:43], s8 offen offset:1024 lds
    buffer_load_dwordx4 v3, s[40:43], s8 offen offset:2048 lds
    buffer_load_dwordx4 v3, s[40:43], s8 offen offset:3072 lds
    s_add_u32 m0, s7, 20480
    s_add_u32 s8, s6, 20480
    buffer_load_dwordx4 v3, s[40:43], s8 offen offset:0 lds
    buffer_load_dwordx4 v3, s[40:43], s8 offen offset:1024 lds
    buffer_load_dwordx4 v3, s[40:43], s8 offen offset:2048 lds
    buffer_load_dwordx4 v3, s[40:43], s8 offen offset:3072 lds
    s_add_u32 m0, s7, 24576
    s_add_u32 s8, s6, 24576
    buffer_load_dwordx4 v3, s[40:43], s8 offen offset:0 lds
    buffer_load_dwordx4 v3, s[40:43], s8 offen offset:1024 lds
    buffer_load_dwordx4 v3, s[40:43], s8 offen offset:2048 lds
    buffer_load_dwordx4 v3, s[40:43], s8 offen offset:3072 lds
    s_waitcnt lgkmcnt(0)
    s_barrier
    s_add_u32 m0, s7, 28672
    s_add_u32 s8, s6, 28672
    buffer_load_dwordx4 v3, s[40:43], s8 offen offset:0 lds
    buffer_load_dwordx4 v3, s[40:43], s8 offen offset:1024 lds
    buffer_load_dwordx4 v3, s[40:43], s8 offen offset:2048 lds
    buffer_load_dwordx4 v3, s[40:43], s8 offen offset:3072 lds
    s_add_u32 m0, s7, 32768
    s_add_u32 s8, s6, 32768
    buffer_load_dwordx4 v3, s[40:43], s8 offen offset:0 lds
    buffer_load_dwordx4 v3, s[40:43], s8 offen offset:1024 lds
    buffer_load_dwordx4 v3, s[40:43], s8 offen offset:2048 lds
    buffer_load_dwordx4 v3, s[40:43], s8 offen offset:3072 lds
    s_add_u32 m0, s7, 36864
    s_add_u32 s8, s6, 36864
    buffer_load_dwordx4 v3, s[40:43], s8 offen offset:0 lds
    buffer_load_dwordx4 v3, s[40:43], s8 offen offset:1024 lds
    buffer_load_dwordx4 v3, s[40:43], s8 offen offset:2048 lds
    buffer_load_dwordx4 v3, s[40:43], s8 offen offset:3072 lds
    s_add_u32 m0, s7, 40960
    s_add_u32 s8, s6, 40960
    buffer_load_dwordx4 v3, s[40:43], s8 offen offset:0 lds
    buffer_load_dwordx4 v3, s[40:43], s8 offen offset:1024 lds
    buffer_load_dwordx4 v3, s[40:43], s8 offen offset:2048 lds
    buffer_load_dwordx4 v3, s[40:43], s8 offen offset:3072 lds
    s_add_u32 m0, s7, 45056
    s_add_u32 s8, s6, 45056
    buffer_load_dwordx4 v3, s[40:43], s8 offen offset:0 lds
    buffer_load_dwordx4 v3, s[40:43], s8 offen offset:1024 lds
    buffer_load_dwordx4 v3, s[40:43], s8 offen offset:2048 lds
    buffer_load_dwordx4 v3, s[40:43], s8 offen offset:3072 lds
    s_add_u32 m0, s7, 49152
    s_add_u32 s8, s6, 49152
    buffer_load_dwordx4 v3, s[40:43], s8 offen offset:0 lds
    buffer_load_dwordx4 v3, s[40:43], s8 offen offset:1024 lds
    buffer_load_dwordx4 v3, s[40:43], s8 offen offset:2048 lds
    buffer_load_dwordx4 v3, s[40:43], s8 offen offset:3072 lds
    s_add_u32 m0, s7, 53248
    s_add_u32 s8, s6, 53248
    buffer_load_dwordx4 v3, s[40:43], s8 offen offset:0 lds
    buffer_load_dwordx4 v3, s[40:43], s8 offen offset:1024 lds
    buffer_load_dwordx4 v3, s[40:43], s8 offen offset:2048 lds
    buffer_load_dwordx4 v3, s[40:43], s8 offen offset:3072 lds
    s_add_u32 m0, s7, 57344
    s_add_u32 s8, s6, 57344
    buffer_load_dwordx4 v3, s[40:43], s8 offen offset:0 lds
    buffer_load_dwordx4 v3, s[40:43], s8 offen offset:1024 lds
    buffer_load_dwordx4 v3, s[40:43], s8 offen offset:2048 lds
    buffer_load_dwordx4 v3, s[40:43], s8 offen offset:3072 lds
    s_add_u32 m0, s7, 61440
    s_add_u32 s8, s6, 61440
    buffer_load_dwordx4 v3, s[40:43], s8 offen offset:0 lds
    buffer_load_dwordx4 v3, s[40:43], s8 offen offset:1024 lds
    buffer_load_dwordx4 v3, s[40:43], s8 offen offset:2048 lds
    buffer_load_dwordx4 v3, s[40:43], s8 offen offset:3072 lds
    v_mov_b32 v11, 1
    s_waitcnt vmcnt(40)
    ds_write_b32 v10, v11
    v_mov_b32 v12, 2
    s_waitcnt vmcnt(0)
    ds_write_b32 v10, v12
    s_lshl_b32 s15, s9, 13
    v_lshrrev_b32 v5, 5, v2
    v_bfe_u32 v6, v2, 4, 1
    v_bfe_u32 v7, v2, 2, 2
    v_and_b32 v8, 1, v2
    v_bfe_u32 v9, v2, 1, 1
    v_lshl_add_u32 v8, v8, 1, v9
    v_lshl_add_u32 v5, v5, 3, v7
    v_lshlrev_b32 v5, 8, v5
    v_lshl_add_u32 v5, v6, 5, v5
    v_lshl_add_u32 v5, v8, 3, v5
    s_add_u32 s14, s15, 0x20000
    v_add_u32 v5, s14, v5
    s_and_b32 s10, s2, 3
    s_lshr_b32 s11, s2, 2
    s_lshl_b32 s11, s11, 1
    s_add_u32 s11, s11, s9
    s_lshr_b32 s12, s11, 5
    s_mul_i32 s13, s10, 3
    s_add_u32 s52, s13, s12
    s_and_b32 s51, s11, 15
    s_bfe_u32 s55, s11, 0x10004
    s_mov_b32 s48, 2752
    s_mov_b32 s49, 0x500000
    s_mov_b32 s50, 32
    s_mov_b32 s53, 43
    s_mov_b32 s54, 1
    s_cmp_ge_u32 s12, 3
    s_cbranch_scc1 k2_pa_done
    s_cmp_ge_u32 s52, 11
    s_cbranch_scc1 k2_pa_done
    s_cmp_eq_u32 s55, 0
    s_cselect_b32 s44, s24, s26
    s_cselect_b32 s45, s25, s27
    s_and_b32 s45, s45, 0xffff
    s_mov_b32 s46, 1409024
    s_mov_b32 s47, 0x20000
    v_lshrrev_b32 v6, 4, v2
    v_mul_lo_u32 v6, v6, s48
    v_and_b32 v4, 15, v2
    v_lshl_add_u32 v6, v4, 4, v6
    s_lshl_b32 s13, s51, 5
    s_mul_i32 s13, s13, s48
    s_lshl_b32 s14, s52, 8
    s_add_u32 s13, s13, s14
    s_lshl_b32 s14, s48, 2
    s_add_u32 m0, s15, 131072
    s_nop 0
    buffer_load_dwordx4 v6, s[44:47], s13 offen lds
    s_add_u32 s13, s13, s14
    s_add_u32 m0, s15, 132096
    s_nop 0
    buffer_load_dwordx4 v6, s[44:47], s13 offen lds
    s_add_u32 s13, s13, s14
    s_add_u32 m0, s15, 133120
    s_nop 0
    buffer_load_dwordx4 v6, s[44:47], s13 offen lds
    s_add_u32 s13, s13, s14
    s_add_u32 m0, s15, 134144
    s_nop 0
    buffer_load_dwordx4 v6, s[44:47], s13 offen lds
    s_add_u32 s13, s13, s14
    s_add_u32 m0, s15, 135168
    s_nop 0
    buffer_load_dwordx4 v6, s[44:47], s13 offen lds
    s_add_u32 s13, s13, s14
    s_add_u32 m0, s15, 136192
    s_nop 0
    buffer_load_dwordx4 v6, s[44:47], s13 offen lds
    s_add_u32 s13, s13, s14
    s_add_u32 m0, s15, 137216
    s_nop 0
    buffer_load_dwordx4 v6, s[44:47], s13 offen lds
    s_add_u32 s13, s13, s14
    s_add_u32 m0, s15, 138240
    s_nop 0
    buffer_load_dwordx4 v6, s[44:47], s13 offen lds
    v_and_b32 v7, 31, v2
    v_lshlrev_b32 v7, 2, v7
    v_add_u32 v8, 2048, v7
    v_add_u32 v7, 4096, v7
    v_cmp_gt_u32 vcc, 32, v2
    s_nop 1
    v_cndmask_b32 v7, v8, v7, vcc
    s_lshl_b32 s13, s51, 7
    s_add_u32 s13, s13, 0x100000
    buffer_load_dword v120, v7, s[40:43], s13 offen
    s_add_u32 s13, s13, 8192
    buffer_load_dword v121, v7, s[40:43], s13 offen
    s_add_u32 s13, s13, 8192
    buffer_load_dword v122, v7, s[40:43], s13 offen
    s_add_u32 s13, s13, 8192
    buffer_load_dword v123, v7, s[40:43], s13 offen
    s_waitcnt vmcnt(0)
    v_add_f32 v120, v120, v121
    v_add_f32 v122, v122, v123
    v_add_f32 v120, v120, v122
    v_cvt_pk_bf16_f32 v120, v120, v120
    v_lshlrev_b32 v120, 16, v120
    v_add_f32 v121, 1.0, v120
    v_cmp_gt_u32 vcc, 32, v2
    s_nop 1
    v_cndmask_b32 v120, v120, v121, vcc
    v_cvt_pk_bf16_f32 v120, v120, v120
    s_lshl_b32 s13, s9, 7
    s_add_u32 s13, s13, 0x24040
    v_lshl_add_u32 v121, v2, 1, s13
    ds_write_b16 v121, v120
    v_lshlrev_b32 v122, 6, v2
    v_and_b32 v122, 64, v122
    v_lshrrev_b32 v123, 5, v2
    v_lshl_add_u32 v122, v123, 4, v122
    v_add_u32 v122, s13, v122
    v_mov_b32 v112, 0
    v_mov_b32 v113, 0
    v_mov_b32 v114, 0
    v_mov_b32 v115, 0
    v_mov_b32 v116, 0
    v_mov_b32 v117, 0
    v_mov_b32 v118, 0
    v_mov_b32 v119, 0
    s_mov_b32 s60, 3
    s_mov_b32 s61, 3
    s_waitcnt lgkmcnt(0)
    s_mov_b64 exec, s[60:61]
    ds_read_b128 v[112:115], v122
    ds_read_b128 v[116:119], v122 offset:32
    s_mov_b64 exec, -1
    v_lshlrev_b32 v120, 4, v2
    s_lshr_b32 s62, s51, 3
    s_lshl_b32 s62, s62, 9
    s_bfe_u32 s63, s51, 0x20001
    s_lshl_b32 s63, s63, 10
    s_add_u32 s62, s62, s63
    s_and_b32 s63, s51, 1
    s_lshl_b32 s63, s63, 3
    s_add_u32 s62, s62, s63
    s_add_u32 s62, s62, 0x300000
    ds_read_b64_tr_b16 v[16:17], v5 offset:0
    ds_read_b64_tr_b16 v[18:19], v5 offset:1024
    ds_read_b64_tr_b16 v[20:21], v5 offset:4096
    ds_read_b64_tr_b16 v[22:23], v5 offset:5120
    ds_read_b64_tr_b16 v[24:25], v5 offset:64
    ds_read_b64_tr_b16 v[26:27], v5 offset:1088
    ds_read_b64_tr_b16 v[28:29], v5 offset:4160
    ds_read_b64_tr_b16 v[30:31], v5 offset:5184
    ds_read_b64_tr_b16 v[32:33], v5 offset:128
    ds_read_b64_tr_b16 v[34:35], v5 offset:1152
    ds_read_b64_tr_b16 v[36:37], v5 offset:4224
    ds_read_b64_tr_b16 v[38:39], v5 offset:5248
    ds_read_b64_tr_b16 v[40:41], v5 offset:192
    ds_read_b64_tr_b16 v[42:43], v5 offset:1216
    ds_read_b64_tr_b16 v[44:45], v5 offset:4288
    ds_read_b64_tr_b16 v[46:47], v5 offset:5312
    s_waitcnt lgkmcnt(0)
    v_mfma_f32_32x32x16_bf16 v[48:63], v[112:115], v[16:19], 0
    v_mfma_f32_32x32x16_bf16 v[64:79], v[112:115], v[24:27], 0
    v_mfma_f32_32x32x16_bf16 v[80:95], v[112:115], v[32:35], 0
    v_mfma_f32_32x32x16_bf16 v[96:111], v[112:115], v[40:43], 0
    v_mfma_f32_32x32x16_bf16 v[48:63], v[116:119], v[20:23], v[48:63]
    v_mfma_f32_32x32x16_bf16 v[64:79], v[116:119], v[28:31], v[64:79]
    v_mfma_f32_32x32x16_bf16 v[80:95], v[116:119], v[36:39], v[80:95]
    v_mfma_f32_32x32x16_bf16 v[96:111], v[116:119], v[44:47], v[96:111]
    s_mov_b32 s60, -1
    s_mov_b32 s61, 0
    s_lshl_b32 s13, s52, 2
    s_add_u32 s13, s13, 0
    s_cmp_ge_u32 s13, s53
    s_cbranch_scc1 k2_pa_done
    s_lshl_b32 s13, s13, s54
    s_add_u32 s13, s13, s55
    s_lshl_b32 s14, s13, 12
    s_add_u32 s14, s14, s62
    s_mov_b64 exec, s[60:61]
    buffer_store_dwordx2 v[48:49], v120, s[40:43], s14 offen sc1
    s_mov_b64 exec, -1
    s_mul_i32 s13, s13, s50
    s_lshl_b32 s14, s51, 1
    s_add_u32 s13, s13, s14
    s_lshl_b32 s13, s13, 10
    s_add_u32 s13, s13, s49
    buffer_store_dwordx4 v[16:19], v3, s[40:43], s13 offen sc1
    buffer_store_dwordx4 v[20:23], v3, s[40:43], s13 offen offset:1024 sc1
    s_lshl_b32 s13, s52, 2
    s_add_u32 s13, s13, 1
    s_cmp_ge_u32 s13, s53
    s_cbranch_scc1 k2_pa_done
    s_lshl_b32 s13, s13, s54
    s_add_u32 s13, s13, s55
    s_lshl_b32 s14, s13, 12
    s_add_u32 s14, s14, s62
    s_mov_b64 exec, s[60:61]
    buffer_store_dwordx2 v[64:65], v120, s[40:43], s14 offen sc1
    s_mov_b64 exec, -1
    s_mul_i32 s13, s13, s50
    s_lshl_b32 s14, s51, 1
    s_add_u32 s13, s13, s14
    s_lshl_b32 s13, s13, 10
    s_add_u32 s13, s13, s49
    buffer_store_dwordx4 v[24:27], v3, s[40:43], s13 offen sc1
    buffer_store_dwordx4 v[28:31], v3, s[40:43], s13 offen offset:1024 sc1
    s_lshl_b32 s13, s52, 2
    s_add_u32 s13, s13, 2
    s_cmp_ge_u32 s13, s53
    s_cbranch_scc1 k2_pa_done
    s_lshl_b32 s13, s13, s54
    s_add_u32 s13, s13, s55
    s_lshl_b32 s14, s13, 12
    s_add_u32 s14, s14, s62
    s_mov_b64 exec, s[60:61]
    buffer_store_dwordx2 v[80:81], v120, s[40:43], s14 offen sc1
    s_mov_b64 exec, -1
    s_mul_i32 s13, s13, s50
    s_lshl_b32 s14, s51, 1
    s_add_u32 s13, s13, s14
    s_lshl_b32 s13, s13, 10
    s_add_u32 s13, s13, s49
    buffer_store_dwordx4 v[32:35], v3, s[40:43], s13 offen sc1
    buffer_store_dwordx4 v[36:39], v3, s[40:43], s13 offen offset:1024 sc1
    s_lshl_b32 s13, s52, 2
    s_add_u32 s13, s13, 3
    s_cmp_ge_u32 s13, s53
    s_cbranch_scc1 k2_pa_done
    s_lshl_b32 s13, s13, s54
    s_add_u32 s13, s13, s55
    s_lshl_b32 s14, s13, 12
    s_add_u32 s14, s14, s62
    s_mov_b64 exec, s[60:61]
    buffer_store_dwordx2 v[96:97], v120, s[40:43], s14 offen sc1
    s_mov_b64 exec, -1
    s_mul_i32 s13, s13, s50
    s_lshl_b32 s14, s51, 1
    s_add_u32 s13, s13, s14
    s_lshl_b32 s13, s13, 10
    s_add_u32 s13, s13, s49
    buffer_store_dwordx4 v[40:43], v3, s[40:43], s13 offen sc1
    buffer_store_dwordx4 v[44:47], v3, s[40:43], s13 offen offset:1024 sc1
k2_pa_done:
    s_lshl_b32 s11, s2, 1
    s_add_u32 s11, s11, s9
    s_mov_b32 s56, 1024
    s_mov_b32 s61, 16
    s_mov_b32 s62, 0
    s_mov_b32 s63, 0
    s_cmp_ge_u32 s11, 236
    s_cbranch_scc1 k2_pb_done
    s_mov_b32 s46, 1409024
    s_mov_b32 s57, 0x800000
    s_cmp_lt_u32 s11, 64
    s_cselect_b32 s44, s20, s28
    s_cselect_b32 s45, s21, s29
    s_cselect_b32 s46, 524288, s46
    s_cselect_b32 s57, 0x480000, s57
    s_cselect_b32 s58, 32, 0x56
    s_cselect_b32 s12, 0, 64
    s_sub_u32 s11, s11, s12
    s_and_b32 s45, s45, 0xffff
    s_mov_b32 s47, 0x20000
    s_lshr_b32 s59, s11, 2
    s_and_b32 s60, s11, 3
    v_lshrrev_b32 v7, 4, v2
    v_mul_lo_u32 v7, v7, s56
    v_and_b32 v4, 15, v2
    v_lshl_add_u32 v7, v4, 4, v7
    s_lshl_b32 s13, s59, 5
    s_mul_i32 s13, s13, s56
    s_lshl_b32 s14, s60, 8
    s_add_u32 s13, s13, s14
    s_lshl_b32 s14, s56, 2
    s_add_u32 m0, s15, 131072
    s_nop 0
    buffer_load_dwordx4 v7, s[44:47], s13 offen lds
    s_add_u32 s13, s13, s14
    s_add_u32 m0, s15, 132096
    s_nop 0
    buffer_load_dwordx4 v7, s[44:47], s13 offen lds
    s_add_u32 s13, s13, s14
    s_add_u32 m0, s15, 133120
    s_nop 0
    buffer_load_dwordx4 v7, s[44:47], s13 offen lds
    s_add_u32 s13, s13, s14
    s_add_u32 m0, s15, 134144
    s_nop 0
    buffer_load_dwordx4 v7, s[44:47], s13 offen lds
    s_add_u32 s13, s13, s14
    s_add_u32 m0, s15, 135168
    s_nop 0
    buffer_load_dwordx4 v7, s[44:47], s13 offen lds
    s_add_u32 s13, s13, s14
    s_add_u32 m0, s15, 136192
    s_nop 0
    buffer_load_dwordx4 v7, s[44:47], s13 offen lds
    s_add_u32 s13, s13, s14
    s_add_u32 m0, s15, 137216
    s_nop 0
    buffer_load_dwordx4 v7, s[44:47], s13 offen lds
    s_add_u32 s13, s13, s14
    s_add_u32 m0, s15, 138240
    s_nop 0
    buffer_load_dwordx4 v7, s[44:47], s13 offen lds
    s_waitcnt vmcnt(0)
    ds_read_b64_tr_b16 v[16:17], v5 offset:0
    ds_read_b64_tr_b16 v[18:19], v5 offset:1024
    ds_read_b64_tr_b16 v[20:21], v5 offset:4096
    ds_read_b64_tr_b16 v[22:23], v5 offset:5120
    ds_read_b64_tr_b16 v[24:25], v5 offset:64
    ds_read_b64_tr_b16 v[26:27], v5 offset:1088
    ds_read_b64_tr_b16 v[28:29], v5 offset:4160
    ds_read_b64_tr_b16 v[30:31], v5 offset:5184
    ds_read_b64_tr_b16 v[32:33], v5 offset:128
    ds_read_b64_tr_b16 v[34:35], v5 offset:1152
    ds_read_b64_tr_b16 v[36:37], v5 offset:4224
    ds_read_b64_tr_b16 v[38:39], v5 offset:5248
    ds_read_b64_tr_b16 v[40:41], v5 offset:192
    ds_read_b64_tr_b16 v[42:43], v5 offset:1216
    ds_read_b64_tr_b16 v[44:45], v5 offset:4288
    ds_read_b64_tr_b16 v[46:47], v5 offset:5312
    s_waitcnt lgkmcnt(0)
    s_lshl_b32 s13, s60, 2
    s_add_u32 s13, s13, 0
    s_cmp_ge_u32 s13, s61
    s_cbranch_scc1 k2_pb_done
    s_lshl_b32 s13, s13, s62
    s_add_u32 s13, s13, s63
    s_mul_i32 s13, s13, s58
    s_lshl_b32 s14, s59, 1
    s_add_u32 s13, s13, s14
    s_lshl_b32 s13, s13, 10
    s_add_u32 s13, s13, s57
    buffer_store_dwordx4 v[16:19], v3, s[40:43], s13 offen sc1
    buffer_store_dwordx4 v[20:23], v3, s[40:43], s13 offen offset:1024 sc1
    s_lshl_b32 s13, s60, 2
    s_add_u32 s13, s13, 1
    s_cmp_ge_u32 s13, s61
    s_cbranch_scc1 k2_pb_done
    s_lshl_b32 s13, s13, s62
    s_add_u32 s13, s13, s63
    s_mul_i32 s13, s13, s58
    s_lshl_b32 s14, s59, 1
    s_add_u32 s13, s13, s14
    s_lshl_b32 s13, s13, 10
    s_add_u32 s13, s13, s57
    buffer_store_dwordx4 v[24:27], v3, s[40:43], s13 offen sc1
    buffer_store_dwordx4 v[28:31], v3, s[40:43], s13 offen offset:1024 sc1
    s_lshl_b32 s13, s60, 2
    s_add_u32 s13, s13, 2
    s_cmp_ge_u32 s13, s61
    s_cbranch_scc1 k2_pb_done
    s_lshl_b32 s13, s13, s62
    s_add_u32 s13, s13, s63
    s_mul_i32 s13, s13, s58
    s_lshl_b32 s14, s59, 1
    s_add_u32 s13, s13, s14
    s_lshl_b32 s13, s13, 10
    s_add_u32 s13, s13, s57
    buffer_store_dwordx4 v[32:35], v3, s[40:43], s13 offen sc1
    buffer_store_dwordx4 v[36:39], v3, s[40:43], s13 offen offset:1024 sc1
    s_lshl_b32 s13, s60, 2
    s_add_u32 s13, s13, 3
    s_cmp_ge_u32 s13, s61
    s_cbranch_scc1 k2_pb_done
    s_lshl_b32 s13, s13, s62
    s_add_u32 s13, s13, s63
    s_mul_i32 s13, s13, s58
    s_lshl_b32 s14, s59, 1
    s_add_u32 s13, s13, s14
    s_lshl_b32 s13, s13, 10
    s_add_u32 s13, s13, s57
    buffer_store_dwordx4 v[40:43], v3, s[40:43], s13 offen sc1
    buffer_store_dwordx4 v[44:47], v3, s[40:43], s13 offen offset:1024 sc1
k2_pb_done:
    s_mov_b32 s56, s36
    s_and_b32 s57, s37, 0xffff
    s_mov_b32 s58, 0x100
    s_mov_b32 s59, 0x20000
    s_waitcnt vmcnt(0)
    v_mov_b32 v16, 0
    v_mov_b32 v17, 1
    v_mov_b32 v18, 1
    s_mov_b64 exec, 1
    buffer_atomic_add v17, v16, s[56:59], 0 offen offset:128 sc0
    s_waitcnt vmcnt(0)
    v_readfirstlane_b32 s52, v17
    s_nop 0
    s_cmp_lg_u32 s52, 511
    s_cbranch_scc1 k2_pf_nl
    buffer_store_dword v18, v16, s[56:59], 0 offen sc1
    s_waitcnt vmcnt(0)
k2_pf_nl:
    s_mov_b64 exec, -1
k2_pf_na:
    s_sub_u32 s52, s2, 192
    s_cmp_ge_u32 s52, 32
    s_cbranch_scc1 k2_nu_done
    s_cmp_lg_u32 s9, 1
    s_cbranch_scc1 k2_nu_done
    v_lshlrev_b32 v6, 2, v2
    v_lshlrev_b32 v7, 1, v2
    s_lshl_b32 s52, s52, 8
    s_add_u32 s53, s52, 0x100000
    buffer_load_dword v16, v6, s[40:43], s53 offen
    s_add_u32 s53, s53, 8192
    buffer_load_dword v17, v6, s[40:43], s53 offen
    s_add_u32 s53, s53, 8192
    buffer_load_dword v18, v6, s[40:43], s53 offen
    s_add_u32 s53, s53, 8192
    buffer_load_dword v19, v6, s[40:43], s53 offen
    s_add_u32 s52, s52, 4096
    s_add_u32 s55, s52, 0x4000
    s_lshr_b32 s53, s52, 1
    s_add_u32 s54, s53, 0x50000
    s_add_u32 s53, s53, 0xe000
    s_waitcnt vmcnt(0)
    v_add_f32 v16, v16, v18
    v_add_f32 v17, v17, v19
    v_add_f32 v16, v16, v17
    v_cvt_pk_bf16_f32 v16, v16, v16
    v_lshlrev_b32 v16, 16, v16
    v_add_f32 v17, 1.0, v16
    v_cvt_pk_bf16_f32 v17, v17, v17
    v_lshlrev_b32 v17, 16, v17
    buffer_store_dword v16, v6, s[40:43], s52 offen offset:0
    buffer_store_dword v17, v6, s[40:43], s55 offen
    buffer_store_short_d16_hi v16, v7, s[40:43], s53 offen
    buffer_store_short_d16_hi v17, v7, s[40:43], s54 offen
k2_nu_done:
    s_sub_u32 s52, s2, 192
    s_cmp_ge_u32 s52, 64
    s_cbranch_scc1 k2_z_done
    s_cmp_lg_u32 s9, 0
    s_cbranch_scc1 k2_z_done
    s_lshl_b32 s52, s52, 10
    s_add_u32 s52, s52, 0x80000
    v_mov_b32 v16, 0
    v_mov_b32 v17, 0
    v_mov_b32 v18, 0
    v_mov_b32 v19, 0
    buffer_store_dwordx4 v[16:19], v3, s[40:43], s52 offen
k2_z_done:
    s_waitcnt vmcnt(0)
    s_setprio 0
    s_mov_b32 s44, s16
    s_and_b32 s45, s17, 0xffff
    s_mov_b32 s46, 0x200000
    s_mov_b32 s47, 0x20000
    s_and_b32 s52, s2, 7
    s_lshl_b32 s52, s52, 18
    s_lshr_b32 s53, s2, 3
    s_lshl_b32 s53, s53, 1
    s_add_u32 s53, s53, s9
    s_lshl_b32 s53, s53, 12
    s_add_u32 s52, s52, s53
    buffer_load_dwordx4 v[32:35], v3, s[44:47], s52 offen offset:0
    buffer_load_dwordx4 v[36:39], v3, s[44:47], s52 offen offset:1024
    buffer_load_dwordx4 v[40:43], v3, s[44:47], s52 offen offset:2048
    buffer_load_dwordx4 v[44:47], v3, s[44:47], s52 offen offset:3072
    s_mov_b32 s52, 0
    v_mov_b32 v16, 0
k2_pf_poll:
    buffer_load_dword v17, v16, s[56:59], 0 offen sc1
    s_waitcnt vmcnt(0)
    v_readfirstlane_b32 s53, v17
    s_nop 0
    s_cmp_eq_u32 s53, 1
    s_cbranch_scc1 k2_pf_go
    s_add_u32 s52, s52, 1
    s_cmp_ge_u32 s52, 5
    s_cbranch_scc1 k2_pf_done
    s_sleep 16
    s_nop 0
    s_branch k2_pf_poll
k2_pf_go:
    s_lshr_b32 s52, s2, 3
    s_lshl_b32 s52, s52, 14
    s_lshl_b32 s53, s9, 13
    s_add_u32 s52, s52, s53
    s_add_u32 s52, s52, 0x480000
    buffer_load_dwordx4 v[32:35], v3, s[40:43], s52 offen offset:0
    buffer_load_dwordx4 v[36:39], v3, s[40:43], s52 offen offset:1024
    buffer_load_dwordx4 v[40:43], v3, s[40:43], s52 offen offset:2048
    buffer_load_dwordx4 v[44:47], v3, s[40:43], s52 offen offset:3072
    s_add_u32 s52, s52, 4096
    buffer_load_dwordx4 v[48:51], v3, s[40:43], s52 offen offset:0
    buffer_load_dwordx4 v[52:55], v3, s[40:43], s52 offen offset:1024
    buffer_load_dwordx4 v[56:59], v3, s[40:43], s52 offen offset:2048
    buffer_load_dwordx4 v[60:63], v3, s[40:43], s52 offen offset:3072
    s_and_b32 s52, s2, 3
    s_mul_i32 s52, s52, 12
    s_min_u32 s52, s52, 35
    s_lshl_b32 s52, s52, 16
    s_lshr_b32 s53, s2, 3
    s_lshl_b32 s53, s53, 1
    s_add_u32 s53, s53, s9
    s_mul_i32 s54, s53, 12288
    s_add_u32 s52, s52, s54
    s_cmp_ge_u32 s52, 0x2b0000
    s_cbranch_scc1 k2_pf_g
    s_add_u32 s52, s52, 0x500000
    buffer_load_dwordx4 v[64:67], v3, s[40:43], s52 offen offset:0
    buffer_load_dwordx4 v[68:71], v3, s[40:43], s52 offen offset:1024
    buffer_load_dwordx4 v[72:75], v3, s[40:43], s52 offen offset:2048
    buffer_load_dwordx4 v[76:79], v3, s[40:43], s52 offen offset:3072
    s_add_u32 s52, s52, 4096
    buffer_load_dwordx4 v[80:83], v3, s[40:43], s52 offen offset:0
    buffer_load_dwordx4 v[84:87], v3, s[40:43], s52 offen offset:1024
    buffer_load_dwordx4 v[88:91], v3, s[40:43], s52 offen offset:2048
    buffer_load_dwordx4 v[92:95], v3, s[40:43], s52 offen offset:3072
    s_add_u32 s52, s52, 4096
    buffer_load_dwordx4 v[96:99], v3, s[40:43], s52 offen offset:0
    buffer_load_dwordx4 v[100:103], v3, s[40:43], s52 offen offset:1024
    buffer_load_dwordx4 v[104:107], v3, s[40:43], s52 offen offset:2048
    buffer_load_dwordx4 v[108:111], v3, s[40:43], s52 offen offset:3072
k2_pf_g:
    s_mul_i32 s52, s53, 22528
    s_add_u32 s52, s52, 0x800000
    buffer_load_dwordx4 v[24:27], v3, s[40:43], s52 offen offset:0
    buffer_load_dwordx4 v[28:31], v3, s[40:43], s52 offen offset:1024
    buffer_load_dwordx4 v[32:35], v3, s[40:43], s52 offen offset:2048
    buffer_load_dwordx4 v[36:39], v3, s[40:43], s52 offen offset:3072
    s_add_u32 s52, s52, 4096
    buffer_load_dwordx4 v[40:43], v3, s[40:43], s52 offen offset:0
    buffer_load_dwordx4 v[44:47], v3, s[40:43], s52 offen offset:1024
    buffer_load_dwordx4 v[48:51], v3, s[40:43], s52 offen offset:2048
    buffer_load_dwordx4 v[52:55], v3, s[40:43], s52 offen offset:3072
    s_add_u32 s52, s52, 4096
    buffer_load_dwordx4 v[56:59], v3, s[40:43], s52 offen offset:0
    buffer_load_dwordx4 v[60:63], v3, s[40:43], s52 offen offset:1024
    buffer_load_dwordx4 v[64:67], v3, s[40:43], s52 offen offset:2048
    buffer_load_dwordx4 v[68:71], v3, s[40:43], s52 offen offset:3072
    s_add_u32 s52, s52, 4096
    buffer_load_dwordx4 v[72:75], v3, s[40:43], s52 offen offset:0
    buffer_load_dwordx4 v[76:79], v3, s[40:43], s52 offen offset:1024
    buffer_load_dwordx4 v[80:83], v3, s[40:43], s52 offen offset:2048
    buffer_load_dwordx4 v[84:87], v3, s[40:43], s52 offen offset:3072
    s_add_u32 s52, s52, 4096
    buffer_load_dwordx4 v[88:91], v3, s[40:43], s52 offen offset:0
    buffer_load_dwordx4 v[92:95], v3, s[40:43], s52 offen offset:1024
    buffer_load_dwordx4 v[96:99], v3, s[40:43], s52 offen offset:2048
    buffer_load_dwordx4 v[100:103], v3, s[40:43], s52 offen offset:3072
    s_add_u32 s52, s52, 4096
    buffer_load_dwordx4 v[104:107], v3, s[40:43], s52 offen offset:0
    buffer_load_dwordx4 v[108:111], v3, s[40:43], s52 offen offset:1024
    s_waitcnt vmcnt(0)
k2_pf_done:
    s_endpgm
k2_kernel_end:
    s_endpgm
.p2align 8
.globl k345_kernel
.type k345_kernel,@function
k345_kernel:
    s_cmp_ge_u32 s2, 256
    s_cbranch_scc1 k345_kernel_end
    s_load_dwordx16 s[16:31], s[0:1], 0
    s_load_dwordx8 s[32:39], s[0:1], 64
    v_lshrrev_b32 v1, 6, v0
    v_and_b32 v2, 63, v0
    s_and_b32 s4, s2, 7
    s_lshl_b32 s4, s4, 2
    s_bfe_u32 s5, s2, 0x20003
    s_add_u32 s4, s4, s5
    s_lshr_b32 s5, s2, 5
    v_readfirstlane_b32 s3, v1
    v_lshlrev_b32 v3, 4, v2
    v_lshrrev_b32 v4, 5, v2
    s_lshr_b32 s6, s3, 1
    s_and_b32 s7, s3, 1
    s_and_b32 s8, s2, 3
    s_bfe_u32 s9, s2, 0x20003
    s_lshl_b32 s8, s8, 2
    s_add_u32 s8, s8, s9
    s_bfe_u32 s9, s2, 0x10002
    s_lshl_b32 s9, s9, 3
    s_lshr_b32 s63, s2, 5
    s_add_u32 s9, s9, s63
    s_lshl_b32 s10, s3, 10
    s_lshl_b32 s11, s3, 11
    s_min_u32 s98, s8, 11
    s_lshl_b32 s63, s8, 1
    s_add_u32 s98, s98, s63
    s_lshl_b32 s63, s98, 16
    s_add_u32 s63, s63, 0x500000
    s_add_u32 s96, s63, s10
    s_add_u32 s97, s63, s11
    s_lshl_b32 s99, s9, 2
    s_add_u32 s99, s99, s3
    s_add_u32 s63, s8, s9
    s_mov_b32 s62, 0
    s_lshl_b32 s62, s62, 13
    v_add_u32 v192, s62, v3
    s_mov_b32 s62, 1
    s_lshl_b32 s62, s62, 13
    v_add_u32 v193, s62, v3
    s_mov_b32 s62, 2
    s_lshl_b32 s62, s62, 13
    v_add_u32 v194, s62, v3
    s_mov_b32 s62, 3
    s_lshl_b32 s62, s62, 13
    v_add_u32 v195, s62, v3
    s_mov_b32 s60, -1
    s_mov_b32 s61, -1
    s_mul_i32 s55, s3, 22
    s_cmp_eq_u32 s3, 3
    s_cselect_b32 s63, 1, 0
    s_sub_u32 s55, s55, s63
    v_and_b32 v5, 0x13, v2
    v_lshrrev_b32 v6, 1, v2
    v_and_b32 v6, 4, v6
    v_lshlrev_b32 v7, 1, v2
    v_and_b32 v7, 8, v7
    v_or3_b32 v5, v5, v6, v7
    v_lshlrev_b32 v10, 10, v5
    v_lshl_add_u32 v10, v4, 4, v10
    v_lshlrev_b32 v9, 5, v4
    v_lshlrev_b32 v8, 3, v5
    v_lshl_add_u32 v6, v4, 17, v8
    v_and_b32 v7, 31, v2
    v_lshlrev_b32 v1, 2, v7
    v_lshlrev_b32 v7, 7, v7
    v_lshl_add_u32 v7, v4, 6, v7
    v_add_u32 v11, 0x10000, v3
    v_add_u32 v12, 0x20000, v3
    v_mov_b32 v13, 155680
    v_mov_b32 v14, 0
    ds_write_b32 v13, v14
    s_waitcnt lgkmcnt(0)
    s_mov_b32 s40, s38
    s_and_b32 s41, s39, 0xffff
    s_mov_b32 s42, 0x2200000
    s_mov_b32 s43, 0x20000
    s_mov_b32 s44, s16
    s_and_b32 s45, s17, 0xffff
    s_mov_b32 s46, 0x200000
    s_mov_b32 s47, 0x20000
    s_mov_b32 s56, s34
    s_and_b32 s57, s35, 0xffff
    s_mov_b32 s58, 0x200000
    s_mov_b32 s59, 0x20000
    s_lshl_b32 s28, s4, 3
    s_add_u32 s28, s28, s5
    s_lshl_b32 s28, s28, 7
    s_add_u32 s28, s28, 0x88000
    s_mul_i32 s20, s3, 3
    s_add_u32 s21, s20, 1
    s_add_u32 s22, s20, 2
    s_add_u32 s23, s3, 11
    s_cmp_eq_u32 s3, 3
    s_cselect_b32 s22, 14, s22
    s_cselect_b32 s30, 0, 4096
    s_cselect_b32 s23, 15, s23
    s_min_u32 s16, s20, 11
    s_lshl_b32 s63, s20, 1
    s_add_u32 s16, s16, s63
    s_lshl_b32 s16, s16, 11
    s_min_u32 s17, s21, 11
    s_lshl_b32 s63, s21, 1
    s_add_u32 s17, s17, s63
    s_lshl_b32 s17, s17, 11
    s_min_u32 s18, s22, 11
    s_lshl_b32 s63, s22, 1
    s_add_u32 s18, s18, s63
    s_lshl_b32 s18, s18, 11
    s_min_u32 s19, s23, 11
    s_lshl_b32 s63, s23, 1
    s_add_u32 s19, s19, s63
    s_lshl_b32 s19, s19, 11
k345_p3:
    s_lshl_b32 s14, s4, 1
    s_add_u32 s14, s14, s6
    s_lshl_b32 s15, s5, 1
    s_add_u32 s15, s15, s7
    s_lshl_b32 s13, s3, 13
    s_lshl_b32 s48, s14, 15
    s_add_u32 s48, s48, s13
    s_add_u32 s48, s48, 0x1000000
    s_xor_b32 s49, s48, 0x8000
    s_lshl_b32 s50, s15, 15
    s_add_u32 s50, s50, s13
    s_add_u32 s50, s50, 0x480000
    s_xor_b32 s51, s50, 0x8000
    s_lshl_b32 s12, s4, 1
    s_add_u32 s12, s12, s5
    s_and_b32 s12, s12, 7
    s_lshl_b32 s12, s12, 10
    s_mov_b32 s52, s12
    v_add_u32 v13, s52, v3
    s_add_u32 s52, s52, 1024
    s_and_b32 s52, s52, 0x1fff
    buffer_load_dwordx4 a[0:3], v13, s[40:43], s48 offen
    buffer_load_dwordx4 a[4:7], v13, s[40:43], s49 offen
    buffer_load_dwordx4 a[8:11], v13, s[40:43], s50 offen
    buffer_load_dwordx4 a[12:15], v13, s[40:43], s51 offen
    v_add_u32 v13, s52, v3
    s_add_u32 s52, s52, 1024
    s_and_b32 s52, s52, 0x1fff
    buffer_load_dwordx4 a[16:19], v13, s[40:43], s48 offen
    buffer_load_dwordx4 a[20:23], v13, s[40:43], s49 offen
    buffer_load_dwordx4 a[24:27], v13, s[40:43], s50 offen
    buffer_load_dwordx4 a[28:31], v13, s[40:43], s51 offen
    v_add_u32 v13, s52, v3
    s_add_u32 s52, s52, 1024
    s_and_b32 s52, s52, 0x1fff
    buffer_load_dwordx4 a[32:35], v13, s[40:43], s48 offen
    buffer_load_dwordx4 a[36:39], v13, s[40:43], s49 offen
    buffer_load_dwordx4 a[40:43], v13, s[40:43], s50 offen
    buffer_load_dwordx4 a[44:47], v13, s[40:43], s51 offen
    s_waitcnt vmcnt(8)
    v_mfma_f32_32x32x16_bf16 v[64:79], a[8:11], a[0:3], 0
    v_mfma_f32_32x32x16_bf16 v[80:95], a[12:15], a[0:3], 0
    v_mfma_f32_32x32x16_bf16 v[96:111], a[8:11], a[4:7], 0
    v_mfma_f32_32x32x16_bf16 v[112:127], a[12:15], a[4:7], 0
    v_add_u32 v13, s52, v3
    s_add_u32 s52, s52, 1024
    s_and_b32 s52, s52, 0x1fff
    buffer_load_dwordx4 a[48:51], v13, s[40:43], s48 offen
    buffer_load_dwordx4 a[52:55], v13, s[40:43], s49 offen
    buffer_load_dwordx4 a[56:59], v13, s[40:43], s50 offen
    buffer_load_dwordx4 a[60:63], v13, s[40:43], s51 offen
    s_waitcnt vmcnt(8)
    v_mfma_f32_32x32x16_bf16 v[64:79], a[24:27], a[16:19], v[64:79]
    v_mfma_f32_32x32x16_bf16 v[80:95], a[28:31], a[16:19], v[80:95]
    v_mfma_f32_32x32x16_bf16 v[96:111], a[24:27], a[20:23], v[96:111]
    v_mfma_f32_32x32x16_bf16 v[112:127], a[28:31], a[20:23], v[112:127]
    v_add_u32 v13, s52, v3
    s_add_u32 s52, s52, 1024
    s_and_b32 s52, s52, 0x1fff
    buffer_load_dwordx4 a[64:67], v13, s[40:43], s48 offen
    buffer_load_dwordx4 a[68:71], v13, s[40:43], s49 offen
    buffer_load_dwordx4 a[72:75], v13, s[40:43], s50 offen
    buffer_load_dwordx4 a[76:79], v13, s[40:43], s51 offen
    s_waitcnt vmcnt(8)
    v_mfma_f32_32x32x16_bf16 v[64:79], a[40:43], a[32:35], v[64:79]
    v_mfma_f32_32x32x16_bf16 v[80:95], a[44:47], a[32:35], v[80:95]
    v_mfma_f32_32x32x16_bf16 v[96:111], a[40:43], a[36:39], v[96:111]
    v_mfma_f32_32x32x16_bf16 v[112:127], a[44:47], a[36:39], v[112:127]
    v_add_u32 v13, s52, v3
    s_add_u32 s52, s52, 1024
    s_and_b32 s52, s52, 0x1fff
    buffer_load_dwordx4 a[80:83], v13, s[40:43], s48 offen
    buffer_load_dwordx4 a[84:87], v13, s[40:43], s49 offen
    buffer_load_dwordx4 a[88:91], v13, s[40:43], s50 offen
    buffer_load_dwordx4 a[92:95], v13, s[40:43], s51 offen
    s_waitcnt vmcnt(8)
    v_mfma_f32_32x32x16_bf16 v[64:79], a[56:59], a[48:51], v[64:79]
    v_mfma_f32_32x32x16_bf16 v[80:95], a[60:63], a[48:51], v[80:95]
    v_mfma_f32_32x32x16_bf16 v[96:111], a[56:59], a[52:55], v[96:111]
    v_mfma_f32_32x32x16_bf16 v[112:127], a[60:63], a[52:55], v[112:127]
    v_add_u32 v13, s52, v3
    s_add_u32 s52, s52, 1024
    s_and_b32 s52, s52, 0x1fff
    buffer_load_dwordx4 a[96:99], v13, s[40:43], s48 offen
    buffer_load_dwordx4 a[100:103], v13, s[40:43], s49 offen
    buffer_load_dwordx4 a[104:107], v13, s[40:43], s50 offen
    buffer_load_dwordx4 a[108:111], v13, s[40:43], s51 offen
    s_waitcnt vmcnt(8)
    v_mfma_f32_32x32x16_bf16 v[64:79], a[72:75], a[64:67], v[64:79]
    v_mfma_f32_32x32x16_bf16 v[80:95], a[76:79], a[64:67], v[80:95]
    v_mfma_f32_32x32x16_bf16 v[96:111], a[72:75], a[68:71], v[96:111]
    v_mfma_f32_32x32x16_bf16 v[112:127], a[76:79], a[68:71], v[112:127]
    v_add_u32 v13, s52, v3
    s_add_u32 s52, s52, 1024
    s_and_b32 s52, s52, 0x1fff
    buffer_load_dwordx4 a[112:115], v13, s[40:43], s48 offen
    buffer_load_dwordx4 a[116:119], v13, s[40:43], s49 offen
    buffer_load_dwordx4 a[120:123], v13, s[40:43], s50 offen
    buffer_load_dwordx4 a[124:127], v13, s[40:43], s51 offen
    s_lshl_b32 s12, s14, 15
    s_lshl_b32 s13, s15, 6
    s_add_u32 s12, s12, s13
    buffer_load_dwordx4 v[16:19], v10, s[44:47], s12 offen
    buffer_load_dwordx4 v[20:23], v10, s[44:47], s12 offen offset:32
    s_lshl_b32 s13, s15, 7
    s_add_u32 s12, s13, 4096
    s_add_u32 s13, s13, 24576
    buffer_load_dwordx4 v[24:27], v9, s[40:43], s12 offen offset:0
    buffer_load_dwordx4 v[28:31], v9, s[40:43], s12 offen offset:16
    buffer_load_dwordx4 v[32:35], v9, s[40:43], s12 offen offset:64
    buffer_load_dwordx4 v[36:39], v9, s[40:43], s12 offen offset:80
    buffer_load_dwordx4 v[40:43], v9, s[40:43], s13 offen offset:0
    buffer_load_dwordx4 v[44:47], v9, s[40:43], s13 offen offset:16
    buffer_load_dwordx4 v[48:51], v9, s[40:43], s13 offen offset:64
    buffer_load_dwordx4 v[52:55], v9, s[40:43], s13 offen offset:80
    s_lshl_b32 s12, s98, 1
    s_add_u32 s12, s12, s3
    s_lshl_b32 s12, s12, 12
    s_add_u32 s12, s12, 0x300000
    buffer_load_dwordx4 v[196:199], v3, s[40:43], s12 offen offset:0
    buffer_load_dwordx4 v[200:203], v3, s[40:43], s12 offen offset:1024
    buffer_load_dwordx4 v[204:207], v3, s[40:43], s12 offen offset:2048
    buffer_load_dwordx4 v[208:211], v3, s[40:43], s12 offen offset:3072
    s_add_u32 s12, s12, 16384
    buffer_load_dwordx4 v[212:215], v3, s[40:43], s12 offen offset:0
    buffer_load_dwordx4 v[216:219], v3, s[40:43], s12 offen offset:1024
    buffer_load_dwordx4 v[220:223], v3, s[40:43], s12 offen offset:2048
    buffer_load_dwordx4 v[224:227], v3, s[40:43], s12 offen offset:3072
    s_barrier
    s_waitcnt vmcnt(26)
    v_mfma_f32_32x32x16_bf16 v[64:79], a[88:91], a[80:83], v[64:79]
    v_mfma_f32_32x32x16_bf16 v[80:95], a[92:95], a[80:83], v[80:95]
    v_mfma_f32_32x32x16_bf16 v[96:111], a[88:91], a[84:87], v[96:111]
    v_mfma_f32_32x32x16_bf16 v[112:127], a[92:95], a[84:87], v[112:127]
    s_waitcnt vmcnt(22)
    v_mfma_f32_32x32x16_bf16 v[64:79], a[104:107], a[96:99], v[64:79]
    v_mfma_f32_32x32x16_bf16 v[80:95], a[108:111], a[96:99], v[80:95]
    v_mfma_f32_32x32x16_bf16 v[96:111], a[104:107], a[100:103], v[96:111]
    v_mfma_f32_32x32x16_bf16 v[112:127], a[108:111], a[100:103], v[112:127]
    s_waitcnt vmcnt(18)
    v_mfma_f32_32x32x16_bf16 v[64:79], a[120:123], a[112:115], v[64:79]
    v_mfma_f32_32x32x16_bf16 v[80:95], a[124:127], a[112:115], v[80:95]
    v_mfma_f32_32x32x16_bf16 v[96:111], a[120:123], a[116:119], v[96:111]
    v_mfma_f32_32x32x16_bf16 v[112:127], a[124:127], a[116:119], v[112:127]
    s_xor_b32 s13, s3, 1
    s_mul_i32 s13, s13, 3
    s_add_u32 s13, s13, 24
    s_lshl_b32 s13, s13, 12
    v_add_u32 v13, s13, v3
    s_nop 4
    ds_write_b128 v13, v[80:83] offset:0
    ds_write_b128 v13, v[84:87] offset:1024
    ds_write_b128 v13, v[88:91] offset:2048
    ds_write_b128 v13, v[92:95] offset:3072
    s_xor_b32 s13, s3, 2
    s_mul_i32 s13, s13, 3
    s_add_u32 s13, s13, 25
    s_lshl_b32 s13, s13, 12
    v_add_u32 v14, s13, v3
    ds_write_b128 v14, v[96:99] offset:0
    ds_write_b128 v14, v[100:103] offset:1024
    ds_write_b128 v14, v[104:107] offset:2048
    ds_write_b128 v14, v[108:111] offset:3072
    s_xor_b32 s13, s3, 3
    s_mul_i32 s13, s13, 3
    s_add_u32 s13, s13, 26
    s_lshl_b32 s13, s13, 12
    v_add_u32 v15, s13, v3
    ds_write_b128 v15, v[112:115] offset:0
    ds_write_b128 v15, v[116:119] offset:1024
    ds_write_b128 v15, v[120:123] offset:2048
    ds_write_b128 v15, v[124:127] offset:3072
    s_mul_i32 s13, s3, 12288
    s_add_u32 s13, s13, 98304
    v_add_u32 v13, s13, v3
    s_add_u32 m0, s10, 0
    s_add_u32 s63, s96, 0
    buffer_load_dwordx4 v192, s[40:43], s63 offen lds
    s_add_u32 m0, s10, 4096
    s_add_u32 s63, s96, 32768
    buffer_load_dwordx4 v192, s[40:43], s63 offen lds
    s_add_u32 m0, s10, 8192
    s_add_u32 s63, s96, 65536
    buffer_load_dwordx4 v192, s[40:43], s63 offen lds
    s_add_u32 m0, s10, 12288
    s_add_u32 s63, s96, 98304
    buffer_load_dwordx4 v192, s[40:43], s63 offen lds
    s_waitcnt lgkmcnt(0)
    s_barrier
    ds_read_b128 v[144:147], v13 offset:0
    ds_read_b128 v[148:151], v13 offset:1024
    ds_read_b128 v[152:155], v13 offset:2048
    ds_read_b128 v[156:159], v13 offset:3072
    ds_read_b128 v[160:163], v13 offset:4096
    ds_read_b128 v[164:167], v13 offset:5120
    ds_read_b128 v[168:171], v13 offset:6144
    ds_read_b128 v[172:175], v13 offset:7168
    ds_read_b128 v[176:179], v13 offset:8192
    ds_read_b128 v[180:183], v13 offset:9216
    ds_read_b128 v[184:187], v13 offset:10240
    ds_read_b128 v[188:191], v13 offset:11264
    s_add_u32 m0, s10, 16384
    s_add_u32 s63, s96, 4096
    buffer_load_dwordx4 v192, s[40:43], s63 offen lds
    s_add_u32 m0, s10, 20480
    s_add_u32 s63, s96, 36864
    buffer_load_dwordx4 v192, s[40:43], s63 offen lds
    s_add_u32 m0, s10, 24576
    s_add_u32 s63, s96, 69632
    buffer_load_dwordx4 v192, s[40:43], s63 offen lds
    s_add_u32 m0, s10, 28672
    s_add_u32 s63, s96, 102400
    buffer_load_dwordx4 v192, s[40:43], s63 offen lds
    s_waitcnt lgkmcnt(8)
    v_pk_add_f32 v[64:65], v[64:65], v[144:145]
    v_pk_add_f32 v[66:67], v[66:67], v[146:147]
    v_pk_add_f32 v[68:69], v[68:69], v[148:149]
    v_pk_add_f32 v[70:71], v[70:71], v[150:151]
    v_pk_add_f32 v[72:73], v[72:73], v[152:153]
    v_pk_add_f32 v[74:75], v[74:75], v[154:155]
    v_pk_add_f32 v[76:77], v[76:77], v[156:157]
    v_pk_add_f32 v[78:79], v[78:79], v[158:159]
    s_waitcnt lgkmcnt(4)
    v_pk_add_f32 v[64:65], v[64:65], v[160:161]
    v_pk_add_f32 v[66:67], v[66:67], v[162:163]
    v_pk_add_f32 v[68:69], v[68:69], v[164:165]
    v_pk_add_f32 v[70:71], v[70:71], v[166:167]
    v_pk_add_f32 v[72:73], v[72:73], v[168:169]
    v_pk_add_f32 v[74:75], v[74:75], v[170:171]
    v_pk_add_f32 v[76:77], v[76:77], v[172:173]
    v_pk_add_f32 v[78:79], v[78:79], v[174:175]
    s_waitcnt lgkmcnt(0)
    v_pk_add_f32 v[64:65], v[64:65], v[176:177]
    v_pk_add_f32 v[66:67], v[66:67], v[178:179]
    v_pk_add_f32 v[68:69], v[68:69], v[180:181]
    v_pk_add_f32 v[70:71], v[70:71], v[182:183]
    v_pk_add_f32 v[72:73], v[72:73], v[184:185]
    v_pk_add_f32 v[74:75], v[74:75], v[186:187]
    v_pk_add_f32 v[76:77], v[76:77], v[188:189]
    v_pk_add_f32 v[78:79], v[78:79], v[190:191]
    s_barrier
    s_waitcnt vmcnt(16)
    v_lshlrev_b32 v144, 16, v16
    v_and_b32 v145, 0xffff0000, v16
    v_pk_fma_f32 v[64:65], v[64:65], v[24:25], v[144:145]
    v_cvt_pk_bf16_f32 v160, v64, v65
    v_pk_mul_f32 v[178:179], v[64:65], v[64:65]
    v_pk_mul_f32 v[148:149], v[64:65], v[40:41]
    v_cvt_pk_bf16_f32 v168, v148, v149
    s_add_u32 m0, s10, 32768
    s_add_u32 s63, s96, 0
    buffer_load_dwordx4 v193, s[40:43], s63 offen lds
    s_add_u32 m0, s10, 36864
    s_add_u32 s63, s96, 32768
    buffer_load_dwordx4 v193, s[40:43], s63 offen lds
    v_lshlrev_b32 v146, 16, v17
    v_and_b32 v147, 0xffff0000, v17
    v_pk_fma_f32 v[66:67], v[66:67], v[26:27], v[146:147]
    v_cvt_pk_bf16_f32 v161, v66, v67
    v_pk_fma_f32 v[178:179], v[66:67], v[66:67], v[178:179]
    v_pk_mul_f32 v[148:149], v[66:67], v[42:43]
    v_pk_add_f32 v[64:65], v[64:65], v[66:67]
    v_cvt_pk_bf16_f32 v169, v148, v149
    s_add_u32 m0, s10, 40960
    s_add_u32 s63, s96, 65536
    buffer_load_dwordx4 v193, s[40:43], s63 offen lds
    s_add_u32 m0, s10, 45056
    s_add_u32 s63, s96, 98304
    buffer_load_dwordx4 v193, s[40:43], s63 offen lds
    v_lshlrev_b32 v144, 16, v18
    v_and_b32 v145, 0xffff0000, v18
    v_pk_fma_f32 v[68:69], v[68:69], v[28:29], v[144:145]
    v_cvt_pk_bf16_f32 v162, v68, v69
    v_pk_fma_f32 v[178:179], v[68:69], v[68:69], v[178:179]
    v_pk_mul_f32 v[148:149], v[68:69], v[44:45]
    v_pk_add_f32 v[64:65], v[64:65], v[68:69]
    v_cvt_pk_bf16_f32 v170, v148, v149
    s_add_u32 m0, s10, 49152
    s_add_u32 s63, s96, 4096
    buffer_load_dwordx4 v193, s[40:43], s63 offen lds
    s_add_u32 m0, s10, 53248
    s_add_u32 s63, s96, 36864
    buffer_load_dwordx4 v193, s[40:43], s63 offen lds
    v_lshlrev_b32 v146, 16, v19
    v_and_b32 v147, 0xffff0000, v19
    v_pk_fma_f32 v[70:71], v[70:71], v[30:31], v[146:147]
    v_cvt_pk_bf16_f32 v163, v70, v71
    v_pk_fma_f32 v[178:179], v[70:71], v[70:71], v[178:179]
    v_pk_mul_f32 v[148:149], v[70:71], v[46:47]
    v_pk_add_f32 v[64:65], v[64:65], v[70:71]
    v_cvt_pk_bf16_f32 v171, v148, v149
    s_add_u32 m0, s10, 57344
    s_add_u32 s63, s96, 69632
    buffer_load_dwordx4 v193, s[40:43], s63 offen lds
    s_add_u32 m0, s10, 61440
    s_add_u32 s63, s96, 102400
    buffer_load_dwordx4 v193, s[40:43], s63 offen lds
    v_lshlrev_b32 v144, 16, v20
    v_and_b32 v145, 0xffff0000, v20
    v_pk_fma_f32 v[72:73], v[72:73], v[32:33], v[144:145]
    v_cvt_pk_bf16_f32 v164, v72, v73
    v_pk_fma_f32 v[178:179], v[72:73], v[72:73], v[178:179]
    v_pk_mul_f32 v[148:149], v[72:73], v[48:49]
    v_pk_add_f32 v[64:65], v[64:65], v[72:73]
    v_cvt_pk_bf16_f32 v172, v148, v149
    s_add_u32 m0, s10, 65536
    s_add_u32 s63, s96, 0
    buffer_load_dwordx4 v194, s[40:43], s63 offen lds
    s_add_u32 m0, s10, 69632
    s_add_u32 s63, s96, 32768
    buffer_load_dwordx4 v194, s[40:43], s63 offen lds
    v_lshlrev_b32 v146, 16, v21
    v_and_b32 v147, 0xffff0000, v21
    v_pk_fma_f32 v[74:75], v[74:75], v[34:35], v[146:147]
    v_cvt_pk_bf16_f32 v165, v74, v75
    v_pk_fma_f32 v[178:179], v[74:75], v[74:75], v[178:179]
    v_pk_mul_f32 v[148:149], v[74:75], v[50:51]
    v_pk_add_f32 v[64:65], v[64:65], v[74:75]
    v_cvt_pk_bf16_f32 v173, v148, v149
    s_add_u32 m0, s10, 73728
    s_add_u32 s63, s96, 65536
    buffer_load_dwordx4 v194, s[40:43], s63 offen lds
    s_add_u32 m0, s10, 77824
    s_add_u32 s63, s96, 98304
    buffer_load_dwordx4 v194, s[40:43], s63 offen lds
    v_lshlrev_b32 v144, 16, v22
    v_and_b32 v145, 0xffff0000, v22
    v_pk_fma_f32 v[76:77], v[76:77], v[36:37], v[144:145]
    v_cvt_pk_bf16_f32 v166, v76, v77
    v_pk_fma_f32 v[178:179], v[76:77], v[76:77], v[178:179]
    v_pk_mul_f32 v[148:149], v[76:77], v[52:53]
    v_pk_add_f32 v[64:65], v[64:65], v[76:77]
    v_cvt_pk_bf16_f32 v174, v148, v149
    s_add_u32 m0, s10, 81920
    s_add_u32 s63, s96, 4096
    buffer_load_dwordx4 v194, s[40:43], s63 offen lds
    s_add_u32 m0, s10, 86016
    s_add_u32 s63, s96, 36864
    buffer_load_dwordx4 v194, s[40:43], s63 offen lds
    v_lshlrev_b32 v146, 16, v23
    v_and_b32 v147, 0xffff0000, v23
    v_pk_fma_f32 v[78:79], v[78:79], v[38:39], v[146:147]
    v_cvt_pk_bf16_f32 v167, v78, v79
    v_pk_fma_f32 v[178:179], v[78:79], v[78:79], v[178:179]
    v_pk_mul_f32 v[148:149], v[78:79], v[54:55]
    v_pk_add_f32 v[64:65], v[64:65], v[78:79]
    v_cvt_pk_bf16_f32 v175, v148, v149
    s_add_u32 m0, s10, 90112
    s_add_u32 s63, s96, 69632
    buffer_load_dwordx4 v194, s[40:43], s63 offen lds
    s_add_u32 m0, s10, 94208
    s_add_u32 s63, s96, 102400
    buffer_load_dwordx4 v194, s[40:43], s63 offen lds
    v_add_f32 v176, v64, v65
    v_add_f32 v177, v178, v179
    s_lshl_b32 s12, s14, 15
    s_lshl_b32 s13, s15, 11
    s_add_u32 s13, s13, s12
    s_add_u32 s12, s13, 0x1200000
    s_add_u32 s13, s13, 0x1400000
    buffer_store_dwordx4 v[168:171], v3, s[40:43], s13 offen sc1
    buffer_store_dwordx4 v[172:175], v3, s[40:43], s13 offen offset:1024 sc1
    v_mov_b32 v178, v176
    v_mov_b32 v179, v177
    s_nop 0
    v_permlane32_swap_b32 v176, v178
    v_permlane32_swap_b32 v177, v179
    v_add_f32 v176, v176, v178
    v_add_f32 v177, v177, v179
    s_lshl_b32 s13, s15, 14
    s_lshl_b32 s63, s14, 8
    s_add_u32 s13, s13, s63
    s_add_u32 s13, s13, 0x10000
    buffer_store_dwordx2 v[176:177], v8, s[40:43], s13 offen sc1
    s_lshr_b32 s13, s4, 1
    s_lshl_b32 s13, s13, 11
    s_and_b32 s63, s4, 1
    s_lshl_b32 s63, s63, 3
    s_add_u32 s63, s63, s5
    s_lshl_b32 s63, s63, 2
    s_add_u32 s13, s13, s63
    s_add_u32 s13, s13, 0x80000
    s_waitcnt vmcnt(0)
    v_mov_b32 v13, 1
    v_mov_b32 v14, 155680
    s_mov_b64 exec, 1
    ds_add_rtn_u32 v15, v14, v13
    s_mov_b64 exec, 0xffff
    v_lshlrev_b32 v14, 7, v2
    s_waitcnt lgkmcnt(0)
    v_readfirstlane_b32 s63, v15
    s_nop 0
    s_and_b32 s63, s63, 3
    s_cmp_lg_u32 s63, 3
    s_cbranch_scc1 k345_f3
    buffer_store_dword v13, v14, s[40:43], s13 offen sc1
k345_f3:
    s_mov_b64 exec, -1
    buffer_store_dwordx4 v[160:163], v3, s[40:43], s12 offen sc1
    buffer_store_dwordx4 v[164:167], v3, s[40:43], s12 offen offset:1024 sc1
    s_cmp_lt_i32 s60, 0
    s_cbranch_scc1 k345_p4
    s_add_u32 s60, s60, 1
    s_cmp_lt_u32 s60, 16
    s_cbranch_scc1 k345_h3next
    s_mov_b32 s60, -1
    s_branch k345_p4
k345_h3next:
    s_lshl_b32 s4, s9, 1
    s_lshr_b32 s5, s60, 3
    s_add_u32 s4, s4, s5
    s_and_b32 s5, s60, 7
    s_branch k345_p3
k345_p4:
    s_cmp_ge_u32 s8, 11
    s_cbranch_scc1 k345_two
    s_add_u32 m0, s10, 98304
    s_add_u32 s63, s96, 0
    buffer_load_dwordx4 v195, s[40:43], s63 offen lds
    s_add_u32 m0, s10, 102400
    s_add_u32 s63, s96, 32768
    buffer_load_dwordx4 v195, s[40:43], s63 offen lds
    s_add_u32 m0, s10, 106496
    s_add_u32 s63, s96, 65536
    buffer_load_dwordx4 v195, s[40:43], s63 offen lds
    s_add_u32 m0, s10, 110592
    s_add_u32 s63, s96, 98304
    buffer_load_dwordx4 v195, s[40:43], s63 offen lds
    s_add_u32 m0, s10, 114688
    s_add_u32 s63, s96, 4096
    buffer_load_dwordx4 v195, s[40:43], s63 offen lds
    s_add_u32 m0, s10, 118784
    s_add_u32 s63, s96, 36864
    buffer_load_dwordx4 v195, s[40:43], s63 offen lds
    s_add_u32 m0, s10, 122880
    s_add_u32 s63, s96, 69632
    buffer_load_dwordx4 v195, s[40:43], s63 offen lds
    s_add_u32 m0, s10, 126976
    s_add_u32 s63, s96, 102400
    buffer_load_dwordx4 v195, s[40:43], s63 offen lds
    s_add_u32 m0, s11, 131072
    s_add_u32 s63, s97, 131072
    buffer_load_dwordx4 v192, s[40:43], s63 offen lds
    s_add_u32 m0, s11, 132096
    s_add_u32 s63, s97, 132096
    buffer_load_dwordx4 v192, s[40:43], s63 offen lds
    s_add_u32 m0, s11, 139264
    s_add_u32 s63, s97, 163840
    buffer_load_dwordx4 v192, s[40:43], s63 offen lds
    s_add_u32 m0, s11, 140288
    s_add_u32 s63, s97, 164864
    buffer_load_dwordx4 v192, s[40:43], s63 offen lds
    s_lshl_b32 s13, s3, 10
    s_add_u32 s13, s13, 147456
    v_add_u32 v15, s13, v3
    v_cmp_gt_u32 vcc, 32, v2
    v_pk_add_f32 v[196:197], v[196:197], v[204:205]
    v_pk_add_f32 v[198:199], v[198:199], v[206:207]
    v_pk_add_f32 v[200:201], v[200:201], v[208:209]
    v_pk_add_f32 v[202:203], v[202:203], v[210:211]
    v_pk_add_f32 v[196:197], v[196:197], v[200:201]
    v_pk_add_f32 v[198:199], v[198:199], v[202:203]
    v_pk_add_f32 v[196:197], v[196:197], v[198:199]
    v_mov_b32 v198, v196
    v_mov_b32 v199, v197
    s_nop 0
    v_permlane32_swap_b32 v196, v198
    v_permlane32_swap_b32 v197, v199
    v_pk_add_f32 v[196:197], v[196:197], v[198:199]
    v_cndmask_b32 v196, 0, v196, vcc
    v_cndmask_b32 v197, 0, v197, vcc
    v_cvt_pk_bf16_f32 v200, v196, v197
    v_lshlrev_b32 v198, 16, v200
    v_and_b32 v199, 0xffff0000, v200
    v_sub_f32 v196, v196, v198
    v_sub_f32 v197, v197, v199
    v_cvt_pk_bf16_f32 v201, v196, v197
    v_lshlrev_b32 v198, 16, v201
    v_and_b32 v199, 0xffff0000, v201
    v_sub_f32 v196, v196, v198
    v_sub_f32 v197, v197, v199
    v_cvt_pk_bf16_f32 v202, v196, v197
    v_mov_b32 v203, 0
    ds_write_b128 v15, v[200:203] offset:0
    v_pk_add_f32 v[212:213], v[212:213], v[220:221]
    v_pk_add_f32 v[214:215], v[214:215], v[222:223]
    v_pk_add_f32 v[216:217], v[216:217], v[224:225]
    v_pk_add_f32 v[218:219], v[218:219], v[226:227]
    v_pk_add_f32 v[212:213], v[212:213], v[216:217]
    v_pk_add_f32 v[214:215], v[214:215], v[218:219]
    v_pk_add_f32 v[212:213], v[212:213], v[214:215]
    v_mov_b32 v214, v212
    v_mov_b32 v215, v213
    s_nop 0
    v_permlane32_swap_b32 v212, v214
    v_permlane32_swap_b32 v213, v215
    v_pk_add_f32 v[212:213], v[212:213], v[214:215]
    v_cndmask_b32 v212, 0, v212, vcc
    v_cndmask_b32 v213, 0, v213, vcc
    v_cvt_pk_bf16_f32 v216, v212, v213
    v_lshlrev_b32 v214, 16, v216
    v_and_b32 v215, 0xffff0000, v216
    v_sub_f32 v212, v212, v214
    v_sub_f32 v213, v213, v215
    v_cvt_pk_bf16_f32 v217, v212, v213
    v_lshlrev_b32 v214, 16, v217
    v_and_b32 v215, 0xffff0000, v217
    v_sub_f32 v212, v212, v214
    v_sub_f32 v213, v213, v215
    v_cvt_pk_bf16_f32 v218, v212, v213
    v_mov_b32 v219, 0
    ds_write_b128 v15, v[216:219] offset:4096
    s_lshl_b32 s12, s99, 8
    s_add_u32 s12, s12, 0x10000
    s_lshl_b32 s50, s99, 15
    s_add_u32 s50, s50, 0x1400000
    s_add_u32 s51, s50, 4096
    s_mul_i32 s13, s99, 86
    s_lshl_b32 s63, s98, 1
    s_add_u32 s13, s13, s63
    s_lshl_b32 s13, s13, 10
    s_add_u32 s52, s13, 0x1600000
    s_add_u32 s53, s13, 0x1600800
    s_add_u32 s54, s13, 0x1601000
    s_lshl_b32 s13, s9, 4
    s_add_u32 s13, s13, s8
    s_lshl_b32 s13, s13, 7
    s_add_u32 s13, s13, 0x80000
    s_mov_b32 s14, 0xffff
    s_mov_b32 s15, 0
    s_mov_b32 s62, 0
    s_cmp_lg_u32 s3, 0
    s_cbranch_scc1 k345_b3_poll_ok
    v_mov_b32 v5, 0
k345_b3_poll:
    buffer_load_dword v5, v1, s[40:43], s13 offen sc1
    s_sleep 1
    s_waitcnt vmcnt(24)
    v_cmp_eq_u32 vcc, 1, v5
    s_nop 0
    s_and_b64 vcc, vcc, s[14:15]
    s_cmp_eq_u64 vcc, s[14:15]
    s_cbranch_scc1 k345_b3_poll_ok
    s_add_u32 s62, s62, 1
    s_cmp_lt_u32 s62, 16000
    s_nop 0
    s_cbranch_scc1 k345_b3_poll
    s_mov_b32 s62, 1
    s_branch k345_b3_poll_to
k345_b3_poll_ok:
    s_mov_b32 s62, 0
k345_b3_poll_to:
    s_lshl_b32 s63, s3, 2
    s_add_u32 s63, s63, 155648
    v_mov_b32 v13, s63
    v_mov_b32 v14, s62
    ds_write_b32 v13, v14
    v_mov_b32 v13, 155648
    s_waitcnt lgkmcnt(0)
    s_barrier
    ds_read_b128 v[144:147], v13
    v_add_u32 v15, 147456, v3
    ds_read_b128 v[32:35], v15 offset:0
    ds_read_b128 v[36:39], v15 offset:1024
    ds_read_b128 v[40:43], v15 offset:2048
    ds_read_b128 v[44:47], v15 offset:3072
    ds_read_b128 v[48:51], v15 offset:4096
    ds_read_b128 v[52:55], v15 offset:5120
    s_waitcnt lgkmcnt(6)
    v_or3_b32 v144, v144, v145, v146
    v_or_b32 v144, v144, v147
    s_nop 0
    v_readfirstlane_b32 s63, v144
    s_nop 0
    s_cmp_lg_u32 s63, 0
    s_cbranch_scc1 k345_help3
    buffer_load_dwordx4 a[0:3], v192, s[40:43], s50 offen offset:0
    buffer_load_dwordx4 a[4:7], v192, s[40:43], s50 offen offset:1024
    buffer_load_dwordx4 a[8:11], v192, s[40:43], s50 offen offset:2048
    buffer_load_dwordx4 a[12:15], v192, s[40:43], s50 offen offset:3072
    buffer_load_dwordx2 v[16:17], v6, s[40:43], s12 offen
    s_add_u32 s12, s12, 16384
    buffer_load_dwordx2 v[18:19], v6, s[40:43], s12 offen
    s_add_u32 s12, s12, 16384
    buffer_load_dwordx2 v[20:21], v6, s[40:43], s12 offen
    s_add_u32 s12, s12, 16384
    buffer_load_dwordx2 v[22:23], v6, s[40:43], s12 offen
    s_add_u32 s12, s12, 16384
    buffer_load_dwordx2 v[24:25], v6, s[40:43], s12 offen
    s_add_u32 s12, s12, 16384
    buffer_load_dwordx2 v[26:27], v6, s[40:43], s12 offen
    s_add_u32 s12, s12, 16384
    buffer_load_dwordx2 v[28:29], v6, s[40:43], s12 offen
    s_add_u32 s12, s12, 16384
    buffer_load_dwordx2 v[30:31], v6, s[40:43], s12 offen
    buffer_load_dwordx4 a[16:19], v192, s[40:43], s51 offen offset:0
    buffer_load_dwordx4 a[20:23], v192, s[40:43], s51 offen offset:1024
    buffer_load_dwordx4 a[24:27], v192, s[40:43], s51 offen offset:2048
    buffer_load_dwordx4 a[28:31], v192, s[40:43], s51 offen offset:3072
    buffer_load_dwordx4 a[32:35], v193, s[40:43], s50 offen offset:0
    buffer_load_dwordx4 a[36:39], v193, s[40:43], s50 offen offset:1024
    buffer_load_dwordx4 a[40:43], v193, s[40:43], s50 offen offset:2048
    buffer_load_dwordx4 a[44:47], v193, s[40:43], s50 offen offset:3072
    s_lshr_b32 s63, s2, 5
    s_lshl_b32 s63, s63, 1
    s_add_u32 s100, s63, s7
    s_xor_b32 s101, s100, 1
    s_mul_i32 s100, s100, 86
    s_lshl_b32 s100, s100, 10
    s_add_u32 s100, s100, 0x800000
    s_mul_i32 s101, s101, 86
    s_lshl_b32 s101, s101, 10
    s_add_u32 s101, s101, 0x800000
    s_waitcnt vmcnt(20)
    s_barrier
    ds_read_b128 v[160:163], v3 offset:0
    ds_read_b128 v[164:167], v3 offset:4096
    ds_read_b128 v[168:171], v3 offset:8192
    ds_read_b128 v[172:175], v3 offset:12288
    s_waitcnt vmcnt(16)
    s_waitcnt lgkmcnt(3)
    v_mfma_f32_32x32x16_bf16 v[64:79], v[160:163], a[0:3], 0
    ds_read_b128 v[176:179], v3 offset:1024
    s_waitcnt lgkmcnt(3)
    v_mfma_f32_32x32x16_bf16 v[80:95], v[164:167], a[0:3], 0
    ds_read_b128 v[180:183], v3 offset:5120
    buffer_load_dwordx4 a[48:51], v193, s[40:43], s51 offen offset:0
    s_waitcnt lgkmcnt(3)
    v_mfma_f32_32x32x16_bf16 v[96:111], v[168:171], a[0:3], 0
    ds_read_b128 v[184:187], v3 offset:9216
    s_waitcnt lgkmcnt(3)
    v_mfma_f32_32x32x16_bf16 v[112:127], v[172:175], a[0:3], 0
    ds_read_b128 v[188:191], v3 offset:13312
    s_waitcnt lgkmcnt(3)
    v_mfma_f32_32x32x16_bf16 v[64:79], v[176:179], a[4:7], v[64:79]
    ds_read_b128 v[160:163], v3 offset:2048
    s_waitcnt lgkmcnt(3)
    v_mfma_f32_32x32x16_bf16 v[80:95], v[180:183], a[4:7], v[80:95]
    ds_read_b128 v[164:167], v3 offset:6144
    buffer_load_dwordx4 a[52:55], v193, s[40:43], s51 offen offset:1024
    s_waitcnt lgkmcnt(3)
    v_mfma_f32_32x32x16_bf16 v[96:111], v[184:187], a[4:7], v[96:111]
    ds_read_b128 v[168:171], v3 offset:10240
    s_waitcnt vmcnt(10)
    v_pk_add_f32 v[16:17], v[16:17], v[20:21]
    v_pk_add_f32 v[16:17], v[16:17], v[24:25]
    v_pk_add_f32 v[16:17], v[16:17], v[28:29]
    v_pk_add_f32 v[18:19], v[18:19], v[22:23]
    v_pk_add_f32 v[18:19], v[18:19], v[26:27]
    v_pk_add_f32 v[18:19], v[18:19], v[30:31]
    v_pk_add_f32 v[16:17], v[16:17], v[18:19]
    v_mov_b32 v18, v16
    v_mov_b32 v19, v17
    s_nop 0
    v_permlane32_swap_b32 v16, v18
    v_permlane32_swap_b32 v17, v19
    v_pk_add_f32 v[16:17], v[16:17], v[18:19]
    v_mul_f32 v16, 0x3b000000, v16
    v_mul_f32 v17, 0x3b000000, v17
    v_fma_f32 v17, -v16, v16, v17
    v_max_f32 v17, 0, v17
    v_cvt_pk_bf16_f32 v17, v17, v17
    v_lshlrev_b32 v17, 16, v17
    v_add_f32 v17, 0x3727c5ac, v17
    v_cvt_pk_bf16_f32 v17, v17, v17
    v_lshlrev_b32 v17, 16, v17
    v_sqrt_f32 v17, v17
    v_sub_f32 v16, 0, v16
    v_cvt_pk_bf16_f32 v56, v16, v17
    v_mov_b32 v57, v56
    v_mov_b32 v58, v56
    v_mov_b32 v59, 0
    v_and_b32 v62, 0xffff0000, v56
    v_rcp_f32 v18, v62
    v_mov_b32 v63, v62
    v_mul_f32 v60, 0xbfb8aa3b, v18
    v_mul_f32 v61, 0xbfb8aa3b, v18
    s_waitcnt lgkmcnt(3)
    v_mfma_f32_32x32x16_bf16 v[112:127], v[188:191], a[4:7], v[112:127]
    ds_read_b128 v[172:175], v3 offset:14336
    s_waitcnt lgkmcnt(3)
    v_mfma_f32_32x32x16_bf16 v[64:79], v[160:163], a[8:11], v[64:79]
    ds_read_b128 v[176:179], v3 offset:3072
    s_waitcnt lgkmcnt(3)
    v_mfma_f32_32x32x16_bf16 v[80:95], v[164:167], a[8:11], v[80:95]
    ds_read_b128 v[180:183], v3 offset:7168
    buffer_load_dwordx4 a[56:59], v193, s[40:43], s51 offen offset:2048
    s_waitcnt lgkmcnt(3)
    v_mfma_f32_32x32x16_bf16 v[96:111], v[168:171], a[8:11], v[96:111]
    ds_read_b128 v[184:187], v3 offset:11264
    s_waitcnt lgkmcnt(3)
    v_mfma_f32_32x32x16_bf16 v[112:127], v[172:175], a[8:11], v[112:127]
    ds_read_b128 v[188:191], v3 offset:15360
    s_waitcnt lgkmcnt(3)
    v_mfma_f32_32x32x16_bf16 v[64:79], v[176:179], a[12:15], v[64:79]
    ds_read_b128 v[160:163], v3 offset:16384
    s_waitcnt lgkmcnt(3)
    v_mfma_f32_32x32x16_bf16 v[80:95], v[180:183], a[12:15], v[80:95]
    ds_read_b128 v[164:167], v3 offset:20480
    buffer_load_dwordx4 a[60:63], v193, s[40:43], s51 offen offset:3072
    s_waitcnt lgkmcnt(3)
    v_mfma_f32_32x32x16_bf16 v[96:111], v[184:187], a[12:15], v[96:111]
    ds_read_b128 v[168:171], v3 offset:24576
    s_waitcnt lgkmcnt(3)
    v_mfma_f32_32x32x16_bf16 v[112:127], v[188:191], a[12:15], v[112:127]
    ds_read_b128 v[172:175], v3 offset:28672
    v_mfma_f32_32x32x16_bf16 v[64:79], v[32:35], v[56:59], v[64:79]
    v_mfma_f32_32x32x16_bf16 v[80:95], v[36:39], v[56:59], v[80:95]
    v_mfma_f32_32x32x16_bf16 v[96:111], v[40:43], v[56:59], v[96:111]
    v_mfma_f32_32x32x16_bf16 v[112:127], v[44:47], v[56:59], v[112:127]
    s_waitcnt vmcnt(8)
    s_waitcnt lgkmcnt(3)
    v_mfma_f32_32x32x16_bf16 v[64:79], v[160:163], a[16:19], v[64:79]
    ds_read_b128 v[176:179], v3 offset:17408
    s_waitcnt lgkmcnt(3)
    v_mfma_f32_32x32x16_bf16 v[80:95], v[164:167], a[16:19], v[80:95]
    ds_read_b128 v[180:183], v3 offset:21504
    buffer_load_dwordx4 a[64:67], v194, s[40:43], s50 offen offset:0
    s_waitcnt lgkmcnt(3)
    v_mfma_f32_32x32x16_bf16 v[96:111], v[168:171], a[16:19], v[96:111]
    ds_read_b128 v[184:187], v3 offset:25600
    s_waitcnt lgkmcnt(3)
    v_mfma_f32_32x32x16_bf16 v[112:127], v[172:175], a[16:19], v[112:127]
    ds_read_b128 v[188:191], v3 offset:29696
    s_waitcnt lgkmcnt(3)
    v_mfma_f32_32x32x16_bf16 v[64:79], v[176:179], a[20:23], v[64:79]
    ds_read_b128 v[160:163], v3 offset:18432
    s_waitcnt lgkmcnt(3)
    v_mfma_f32_32x32x16_bf16 v[80:95], v[180:183], a[20:23], v[80:95]
    ds_read_b128 v[164:167], v3 offset:22528
    buffer_load_dwordx4 a[68:71], v194, s[40:43], s50 offen offset:1024
    s_waitcnt lgkmcnt(3)
    v_mfma_f32_32x32x16_bf16 v[96:111], v[184:187], a[20:23], v[96:111]
    ds_read_b128 v[168:171], v3 offset:26624
    s_waitcnt lgkmcnt(3)
    v_mfma_f32_32x32x16_bf16 v[112:127], v[188:191], a[20:23], v[112:127]
    ds_read_b128 v[172:175], v3 offset:30720
    s_waitcnt lgkmcnt(3)
    v_mfma_f32_32x32x16_bf16 v[64:79], v[160:163], a[24:27], v[64:79]
    ds_read_b128 v[176:179], v3 offset:19456
    s_waitcnt lgkmcnt(3)
    v_mfma_f32_32x32x16_bf16 v[80:95], v[164:167], a[24:27], v[80:95]
    ds_read_b128 v[180:183], v3 offset:23552
    buffer_load_dwordx4 a[72:75], v194, s[40:43], s50 offen offset:2048
    s_waitcnt lgkmcnt(3)
    v_mfma_f32_32x32x16_bf16 v[96:111], v[168:171], a[24:27], v[96:111]
    ds_read_b128 v[184:187], v3 offset:27648
    s_waitcnt lgkmcnt(3)
    v_mfma_f32_32x32x16_bf16 v[112:127], v[172:175], a[24:27], v[112:127]
    ds_read_b128 v[188:191], v3 offset:31744
    s_waitcnt lgkmcnt(3)
    v_mfma_f32_32x32x16_bf16 v[64:79], v[176:179], a[28:31], v[64:79]
    ds_read_b128 v[160:163], v3 offset:32768
    s_waitcnt lgkmcnt(3)
    v_mfma_f32_32x32x16_bf16 v[80:95], v[180:183], a[28:31], v[80:95]
    ds_read_b128 v[164:167], v3 offset:36864
    buffer_load_dwordx4 a[76:79], v194, s[40:43], s50 offen offset:3072
    s_waitcnt lgkmcnt(3)
    v_mfma_f32_32x32x16_bf16 v[96:111], v[184:187], a[28:31], v[96:111]
    ds_read_b128 v[168:171], v3 offset:40960
    s_waitcnt lgkmcnt(3)
    v_mfma_f32_32x32x16_bf16 v[112:127], v[188:191], a[28:31], v[112:127]
    ds_read_b128 v[172:175], v3 offset:45056
    s_waitcnt vmcnt(8)
    s_waitcnt lgkmcnt(3)
    v_mfma_f32_32x32x16_bf16 v[64:79], v[160:163], a[32:35], v[64:79]
    ds_read_b128 v[176:179], v3 offset:33792
    s_waitcnt lgkmcnt(3)
    v_mfma_f32_32x32x16_bf16 v[80:95], v[164:167], a[32:35], v[80:95]
    ds_read_b128 v[180:183], v3 offset:37888
    buffer_load_dwordx4 a[80:83], v194, s[40:43], s51 offen offset:0
    s_waitcnt lgkmcnt(3)
    v_mfma_f32_32x32x16_bf16 v[96:111], v[168:171], a[32:35], v[96:111]
    ds_read_b128 v[184:187], v3 offset:41984
    s_waitcnt lgkmcnt(3)
    v_mfma_f32_32x32x16_bf16 v[112:127], v[172:175], a[32:35], v[112:127]
    ds_read_b128 v[188:191], v3 offset:46080
    s_waitcnt lgkmcnt(3)
    v_mfma_f32_32x32x16_bf16 v[64:79], v[176:179], a[36:39], v[64:79]
    ds_read_b128 v[160:163], v3 offset:34816
    s_waitcnt lgkmcnt(3)
    v_mfma_f32_32x32x16_bf16 v[80:95], v[180:183], a[36:39], v[80:95]
    ds_read_b128 v[164:167], v3 offset:38912
    buffer_load_dwordx4 a[84:87], v194, s[40:43], s51 offen offset:1024
    s_waitcnt lgkmcnt(3)
    v_mfma_f32_32x32x16_bf16 v[96:111], v[184:187], a[36:39], v[96:111]
    ds_read_b128 v[168:171], v3 offset:43008
    s_waitcnt lgkmcnt(3)
    v_mfma_f32_32x32x16_bf16 v[112:127], v[188:191], a[36:39], v[112:127]
    ds_read_b128 v[172:175], v3 offset:47104
    s_waitcnt lgkmcnt(3)
    v_mfma_f32_32x32x16_bf16 v[64:79], v[160:163], a[40:43], v[64:79]
    ds_read_b128 v[176:179], v3 offset:35840
    s_waitcnt lgkmcnt(3)
    v_mfma_f32_32x32x16_bf16 v[80:95], v[164:167], a[40:43], v[80:95]
    ds_read_b128 v[180:183], v3 offset:39936
    buffer_load_dwordx4 a[88:91], v194, s[40:43], s51 offen offset:2048
    s_waitcnt lgkmcnt(3)
    v_mfma_f32_32x32x16_bf16 v[96:111], v[168:171], a[40:43], v[96:111]
    ds_read_b128 v[184:187], v3 offset:44032
    s_waitcnt lgkmcnt(3)
    v_mfma_f32_32x32x16_bf16 v[112:127], v[172:175], a[40:43], v[112:127]
    ds_read_b128 v[188:191], v3 offset:48128
    s_waitcnt lgkmcnt(3)
    v_mfma_f32_32x32x16_bf16 v[64:79], v[176:179], a[44:47], v[64:79]
    ds_read_b128 v[160:163], v3 offset:49152
    s_waitcnt lgkmcnt(3)
    v_mfma_f32_32x32x16_bf16 v[80:95], v[180:183], a[44:47], v[80:95]
    ds_read_b128 v[164:167], v3 offset:53248
    buffer_load_dwordx4 a[92:95], v194, s[40:43], s51 offen offset:3072
    s_waitcnt lgkmcnt(3)
    v_mfma_f32_32x32x16_bf16 v[96:111], v[184:187], a[44:47], v[96:111]
    ds_read_b128 v[168:171], v3 offset:57344
    s_waitcnt lgkmcnt(3)
    v_mfma_f32_32x32x16_bf16 v[112:127], v[188:191], a[44:47], v[112:127]
    ds_read_b128 v[172:175], v3 offset:61440
    s_waitcnt vmcnt(8)
    s_waitcnt lgkmcnt(3)
    v_mfma_f32_32x32x16_bf16 v[64:79], v[160:163], a[48:51], v[64:79]
    ds_read_b128 v[176:179], v3 offset:50176
    s_waitcnt lgkmcnt(3)
    v_mfma_f32_32x32x16_bf16 v[80:95], v[164:167], a[48:51], v[80:95]
    ds_read_b128 v[180:183], v3 offset:54272
    buffer_load_dwordx4 a[96:99], v195, s[40:43], s50 offen offset:0
    s_waitcnt lgkmcnt(3)
    v_mfma_f32_32x32x16_bf16 v[96:111], v[168:171], a[48:51], v[96:111]
    ds_read_b128 v[184:187], v3 offset:58368
    s_waitcnt lgkmcnt(3)
    v_mfma_f32_32x32x16_bf16 v[112:127], v[172:175], a[48:51], v[112:127]
    ds_read_b128 v[188:191], v3 offset:62464
    s_waitcnt lgkmcnt(3)
    v_mfma_f32_32x32x16_bf16 v[64:79], v[176:179], a[52:55], v[64:79]
    ds_read_b128 v[160:163], v3 offset:51200
    s_waitcnt lgkmcnt(3)
    v_mfma_f32_32x32x16_bf16 v[80:95], v[180:183], a[52:55], v[80:95]
    ds_read_b128 v[164:167], v3 offset:55296
    buffer_load_dwordx4 a[100:103], v195, s[40:43], s50 offen offset:1024
    s_waitcnt lgkmcnt(3)
    v_mfma_f32_32x32x16_bf16 v[96:111], v[184:187], a[52:55], v[96:111]
    ds_read_b128 v[168:171], v3 offset:59392
    s_waitcnt lgkmcnt(3)
    v_mfma_f32_32x32x16_bf16 v[112:127], v[188:191], a[52:55], v[112:127]
    ds_read_b128 v[172:175], v3 offset:63488
    s_waitcnt lgkmcnt(3)
    v_mfma_f32_32x32x16_bf16 v[64:79], v[160:163], a[56:59], v[64:79]
    ds_read_b128 v[176:179], v3 offset:52224
    s_waitcnt lgkmcnt(3)
    v_mfma_f32_32x32x16_bf16 v[80:95], v[164:167], a[56:59], v[80:95]
    ds_read_b128 v[180:183], v3 offset:56320
    buffer_load_dwordx4 a[104:107], v195, s[40:43], s50 offen offset:2048
    s_waitcnt lgkmcnt(3)
    v_mfma_f32_32x32x16_bf16 v[96:111], v[168:171], a[56:59], v[96:111]
    ds_read_b128 v[184:187], v3 offset:60416
    s_waitcnt lgkmcnt(3)
    v_mfma_f32_32x32x16_bf16 v[112:127], v[172:175], a[56:59], v[112:127]
    ds_read_b128 v[188:191], v3 offset:64512
    s_waitcnt lgkmcnt(3)
    v_mfma_f32_32x32x16_bf16 v[64:79], v[176:179], a[60:63], v[64:79]
    s_barrier
    ds_read_b128 v[160:163], v11 offset:0
    s_waitcnt lgkmcnt(3)
    v_mfma_f32_32x32x16_bf16 v[80:95], v[180:183], a[60:63], v[80:95]
    ds_read_b128 v[164:167], v11 offset:4096
    buffer_load_dwordx4 a[108:111], v195, s[40:43], s50 offen offset:3072
    s_waitcnt lgkmcnt(3)
    v_mfma_f32_32x32x16_bf16 v[96:111], v[184:187], a[60:63], v[96:111]
    ds_read_b128 v[168:171], v11 offset:8192
    s_waitcnt lgkmcnt(3)
    v_mfma_f32_32x32x16_bf16 v[112:127], v[188:191], a[60:63], v[112:127]
    ds_read_b128 v[172:175], v11 offset:12288
    s_waitcnt vmcnt(8)
    s_waitcnt lgkmcnt(3)
    v_mfma_f32_32x32x16_bf16 v[64:79], v[160:163], a[64:67], v[64:79]
    ds_read_b128 v[176:179], v11 offset:1024
    s_waitcnt lgkmcnt(3)
    v_mfma_f32_32x32x16_bf16 v[80:95], v[164:167], a[64:67], v[80:95]
    ds_read_b128 v[180:183], v11 offset:5120
    buffer_load_dwordx4 a[112:115], v195, s[40:43], s51 offen offset:0
    s_waitcnt lgkmcnt(3)
    v_mfma_f32_32x32x16_bf16 v[96:111], v[168:171], a[64:67], v[96:111]
    ds_read_b128 v[184:187], v11 offset:9216
    s_waitcnt lgkmcnt(3)
    v_mfma_f32_32x32x16_bf16 v[112:127], v[172:175], a[64:67], v[112:127]
    ds_read_b128 v[188:191], v11 offset:13312
    s_waitcnt lgkmcnt(3)
    v_mfma_f32_32x32x16_bf16 v[64:79], v[176:179], a[68:71], v[64:79]
    ds_read_b128 v[160:163], v11 offset:2048
    s_waitcnt lgkmcnt(3)
    v_mfma_f32_32x32x16_bf16 v[80:95], v[180:183], a[68:71], v[80:95]
    ds_read_b128 v[164:167], v11 offset:6144
    buffer_load_dwordx4 a[116:119], v195, s[40:43], s51 offen offset:1024
    s_waitcnt lgkmcnt(3)
    v_mfma_f32_32x32x16_bf16 v[96:111], v[184:187], a[68:71], v[96:111]
    ds_read_b128 v[168:171], v11 offset:10240
    s_waitcnt lgkmcnt(3)
    v_mfma_f32_32x32x16_bf16 v[112:127], v[188:191], a[68:71], v[112:127]
    ds_read_b128 v[172:175], v11 offset:14336
    s_waitcnt lgkmcnt(3)
    v_mfma_f32_32x32x16_bf16 v[64:79], v[160:163], a[72:75], v[64:79]
    ds_read_b128 v[176:179], v11 offset:3072
    s_waitcnt lgkmcnt(3)
    v_mfma_f32_32x32x16_bf16 v[80:95], v[164:167], a[72:75], v[80:95]
    ds_read_b128 v[180:183], v11 offset:7168
    buffer_load_dwordx4 a[120:123], v195, s[40:43], s51 offen offset:2048
    s_waitcnt lgkmcnt(3)
    v_mfma_f32_32x32x16_bf16 v[96:111], v[168:171], a[72:75], v[96:111]
    ds_read_b128 v[184:187], v11 offset:11264
    s_waitcnt lgkmcnt(3)
    v_mfma_f32_32x32x16_bf16 v[112:127], v[172:175], a[72:75], v[112:127]
    ds_read_b128 v[188:191], v11 offset:15360
    s_waitcnt lgkmcnt(3)
    v_mfma_f32_32x32x16_bf16 v[64:79], v[176:179], a[76:79], v[64:79]
    ds_read_b128 v[160:163], v11 offset:16384
    s_waitcnt lgkmcnt(3)
    v_mfma_f32_32x32x16_bf16 v[80:95], v[180:183], a[76:79], v[80:95]
    ds_read_b128 v[164:167], v11 offset:20480
    buffer_load_dwordx4 a[124:127], v195, s[40:43], s51 offen offset:3072
    s_waitcnt lgkmcnt(3)
    v_mfma_f32_32x32x16_bf16 v[96:111], v[184:187], a[76:79], v[96:111]
    ds_read_b128 v[168:171], v11 offset:24576
    s_waitcnt lgkmcnt(3)
    v_mfma_f32_32x32x16_bf16 v[112:127], v[188:191], a[76:79], v[112:127]
    ds_read_b128 v[172:175], v11 offset:28672
    s_waitcnt vmcnt(8)
    s_waitcnt lgkmcnt(3)
    v_mfma_f32_32x32x16_bf16 v[64:79], v[160:163], a[80:83], v[64:79]
    ds_read_b128 v[176:179], v11 offset:17408
    s_waitcnt lgkmcnt(3)
    v_mfma_f32_32x32x16_bf16 v[80:95], v[164:167], a[80:83], v[80:95]
    ds_read_b128 v[180:183], v11 offset:21504
    s_waitcnt lgkmcnt(3)
    v_mfma_f32_32x32x16_bf16 v[96:111], v[168:171], a[80:83], v[96:111]
    ds_read_b128 v[184:187], v11 offset:25600
    s_waitcnt lgkmcnt(3)
    v_mfma_f32_32x32x16_bf16 v[112:127], v[172:175], a[80:83], v[112:127]
    ds_read_b128 v[188:191], v11 offset:29696
    s_waitcnt lgkmcnt(3)
    v_mfma_f32_32x32x16_bf16 v[64:79], v[176:179], a[84:87], v[64:79]
    ds_read_b128 v[160:163], v11 offset:18432
    s_add_u32 m0, s11, 0
    s_add_u32 s63, s97, 131072
    buffer_load_dwordx4 v193, s[40:43], s63 offen lds
    s_waitcnt lgkmcnt(3)
    v_mfma_f32_32x32x16_bf16 v[80:95], v[180:183], a[84:87], v[80:95]
    ds_read_b128 v[164:167], v11 offset:22528
    s_waitcnt lgkmcnt(3)
    v_mfma_f32_32x32x16_bf16 v[96:111], v[184:187], a[84:87], v[96:111]
    ds_read_b128 v[168:171], v11 offset:26624
    s_waitcnt lgkmcnt(3)
    v_mfma_f32_32x32x16_bf16 v[112:127], v[188:191], a[84:87], v[112:127]
    ds_read_b128 v[172:175], v11 offset:30720
    s_waitcnt lgkmcnt(3)
    v_mfma_f32_32x32x16_bf16 v[64:79], v[160:163], a[88:91], v[64:79]
    ds_read_b128 v[176:179], v11 offset:19456
    s_add_u32 m0, s11, 1024
    s_add_u32 s63, s97, 132096
    buffer_load_dwordx4 v193, s[40:43], s63 offen lds
    s_waitcnt lgkmcnt(3)
    v_mfma_f32_32x32x16_bf16 v[80:95], v[164:167], a[88:91], v[80:95]
    ds_read_b128 v[180:183], v11 offset:23552
    s_waitcnt lgkmcnt(3)
    v_mfma_f32_32x32x16_bf16 v[96:111], v[168:171], a[88:91], v[96:111]
    ds_read_b128 v[184:187], v11 offset:27648
    s_waitcnt lgkmcnt(3)
    v_mfma_f32_32x32x16_bf16 v[112:127], v[172:175], a[88:91], v[112:127]
    ds_read_b128 v[188:191], v11 offset:31744
    s_waitcnt lgkmcnt(3)
    v_mfma_f32_32x32x16_bf16 v[64:79], v[176:179], a[92:95], v[64:79]
    ds_read_b128 v[160:163], v11 offset:32768
    s_add_u32 m0, s11, 8192
    s_add_u32 s63, s97, 163840
    buffer_load_dwordx4 v193, s[40:43], s63 offen lds
    s_waitcnt lgkmcnt(3)
    v_mfma_f32_32x32x16_bf16 v[80:95], v[180:183], a[92:95], v[80:95]
    ds_read_b128 v[164:167], v11 offset:36864
    s_waitcnt lgkmcnt(3)
    v_mfma_f32_32x32x16_bf16 v[96:111], v[184:187], a[92:95], v[96:111]
    ds_read_b128 v[168:171], v11 offset:40960
    s_waitcnt lgkmcnt(3)
    v_mfma_f32_32x32x16_bf16 v[112:127], v[188:191], a[92:95], v[112:127]
    ds_read_b128 v[172:175], v11 offset:45056
    s_waitcnt vmcnt(7)
    s_waitcnt lgkmcnt(3)
    v_mfma_f32_32x32x16_bf16 v[64:79], v[160:163], a[96:99], v[64:79]
    ds_read_b128 v[176:179], v11 offset:33792
    s_add_u32 m0, s11, 9216
    s_add_u32 s63, s97, 164864
    buffer_load_dwordx4 v193, s[40:43], s63 offen lds
    s_waitcnt lgkmcnt(3)
    v_mfma_f32_32x32x16_bf16 v[80:95], v[164:167], a[96:99], v[80:95]
    ds_read_b128 v[180:183], v11 offset:37888
    s_waitcnt lgkmcnt(3)
    v_mfma_f32_32x32x16_bf16 v[96:111], v[168:171], a[96:99], v[96:111]
    ds_read_b128 v[184:187], v11 offset:41984
    s_waitcnt lgkmcnt(3)
    v_mfma_f32_32x32x16_bf16 v[112:127], v[172:175], a[96:99], v[112:127]
    ds_read_b128 v[188:191], v11 offset:46080
    s_waitcnt lgkmcnt(3)
    v_mfma_f32_32x32x16_bf16 v[64:79], v[176:179], a[100:103], v[64:79]
    ds_read_b128 v[160:163], v11 offset:34816
    s_add_u32 m0, s11, 16384
    s_add_u32 s63, s97, 131072
    buffer_load_dwordx4 v194, s[40:43], s63 offen lds
    s_waitcnt lgkmcnt(3)
    v_mfma_f32_32x32x16_bf16 v[80:95], v[180:183], a[100:103], v[80:95]
    ds_read_b128 v[164:167], v11 offset:38912
    s_waitcnt lgkmcnt(3)
    v_mfma_f32_32x32x16_bf16 v[96:111], v[184:187], a[100:103], v[96:111]
    ds_read_b128 v[168:171], v11 offset:43008
    s_waitcnt lgkmcnt(3)
    v_mfma_f32_32x32x16_bf16 v[112:127], v[188:191], a[100:103], v[112:127]
    ds_read_b128 v[172:175], v11 offset:47104
    s_waitcnt lgkmcnt(3)
    v_mfma_f32_32x32x16_bf16 v[64:79], v[160:163], a[104:107], v[64:79]
    ds_read_b128 v[176:179], v11 offset:35840
    s_add_u32 m0, s11, 17408
    s_add_u32 s63, s97, 132096
    buffer_load_dwordx4 v194, s[40:43], s63 offen lds
    s_waitcnt lgkmcnt(3)
    v_mfma_f32_32x32x16_bf16 v[80:95], v[164:167], a[104:107], v[80:95]
    ds_read_b128 v[180:183], v11 offset:39936
    s_waitcnt lgkmcnt(3)
    v_mfma_f32_32x32x16_bf16 v[96:111], v[168:171], a[104:107], v[96:111]
    ds_read_b128 v[184:187], v11 offset:44032
    s_waitcnt lgkmcnt(3)
    v_mfma_f32_32x32x16_bf16 v[112:127], v[172:175], a[104:107], v[112:127]
    ds_read_b128 v[188:191], v11 offset:48128
    s_waitcnt lgkmcnt(3)
    v_mfma_f32_32x32x16_bf16 v[64:79], v[176:179], a[108:111], v[64:79]
    ds_read_b128 v[160:163], v11 offset:49152
    s_add_u32 m0, s11, 24576
    s_add_u32 s63, s97, 163840
    buffer_load_dwordx4 v194, s[40:43], s63 offen lds
    s_waitcnt lgkmcnt(3)
    v_mfma_f32_32x32x16_bf16 v[80:95], v[180:183], a[108:111], v[80:95]
    ds_read_b128 v[164:167], v11 offset:53248
    s_waitcnt lgkmcnt(3)
    v_mfma_f32_32x32x16_bf16 v[96:111], v[184:187], a[108:111], v[96:111]
    ds_read_b128 v[168:171], v11 offset:57344
    s_waitcnt lgkmcnt(3)
    v_mfma_f32_32x32x16_bf16 v[112:127], v[188:191], a[108:111], v[112:127]
    ds_read_b128 v[172:175], v11 offset:61440
    s_waitcnt vmcnt(7)
    s_waitcnt lgkmcnt(3)
    v_mfma_f32_32x32x16_bf16 v[64:79], v[160:163], a[112:115], v[64:79]
    ds_read_b128 v[176:179], v11 offset:50176
    s_add_u32 m0, s11, 25600
    s_add_u32 s63, s97, 164864
    buffer_load_dwordx4 v194, s[40:43], s63 offen lds
    s_waitcnt lgkmcnt(3)
    v_mfma_f32_32x32x16_bf16 v[80:95], v[164:167], a[112:115], v[80:95]
    ds_read_b128 v[180:183], v11 offset:54272
    s_waitcnt lgkmcnt(3)
    v_mfma_f32_32x32x16_bf16 v[96:111], v[168:171], a[112:115], v[96:111]
    ds_read_b128 v[184:187], v11 offset:58368
    s_waitcnt lgkmcnt(3)
    v_mfma_f32_32x32x16_bf16 v[112:127], v[172:175], a[112:115], v[112:127]
    ds_read_b128 v[188:191], v11 offset:62464
    s_waitcnt lgkmcnt(3)
    v_mfma_f32_32x32x16_bf16 v[64:79], v[176:179], a[116:119], v[64:79]
    ds_read_b128 v[160:163], v11 offset:51200
    s_add_u32 m0, s11, 32768
    s_add_u32 s63, s97, 131072
    buffer_load_dwordx4 v195, s[40:43], s63 offen lds
    s_waitcnt lgkmcnt(3)
    v_mfma_f32_32x32x16_bf16 v[80:95], v[180:183], a[116:119], v[80:95]
    ds_read_b128 v[164:167], v11 offset:55296
    s_waitcnt lgkmcnt(3)
    v_mfma_f32_32x32x16_bf16 v[96:111], v[184:187], a[116:119], v[96:111]
    ds_read_b128 v[168:171], v11 offset:59392
    s_waitcnt lgkmcnt(3)
    v_mfma_f32_32x32x16_bf16 v[112:127], v[188:191], a[116:119], v[112:127]
    ds_read_b128 v[172:175], v11 offset:63488
    s_waitcnt lgkmcnt(3)
    v_mfma_f32_32x32x16_bf16 v[64:79], v[160:163], a[120:123], v[64:79]
    ds_read_b128 v[176:179], v11 offset:52224
    s_add_u32 m0, s11, 33792
    s_add_u32 s63, s97, 132096
    buffer_load_dwordx4 v195, s[40:43], s63 offen lds
    s_waitcnt lgkmcnt(3)
    v_mfma_f32_32x32x16_bf16 v[80:95], v[164:167], a[120:123], v[80:95]
    ds_read_b128 v[180:183], v11 offset:56320
    s_waitcnt lgkmcnt(3)
    v_mfma_f32_32x32x16_bf16 v[96:111], v[168:171], a[120:123], v[96:111]
    ds_read_b128 v[184:187], v11 offset:60416
    s_waitcnt lgkmcnt(3)
    v_mfma_f32_32x32x16_bf16 v[112:127], v[172:175], a[120:123], v[112:127]
    ds_read_b128 v[188:191], v11 offset:64512
    s_waitcnt lgkmcnt(3)
    v_mfma_f32_32x32x16_bf16 v[64:79], v[176:179], a[124:127], v[64:79]
    ds_read_b128 v[160:163], v12 offset:0
    s_add_u32 m0, s11, 40960
    s_add_u32 s63, s97, 163840
    buffer_load_dwordx4 v195, s[40:43], s63 offen lds
    s_waitcnt lgkmcnt(3)
    v_mfma_f32_32x32x16_bf16 v[80:95], v[180:183], a[124:127], v[80:95]
    ds_read_b128 v[164:167], v12 offset:8192
    s_waitcnt lgkmcnt(3)
    v_mfma_f32_32x32x16_bf16 v[96:111], v[184:187], a[124:127], v[96:111]
    ds_read_b128 v[168:171], v12 offset:1024
    s_waitcnt lgkmcnt(3)
    v_mfma_f32_32x32x16_bf16 v[112:127], v[188:191], a[124:127], v[112:127]
    ds_read_b128 v[172:175], v12 offset:9216
    v_mfma_f32_32x32x16_bf16 v[128:143], v[48:51], v[56:59], 0
    v_mfma_f32_32x32x16_bf16 v[144:159], v[52:55], v[56:59], 0
    s_waitcnt lgkmcnt(3)
    v_mfma_f32_32x32x16_bf16 v[128:143], v[160:163], a[0:3], v[128:143]
    ds_read_b128 v[176:179], v12 offset:2048
    s_add_u32 m0, s11, 41984
    s_add_u32 s63, s97, 164864
    buffer_load_dwordx4 v195, s[40:43], s63 offen lds
    s_add_u32 s48, s100, s19
    s_add_u32 s49, s101, s19
    buffer_load_dwordx4 v[224:227], v3, s[40:43], s48 offen offset:0
    buffer_load_dwordx4 v[228:231], v3, s[40:43], s49 offen offset:0
    s_waitcnt lgkmcnt(3)
    v_mfma_f32_32x32x16_bf16 v[144:159], v[164:167], a[0:3], v[144:159]
    ds_read_b128 v[180:183], v12 offset:10240
    buffer_load_dwordx4 v[232:235], v3, s[40:43], s48 offen offset:1024
    v_pk_mul_f32 v[64:65], v[64:65], v[60:61]
    v_exp_f32 v64, v64
    s_waitcnt lgkmcnt(3)
    v_mfma_f32_32x32x16_bf16 v[128:143], v[168:171], a[4:7], v[128:143]
    ds_read_b128 v[184:187], v12 offset:3072
    buffer_load_dwordx4 v[236:239], v3, s[40:43], s49 offen offset:1024
    v_exp_f32 v65, v65
    v_pk_mul_f32 v[66:67], v[66:67], v[60:61]
    s_waitcnt lgkmcnt(3)
    v_mfma_f32_32x32x16_bf16 v[144:159], v[172:175], a[4:7], v[144:159]
    ds_read_b128 v[188:191], v12 offset:11264
    buffer_load_dwordx4 v[240:243], v3, s[40:43], s48 offen offset:2048
    v_exp_f32 v66, v66
    v_exp_f32 v67, v67
    s_waitcnt lgkmcnt(3)
    v_mfma_f32_32x32x16_bf16 v[128:143], v[176:179], a[8:11], v[128:143]
    ds_read_b128 v[160:163], v12 offset:4096
    buffer_load_dwordx4 v[244:247], v3, s[40:43], s49 offen offset:2048
    v_pk_mul_f32 v[68:69], v[68:69], v[60:61]
    v_exp_f32 v68, v68
    s_waitcnt lgkmcnt(3)
    v_mfma_f32_32x32x16_bf16 v[144:159], v[180:183], a[8:11], v[144:159]
    ds_read_b128 v[164:167], v12 offset:12288
    buffer_load_dwordx4 v[248:251], v3, s[40:43], s48 offen offset:3072
    v_exp_f32 v69, v69
    v_pk_mul_f32 v[70:71], v[70:71], v[60:61]
    s_waitcnt lgkmcnt(3)
    v_mfma_f32_32x32x16_bf16 v[128:143], v[184:187], a[12:15], v[128:143]
    ds_read_b128 v[168:171], v12 offset:5120
    buffer_load_dwordx4 v[252:255], v3, s[40:43], s49 offen offset:3072
    v_exp_f32 v70, v70
    v_exp_f32 v71, v71
    s_waitcnt lgkmcnt(3)
    v_mfma_f32_32x32x16_bf16 v[144:159], v[188:191], a[12:15], v[144:159]
    ds_read_b128 v[172:175], v12 offset:13312
    s_add_u32 s48, s100, s16
    s_add_u32 s49, s101, s16
    buffer_load_dwordx4 a[128:131], v3, s[40:43], s48 offen offset:0
    v_pk_mul_f32 v[72:73], v[72:73], v[60:61]
    v_exp_f32 v72, v72
    s_waitcnt lgkmcnt(3)
    v_mfma_f32_32x32x16_bf16 v[128:143], v[160:163], a[16:19], v[128:143]
    ds_read_b128 v[176:179], v12 offset:6144
    buffer_load_dwordx4 a[132:135], v3, s[40:43], s49 offen offset:0
    v_exp_f32 v73, v73
    v_pk_mul_f32 v[74:75], v[74:75], v[60:61]
    s_waitcnt lgkmcnt(3)
    v_mfma_f32_32x32x16_bf16 v[144:159], v[164:167], a[16:19], v[144:159]
    ds_read_b128 v[180:183], v12 offset:14336
    buffer_load_dwordx4 a[136:139], v3, s[40:43], s48 offen offset:1024
    v_exp_f32 v74, v74
    v_exp_f32 v75, v75
    s_waitcnt lgkmcnt(3)
    v_mfma_f32_32x32x16_bf16 v[128:143], v[168:171], a[20:23], v[128:143]
    ds_read_b128 v[184:187], v12 offset:7168
    buffer_load_dwordx4 a[140:143], v3, s[40:43], s49 offen offset:1024
    v_pk_mul_f32 v[76:77], v[76:77], v[60:61]
    v_exp_f32 v76, v76
    s_waitcnt lgkmcnt(3)
    v_mfma_f32_32x32x16_bf16 v[144:159], v[172:175], a[20:23], v[144:159]
    ds_read_b128 v[188:191], v12 offset:15360
    buffer_load_dwordx4 a[144:147], v3, s[40:43], s48 offen offset:2048
    v_exp_f32 v77, v77
    v_pk_mul_f32 v[78:79], v[78:79], v[60:61]
    s_waitcnt lgkmcnt(3)
    v_mfma_f32_32x32x16_bf16 v[128:143], v[176:179], a[24:27], v[128:143]
    s_waitcnt vmcnt(13)
    s_barrier
    ds_read_b128 v[160:163], v3 offset:0
    buffer_load_dwordx4 a[148:151], v3, s[40:43], s49 offen offset:2048
    v_exp_f32 v78, v78
    v_exp_f32 v79, v79
    s_waitcnt lgkmcnt(3)
    v_mfma_f32_32x32x16_bf16 v[144:159], v[180:183], a[24:27], v[144:159]
    ds_read_b128 v[164:167], v3 offset:8192
    buffer_load_dwordx4 a[152:155], v3, s[40:43], s48 offen offset:3072
    v_pk_fma_f32 v[64:65], v[64:65], v[62:63], v[62:63]
    v_rcp_f32 v64, v64
    s_waitcnt lgkmcnt(3)
    v_mfma_f32_32x32x16_bf16 v[128:143], v[184:187], a[28:31], v[128:143]
    ds_read_b128 v[168:171], v3 offset:1024
    buffer_load_dwordx4 a[156:159], v3, s[40:43], s49 offen offset:3072
    v_rcp_f32 v65, v65
    v_pk_fma_f32 v[66:67], v[66:67], v[62:63], v[62:63]
    s_waitcnt lgkmcnt(3)
    v_mfma_f32_32x32x16_bf16 v[144:159], v[188:191], a[28:31], v[144:159]
    ds_read_b128 v[172:175], v3 offset:9216
    s_add_u32 s48, s48, 4096
    s_add_u32 s49, s49, 4096
    buffer_load_dwordx4 a[160:163], v3, s[40:43], s48 offen offset:0
    v_rcp_f32 v66, v66
    v_rcp_f32 v67, v67
    s_waitcnt lgkmcnt(3)
    v_mfma_f32_32x32x16_bf16 v[128:143], v[160:163], a[32:35], v[128:143]
    ds_read_b128 v[176:179], v3 offset:2048
    buffer_load_dwordx4 a[164:167], v3, s[40:43], s49 offen offset:0
    v_pk_fma_f32 v[68:69], v[68:69], v[62:63], v[62:63]
    v_rcp_f32 v68, v68
    s_waitcnt lgkmcnt(3)
    v_mfma_f32_32x32x16_bf16 v[144:159], v[164:167], a[32:35], v[144:159]
    ds_read_b128 v[180:183], v3 offset:10240
    buffer_load_dwordx4 a[168:171], v3, s[40:43], s48 offen offset:1024
    v_rcp_f32 v69, v69
    v_pk_fma_f32 v[70:71], v[70:71], v[62:63], v[62:63]
    s_waitcnt lgkmcnt(3)
    v_mfma_f32_32x32x16_bf16 v[128:143], v[168:171], a[36:39], v[128:143]
    ds_read_b128 v[184:187], v3 offset:3072
    buffer_load_dwordx4 a[172:175], v3, s[40:43], s49 offen offset:1024
    v_rcp_f32 v70, v70
    v_rcp_f32 v71, v71
    s_waitcnt lgkmcnt(3)
    v_mfma_f32_32x32x16_bf16 v[144:159], v[172:175], a[36:39], v[144:159]
    ds_read_b128 v[188:191], v3 offset:11264
    s_add_u32 s48, s100, s17
    s_add_u32 s49, s101, s17
    buffer_load_dwordx4 a[176:179], v3, s[40:43], s48 offen offset:0
    v_pk_fma_f32 v[72:73], v[72:73], v[62:63], v[62:63]
    v_rcp_f32 v72, v72
    s_waitcnt lgkmcnt(3)
    v_mfma_f32_32x32x16_bf16 v[128:143], v[176:179], a[40:43], v[128:143]
    ds_read_b128 v[160:163], v3 offset:4096
    buffer_load_dwordx4 a[180:183], v3, s[40:43], s49 offen offset:0
    v_rcp_f32 v73, v73
    v_pk_fma_f32 v[74:75], v[74:75], v[62:63], v[62:63]
    s_waitcnt lgkmcnt(3)
    v_mfma_f32_32x32x16_bf16 v[144:159], v[180:183], a[40:43], v[144:159]
    ds_read_b128 v[164:167], v3 offset:12288
    buffer_load_dwordx4 a[184:187], v3, s[40:43], s48 offen offset:1024
    v_rcp_f32 v74, v74
    v_rcp_f32 v75, v75
    s_waitcnt lgkmcnt(3)
    v_mfma_f32_32x32x16_bf16 v[128:143], v[184:187], a[44:47], v[128:143]
    ds_read_b128 v[168:171], v3 offset:5120
    buffer_load_dwordx4 a[188:191], v3, s[40:43], s49 offen offset:1024
    v_pk_fma_f32 v[76:77], v[76:77], v[62:63], v[62:63]
    v_rcp_f32 v76, v76
    s_waitcnt lgkmcnt(3)
    v_mfma_f32_32x32x16_bf16 v[144:159], v[188:191], a[44:47], v[144:159]
    ds_read_b128 v[172:175], v3 offset:13312
    buffer_load_dwordx4 a[192:195], v3, s[40:43], s48 offen offset:2048
    v_rcp_f32 v77, v77
    v_pk_fma_f32 v[78:79], v[78:79], v[62:63], v[62:63]
    s_waitcnt lgkmcnt(3)
    v_mfma_f32_32x32x16_bf16 v[128:143], v[160:163], a[48:51], v[128:143]
    ds_read_b128 v[176:179], v3 offset:6144
    buffer_load_dwordx4 a[196:199], v3, s[40:43], s49 offen offset:2048
    v_rcp_f32 v78, v78
    v_rcp_f32 v79, v79
    s_waitcnt lgkmcnt(3)
    v_mfma_f32_32x32x16_bf16 v[144:159], v[164:167], a[48:51], v[144:159]
    ds_read_b128 v[180:183], v3 offset:14336
    buffer_load_dwordx4 a[200:203], v3, s[40:43], s48 offen offset:3072
    v_pk_mul_f32 v[80:81], v[80:81], v[64:65]
    v_pk_mul_f32 v[82:83], v[82:83], v[66:67]
    v_pk_mul_f32 v[84:85], v[84:85], v[68:69]
    v_pk_mul_f32 v[86:87], v[86:87], v[70:71]
    s_waitcnt lgkmcnt(3)
    v_mfma_f32_32x32x16_bf16 v[128:143], v[168:171], a[52:55], v[128:143]
    ds_read_b128 v[184:187], v3 offset:7168
    buffer_load_dwordx4 a[204:207], v3, s[40:43], s49 offen offset:3072
    v_pk_mul_f32 v[88:89], v[88:89], v[72:73]
    v_pk_mul_f32 v[90:91], v[90:91], v[74:75]
    v_pk_mul_f32 v[92:93], v[92:93], v[76:77]
    v_pk_mul_f32 v[94:95], v[94:95], v[78:79]
    s_waitcnt lgkmcnt(3)
    v_mfma_f32_32x32x16_bf16 v[144:159], v[172:175], a[52:55], v[144:159]
    ds_read_b128 v[188:191], v3 offset:15360
    s_add_u32 s48, s48, 4096
    s_add_u32 s49, s49, 4096
    buffer_load_dwordx4 a[208:211], v3, s[40:43], s48 offen offset:0
    v_cvt_pk_bf16_f32 v192, v80, v81
    v_cvt_pk_bf16_f32 v193, v82, v83
    v_cvt_pk_bf16_f32 v194, v84, v85
    v_cvt_pk_bf16_f32 v195, v86, v87
    s_waitcnt lgkmcnt(3)
    v_mfma_f32_32x32x16_bf16 v[128:143], v[176:179], a[56:59], v[128:143]
    ds_read_b128 v[160:163], v3 offset:16384
    buffer_load_dwordx4 a[212:215], v3, s[40:43], s49 offen offset:0
    v_cvt_pk_bf16_f32 v196, v88, v89
    v_cvt_pk_bf16_f32 v197, v90, v91
    v_cvt_pk_bf16_f32 v198, v92, v93
    v_cvt_pk_bf16_f32 v199, v94, v95
    s_waitcnt lgkmcnt(3)
    v_mfma_f32_32x32x16_bf16 v[144:159], v[180:183], a[56:59], v[144:159]
    ds_read_b128 v[164:167], v3 offset:24576
    buffer_load_dwordx4 a[216:219], v3, s[40:43], s48 offen offset:1024
    buffer_store_dwordx4 v[192:195], v3, s[40:43], s52 offen sc1
    buffer_store_dwordx4 v[196:199], v3, s[40:43], s52 offen offset:1024 sc1
    s_waitcnt lgkmcnt(3)
    v_mfma_f32_32x32x16_bf16 v[128:143], v[184:187], a[60:63], v[128:143]
    ds_read_b128 v[168:171], v3 offset:17408
    buffer_load_dwordx4 a[220:223], v3, s[40:43], s49 offen offset:1024
    v_pk_mul_f32 v[96:97], v[96:97], v[60:61]
    v_exp_f32 v96, v96
    s_waitcnt lgkmcnt(3)
    v_mfma_f32_32x32x16_bf16 v[144:159], v[188:191], a[60:63], v[144:159]
    ds_read_b128 v[172:175], v3 offset:25600
    s_add_u32 s48, s100, s18
    s_add_u32 s49, s101, s18
    buffer_load_dwordx4 a[224:227], v3, s[40:43], s48 offen offset:0
    v_exp_f32 v97, v97
    v_pk_mul_f32 v[98:99], v[98:99], v[60:61]
    s_waitcnt lgkmcnt(3)
    v_mfma_f32_32x32x16_bf16 v[128:143], v[160:163], a[64:67], v[128:143]
    ds_read_b128 v[176:179], v3 offset:18432
    buffer_load_dwordx4 a[228:231], v3, s[40:43], s49 offen offset:0
    v_exp_f32 v98, v98
    v_exp_f32 v99, v99
    s_waitcnt lgkmcnt(3)
    v_mfma_f32_32x32x16_bf16 v[144:159], v[164:167], a[64:67], v[144:159]
    ds_read_b128 v[180:183], v3 offset:26624
    buffer_load_dwordx4 a[232:235], v3, s[40:43], s48 offen offset:1024
    v_pk_mul_f32 v[100:101], v[100:101], v[60:61]
    v_exp_f32 v100, v100
    s_waitcnt lgkmcnt(3)
    v_mfma_f32_32x32x16_bf16 v[128:143], v[168:171], a[68:71], v[128:143]
    ds_read_b128 v[184:187], v3 offset:19456
    buffer_load_dwordx4 a[236:239], v3, s[40:43], s49 offen offset:1024
    v_exp_f32 v101, v101
    v_pk_mul_f32 v[102:103], v[102:103], v[60:61]
    s_waitcnt lgkmcnt(3)
    v_mfma_f32_32x32x16_bf16 v[144:159], v[172:175], a[68:71], v[144:159]
    ds_read_b128 v[188:191], v3 offset:27648
    buffer_load_dwordx4 a[240:243], v3, s[40:43], s48 offen offset:2048
    v_exp_f32 v102, v102
    v_exp_f32 v103, v103
    s_waitcnt lgkmcnt(3)
    v_mfma_f32_32x32x16_bf16 v[128:143], v[176:179], a[72:75], v[128:143]
    ds_read_b128 v[160:163], v3 offset:20480
    buffer_load_dwordx4 a[244:247], v3, s[40:43], s49 offen offset:2048
    v_pk_mul_f32 v[104:105], v[104:105], v[60:61]
    v_exp_f32 v104, v104
    s_waitcnt lgkmcnt(3)
    v_mfma_f32_32x32x16_bf16 v[144:159], v[180:183], a[72:75], v[144:159]
    ds_read_b128 v[164:167], v3 offset:28672
    buffer_load_dwordx4 a[248:251], v3, s[40:43], s48 offen offset:3072
    v_exp_f32 v105, v105
    v_pk_mul_f32 v[106:107], v[106:107], v[60:61]
    s_waitcnt lgkmcnt(3)
    v_mfma_f32_32x32x16_bf16 v[128:143], v[184:187], a[76:79], v[128:143]
    ds_read_b128 v[168:171], v3 offset:21504
    buffer_load_dwordx4 a[252:255], v3, s[40:43], s49 offen offset:3072
    v_exp_f32 v106, v106
    v_exp_f32 v107, v107
    s_waitcnt lgkmcnt(3)
    v_mfma_f32_32x32x16_bf16 v[144:159], v[188:191], a[76:79], v[144:159]
    ds_read_b128 v[172:175], v3 offset:29696
    s_add_u32 s48, s48, 4096
    s_add_u32 s49, s49, 4096
    buffer_load_dwordx4 v[208:211], v3, s[40:43], s48 offen offset:0
    v_pk_mul_f32 v[108:109], v[108:109], v[60:61]
    v_exp_f32 v108, v108
    s_waitcnt lgkmcnt(3)
    v_mfma_f32_32x32x16_bf16 v[128:143], v[160:163], a[80:83], v[128:143]
    ds_read_b128 v[176:179], v3 offset:22528
    buffer_load_dwordx4 v[212:215], v3, s[40:43], s49 offen offset:0
    v_exp_f32 v109, v109
    v_pk_mul_f32 v[110:111], v[110:111], v[60:61]
    s_waitcnt lgkmcnt(3)
    v_mfma_f32_32x32x16_bf16 v[144:159], v[164:167], a[80:83], v[144:159]
    ds_read_b128 v[180:183], v3 offset:30720
    buffer_load_dwordx4 v[216:219], v3, s[40:43], s48 offen offset:1024
    v_exp_f32 v110, v110
    v_exp_f32 v111, v111
    s_waitcnt lgkmcnt(3)
    v_mfma_f32_32x32x16_bf16 v[128:143], v[168:171], a[84:87], v[128:143]
    ds_read_b128 v[184:187], v3 offset:23552
    buffer_load_dwordx4 v[220:223], v3, s[40:43], s49 offen offset:1024
    v_pk_fma_f32 v[96:97], v[96:97], v[62:63], v[62:63]
    v_rcp_f32 v96, v96
    s_waitcnt lgkmcnt(3)
    v_mfma_f32_32x32x16_bf16 v[144:159], v[172:175], a[84:87], v[144:159]
    ds_read_b128 v[188:191], v3 offset:31744
    v_rcp_f32 v97, v97
    v_pk_fma_f32 v[98:99], v[98:99], v[62:63], v[62:63]
    s_waitcnt lgkmcnt(3)
    v_mfma_f32_32x32x16_bf16 v[128:143], v[176:179], a[88:91], v[128:143]
    ds_read_b128 v[160:163], v3 offset:32768
    v_rcp_f32 v98, v98
    v_rcp_f32 v99, v99
    s_waitcnt lgkmcnt(3)
    v_mfma_f32_32x32x16_bf16 v[144:159], v[180:183], a[88:91], v[144:159]
    ds_read_b128 v[164:167], v3 offset:40960
    v_pk_fma_f32 v[100:101], v[100:101], v[62:63], v[62:63]
    v_rcp_f32 v100, v100
    s_waitcnt lgkmcnt(3)
    v_mfma_f32_32x32x16_bf16 v[128:143], v[184:187], a[92:95], v[128:143]
    ds_read_b128 v[168:171], v3 offset:33792
    v_rcp_f32 v101, v101
    v_pk_fma_f32 v[102:103], v[102:103], v[62:63], v[62:63]
    s_waitcnt lgkmcnt(3)
    v_mfma_f32_32x32x16_bf16 v[144:159], v[188:191], a[92:95], v[144:159]
    ds_read_b128 v[172:175], v3 offset:41984
    v_rcp_f32 v102, v102
    v_rcp_f32 v103, v103
    s_waitcnt lgkmcnt(3)
    v_mfma_f32_32x32x16_bf16 v[128:143], v[160:163], a[96:99], v[128:143]
    ds_read_b128 v[176:179], v3 offset:34816
    v_pk_fma_f32 v[104:105], v[104:105], v[62:63], v[62:63]
    v_rcp_f32 v104, v104
    s_waitcnt lgkmcnt(3)
    v_mfma_f32_32x32x16_bf16 v[144:159], v[164:167], a[96:99], v[144:159]
    ds_read_b128 v[180:183], v3 offset:43008
    v_rcp_f32 v105, v105
    v_pk_fma_f32 v[106:107], v[106:107], v[62:63], v[62:63]
    s_waitcnt lgkmcnt(3)
    v_mfma_f32_32x32x16_bf16 v[128:143], v[168:171], a[100:103], v[128:143]
    ds_read_b128 v[184:187], v3 offset:35840
    v_rcp_f32 v106, v106
    v_rcp_f32 v107, v107
    s_waitcnt lgkmcnt(3)
    v_mfma_f32_32x32x16_bf16 v[144:159], v[172:175], a[100:103], v[144:159]
    ds_read_b128 v[188:191], v3 offset:44032
    v_pk_fma_f32 v[108:109], v[108:109], v[62:63], v[62:63]
    v_rcp_f32 v108, v108
    s_waitcnt lgkmcnt(3)
    v_mfma_f32_32x32x16_bf16 v[128:143], v[176:179], a[104:107], v[128:143]
    ds_read_b128 v[160:163], v3 offset:36864
    v_rcp_f32 v109, v109
    v_pk_fma_f32 v[110:111], v[110:111], v[62:63], v[62:63]
    s_waitcnt lgkmcnt(3)
    v_mfma_f32_32x32x16_bf16 v[144:159], v[180:183], a[104:107], v[144:159]
    ds_read_b128 v[164:167], v3 offset:45056
    v_rcp_f32 v110, v110
    v_rcp_f32 v111, v111
    s_waitcnt lgkmcnt(3)
    v_mfma_f32_32x32x16_bf16 v[128:143], v[184:187], a[108:111], v[128:143]
    ds_read_b128 v[168:171], v3 offset:37888
    v_pk_mul_f32 v[112:113], v[112:113], v[96:97]
    v_pk_mul_f32 v[114:115], v[114:115], v[98:99]
    v_pk_mul_f32 v[116:117], v[116:117], v[100:101]
    v_pk_mul_f32 v[118:119], v[118:119], v[102:103]
    s_waitcnt lgkmcnt(3)
    v_mfma_f32_32x32x16_bf16 v[144:159], v[188:191], a[108:111], v[144:159]
    ds_read_b128 v[172:175], v3 offset:46080
    v_pk_mul_f32 v[120:121], v[120:121], v[104:105]
    v_pk_mul_f32 v[122:123], v[122:123], v[106:107]
    v_pk_mul_f32 v[124:125], v[124:125], v[108:109]
    v_pk_mul_f32 v[126:127], v[126:127], v[110:111]
    s_waitcnt lgkmcnt(3)
    v_mfma_f32_32x32x16_bf16 v[128:143], v[160:163], a[112:115], v[128:143]
    ds_read_b128 v[176:179], v3 offset:38912
    v_cvt_pk_bf16_f32 v200, v112, v113
    v_cvt_pk_bf16_f32 v201, v114, v115
    v_cvt_pk_bf16_f32 v202, v116, v117
    v_cvt_pk_bf16_f32 v203, v118, v119
    s_waitcnt lgkmcnt(3)
    v_mfma_f32_32x32x16_bf16 v[144:159], v[164:167], a[112:115], v[144:159]
    ds_read_b128 v[180:183], v3 offset:47104
    v_cvt_pk_bf16_f32 v204, v120, v121
    v_cvt_pk_bf16_f32 v205, v122, v123
    v_cvt_pk_bf16_f32 v206, v124, v125
    v_cvt_pk_bf16_f32 v207, v126, v127
    s_waitcnt lgkmcnt(3)
    v_mfma_f32_32x32x16_bf16 v[128:143], v[168:171], a[116:119], v[128:143]
    ds_read_b128 v[184:187], v3 offset:39936
    buffer_store_dwordx4 v[200:203], v3, s[40:43], s53 offen sc1
    buffer_store_dwordx4 v[204:207], v3, s[40:43], s53 offen offset:1024 sc1
    s_waitcnt lgkmcnt(3)
    v_mfma_f32_32x32x16_bf16 v[144:159], v[172:175], a[116:119], v[144:159]
    ds_read_b128 v[188:191], v3 offset:48128
    s_waitcnt lgkmcnt(3)
    v_mfma_f32_32x32x16_bf16 v[128:143], v[176:179], a[120:123], v[128:143]
    s_waitcnt lgkmcnt(2)
    v_mfma_f32_32x32x16_bf16 v[144:159], v[180:183], a[120:123], v[144:159]
    s_waitcnt lgkmcnt(1)
    v_mfma_f32_32x32x16_bf16 v[128:143], v[184:187], a[124:127], v[128:143]
    s_waitcnt lgkmcnt(0)
    v_mfma_f32_32x32x16_bf16 v[144:159], v[188:191], a[124:127], v[144:159]
    s_nop 9
    v_pk_mul_f32 v[128:129], v[128:129], v[60:61]
    v_exp_f32 v128, v128
    v_exp_f32 v129, v129
    v_pk_mul_f32 v[130:131], v[130:131], v[60:61]
    v_exp_f32 v130, v130
    v_exp_f32 v131, v131
    v_pk_mul_f32 v[132:133], v[132:133], v[60:61]
    v_exp_f32 v132, v132
    v_exp_f32 v133, v133
    v_pk_mul_f32 v[134:135], v[134:135], v[60:61]
    v_exp_f32 v134, v134
    v_exp_f32 v135, v135
    v_pk_mul_f32 v[136:137], v[136:137], v[60:61]
    v_exp_f32 v136, v136
    v_exp_f32 v137, v137
    v_pk_mul_f32 v[138:139], v[138:139], v[60:61]
    v_exp_f32 v138, v138
    v_exp_f32 v139, v139
    v_pk_mul_f32 v[140:141], v[140:141], v[60:61]
    v_exp_f32 v140, v140
    v_exp_f32 v141, v141
    v_pk_mul_f32 v[142:143], v[142:143], v[60:61]
    v_exp_f32 v142, v142
    v_exp_f32 v143, v143
    v_pk_fma_f32 v[128:129], v[128:129], v[62:63], v[62:63]
    v_rcp_f32 v128, v128
    v_rcp_f32 v129, v129
    v_pk_fma_f32 v[130:131], v[130:131], v[62:63], v[62:63]
    v_rcp_f32 v130, v130
    v_rcp_f32 v131, v131
    v_pk_fma_f32 v[132:133], v[132:133], v[62:63], v[62:63]
    v_rcp_f32 v132, v132
    v_rcp_f32 v133, v133
    v_pk_fma_f32 v[134:135], v[134:135], v[62:63], v[62:63]
    v_rcp_f32 v134, v134
    v_rcp_f32 v135, v135
    v_pk_fma_f32 v[136:137], v[136:137], v[62:63], v[62:63]
    v_rcp_f32 v136, v136
    v_rcp_f32 v137, v137
    v_pk_fma_f32 v[138:139], v[138:139], v[62:63], v[62:63]
    v_rcp_f32 v138, v138
    v_rcp_f32 v139, v139
    v_pk_fma_f32 v[140:141], v[140:141], v[62:63], v[62:63]
    v_rcp_f32 v140, v140
    v_rcp_f32 v141, v141
    v_pk_fma_f32 v[142:143], v[142:143], v[62:63], v[62:63]
    v_rcp_f32 v142, v142
    v_rcp_f32 v143, v143
    v_pk_mul_f32 v[144:145], v[144:145], v[128:129]
    v_pk_mul_f32 v[146:147], v[146:147], v[130:131]
    v_pk_mul_f32 v[148:149], v[148:149], v[132:133]
    v_pk_mul_f32 v[150:151], v[150:151], v[134:135]
    v_pk_mul_f32 v[152:153], v[152:153], v[136:137]
    v_pk_mul_f32 v[154:155], v[154:155], v[138:139]
    v_pk_mul_f32 v[156:157], v[156:157], v[140:141]
    v_pk_mul_f32 v[158:159], v[158:159], v[142:143]
    v_cvt_pk_bf16_f32 v192, v144, v145
    v_cvt_pk_bf16_f32 v193, v146, v147
    v_cvt_pk_bf16_f32 v194, v148, v149
    v_cvt_pk_bf16_f32 v195, v150, v151
    v_cvt_pk_bf16_f32 v196, v152, v153
    v_cvt_pk_bf16_f32 v197, v154, v155
    v_cvt_pk_bf16_f32 v198, v156, v157
    v_cvt_pk_bf16_f32 v199, v158, v159
    buffer_store_dwordx4 v[192:195], v3, s[40:43], s54 offen sc1
    buffer_store_dwordx4 v[196:199], v3, s[40:43], s54 offen offset:1024 sc1
    s_lshl_b32 s13, s9, 11
    s_lshl_b32 s63, s8, 2
    s_add_u32 s13, s13, s63
    s_add_u32 s13, s13, 0x88000
    v_mov_b32 v5, 0
    buffer_load_dword v5, v1, s[40:43], s28 offen sc1
    s_waitcnt vmcnt(1)
    v_mov_b32 v13, 1
    v_mov_b32 v14, 155680
    s_mov_b64 exec, 1
    ds_add_rtn_u32 v15, v14, v13
    s_mov_b64 exec, 0xffff
    v_lshlrev_b32 v14, 7, v2
    s_waitcnt lgkmcnt(0)
    v_readfirstlane_b32 s63, v15
    s_nop 0
    s_and_b32 s63, s63, 3
    s_cmp_lg_u32 s63, 3
    s_cbranch_scc1 k345_b3_f4
    buffer_store_dword v13, v14, s[40:43], s13 offen sc1
k345_b3_f4:
    s_mov_b64 exec, -1
    s_branch k345_p4done
k345_two:
    s_add_u32 m0, s10, 98304
    s_add_u32 s63, s96, 0
    buffer_load_dwordx4 v195, s[40:43], s63 offen lds
    s_add_u32 m0, s10, 102400
    s_add_u32 s63, s96, 32768
    buffer_load_dwordx4 v195, s[40:43], s63 offen lds
    s_add_u32 m0, s10, 106496
    s_add_u32 s63, s96, 65536
    buffer_load_dwordx4 v195, s[40:43], s63 offen lds
    s_add_u32 m0, s10, 110592
    s_add_u32 s63, s96, 98304
    buffer_load_dwordx4 v195, s[40:43], s63 offen lds
    s_add_u32 m0, s10, 114688
    s_add_u32 s63, s96, 4096
    buffer_load_dwordx4 v195, s[40:43], s63 offen lds
    s_add_u32 m0, s10, 118784
    s_add_u32 s63, s96, 36864
    buffer_load_dwordx4 v195, s[40:43], s63 offen lds
    s_add_u32 m0, s10, 122880
    s_add_u32 s63, s96, 69632
    buffer_load_dwordx4 v195, s[40:43], s63 offen lds
    s_add_u32 m0, s10, 126976
    s_add_u32 s63, s96, 102400
    buffer_load_dwordx4 v195, s[40:43], s63 offen lds
    s_lshl_b32 s13, s3, 10
    s_add_u32 s13, s13, 147456
    v_add_u32 v15, s13, v3
    v_cmp_gt_u32 vcc, 32, v2
    v_pk_add_f32 v[196:197], v[196:197], v[204:205]
    v_pk_add_f32 v[198:199], v[198:199], v[206:207]
    v_pk_add_f32 v[200:201], v[200:201], v[208:209]
    v_pk_add_f32 v[202:203], v[202:203], v[210:211]
    v_pk_add_f32 v[196:197], v[196:197], v[200:201]
    v_pk_add_f32 v[198:199], v[198:199], v[202:203]
    v_pk_add_f32 v[196:197], v[196:197], v[198:199]
    v_mov_b32 v198, v196
    v_mov_b32 v199, v197
    s_nop 0
    v_permlane32_swap_b32 v196, v198
    v_permlane32_swap_b32 v197, v199
    v_pk_add_f32 v[196:197], v[196:197], v[198:199]
    v_cndmask_b32 v196, 0, v196, vcc
    v_cndmask_b32 v197, 0, v197, vcc
    v_cvt_pk_bf16_f32 v200, v196, v197
    v_lshlrev_b32 v198, 16, v200
    v_and_b32 v199, 0xffff0000, v200
    v_sub_f32 v196, v196, v198
    v_sub_f32 v197, v197, v199
    v_cvt_pk_bf16_f32 v201, v196, v197
    v_lshlrev_b32 v198, 16, v201
    v_and_b32 v199, 0xffff0000, v201
    v_sub_f32 v196, v196, v198
    v_sub_f32 v197, v197, v199
    v_cvt_pk_bf16_f32 v202, v196, v197
    v_mov_b32 v203, 0
    ds_write_b128 v15, v[200:203] offset:0
    s_lshl_b32 s12, s99, 8
    s_add_u32 s12, s12, 0x10000
    s_lshl_b32 s50, s99, 15
    s_add_u32 s50, s50, 0x1400000
    s_add_u32 s51, s50, 4096
    s_mul_i32 s13, s99, 86
    s_lshl_b32 s63, s98, 1
    s_add_u32 s13, s13, s63
    s_lshl_b32 s13, s13, 10
    s_add_u32 s52, s13, 0x1600000
    s_add_u32 s53, s13, 0x1600800
    s_add_u32 s54, s13, 0x1601000
    s_lshl_b32 s13, s9, 4
    s_add_u32 s13, s13, s8
    s_lshl_b32 s13, s13, 7
    s_add_u32 s13, s13, 0x80000
    s_mov_b32 s14, 0xffff
    s_mov_b32 s15, 0
    s_mov_b32 s62, 0
    s_cmp_lg_u32 s3, 0
    s_cbranch_scc1 k345_b2_poll_ok
    v_mov_b32 v5, 0
k345_b2_poll:
    buffer_load_dword v5, v1, s[40:43], s13 offen sc1
    s_sleep 1
    s_waitcnt vmcnt(24)
    v_cmp_eq_u32 vcc, 1, v5
    s_nop 0
    s_and_b64 vcc, vcc, s[14:15]
    s_cmp_eq_u64 vcc, s[14:15]
    s_cbranch_scc1 k345_b2_poll_ok
    s_add_u32 s62, s62, 1
    s_cmp_lt_u32 s62, 16000
    s_nop 0
    s_cbranch_scc1 k345_b2_poll
    s_mov_b32 s62, 1
    s_branch k345_b2_poll_to
k345_b2_poll_ok:
    s_mov_b32 s62, 0
k345_b2_poll_to:
    s_lshl_b32 s63, s3, 2
    s_add_u32 s63, s63, 155648
    v_mov_b32 v13, s63
    v_mov_b32 v14, s62
    ds_write_b32 v13, v14
    v_mov_b32 v13, 155648
    s_waitcnt lgkmcnt(0)
    s_barrier
    ds_read_b128 v[144:147], v13
    v_add_u32 v15, 147456, v3
    ds_read_b128 v[32:35], v15 offset:0
    ds_read_b128 v[36:39], v15 offset:1024
    ds_read_b128 v[40:43], v15 offset:2048
    ds_read_b128 v[44:47], v15 offset:3072
    s_waitcnt lgkmcnt(4)
    v_or3_b32 v144, v144, v145, v146
    v_or_b32 v144, v144, v147
    s_nop 0
    v_readfirstlane_b32 s63, v144
    s_nop 0
    s_cmp_lg_u32 s63, 0
    s_cbranch_scc1 k345_help3
    buffer_load_dwordx4 a[0:3], v192, s[40:43], s50 offen offset:0
    buffer_load_dwordx4 a[4:7], v192, s[40:43], s50 offen offset:1024
    buffer_load_dwordx4 a[8:11], v192, s[40:43], s50 offen offset:2048
    buffer_load_dwordx4 a[12:15], v192, s[40:43], s50 offen offset:3072
    buffer_load_dwordx2 v[16:17], v6, s[40:43], s12 offen
    s_add_u32 s12, s12, 16384
    buffer_load_dwordx2 v[18:19], v6, s[40:43], s12 offen
    s_add_u32 s12, s12, 16384
    buffer_load_dwordx2 v[20:21], v6, s[40:43], s12 offen
    s_add_u32 s12, s12, 16384
    buffer_load_dwordx2 v[22:23], v6, s[40:43], s12 offen
    s_add_u32 s12, s12, 16384
    buffer_load_dwordx2 v[24:25], v6, s[40:43], s12 offen
    s_add_u32 s12, s12, 16384
    buffer_load_dwordx2 v[26:27], v6, s[40:43], s12 offen
    s_add_u32 s12, s12, 16384
    buffer_load_dwordx2 v[28:29], v6, s[40:43], s12 offen
    s_add_u32 s12, s12, 16384
    buffer_load_dwordx2 v[30:31], v6, s[40:43], s12 offen
    buffer_load_dwordx4 a[16:19], v192, s[40:43], s51 offen offset:0
    buffer_load_dwordx4 a[20:23], v192, s[40:43], s51 offen offset:1024
    buffer_load_dwordx4 a[24:27], v192, s[40:43], s51 offen offset:2048
    buffer_load_dwordx4 a[28:31], v192, s[40:43], s51 offen offset:3072
    buffer_load_dwordx4 a[32:35], v193, s[40:43], s50 offen offset:0
    buffer_load_dwordx4 a[36:39], v193, s[40:43], s50 offen offset:1024
    buffer_load_dwordx4 a[40:43], v193, s[40:43], s50 offen offset:2048
    buffer_load_dwordx4 a[44:47], v193, s[40:43], s50 offen offset:3072
    s_lshr_b32 s63, s2, 5
    s_lshl_b32 s63, s63, 1
    s_add_u32 s100, s63, s7
    s_xor_b32 s101, s100, 1
    s_mul_i32 s100, s100, 86
    s_lshl_b32 s100, s100, 10
    s_add_u32 s100, s100, 0x800000
    s_mul_i32 s101, s101, 86
    s_lshl_b32 s101, s101, 10
    s_add_u32 s101, s101, 0x800000
    s_waitcnt vmcnt(20)
    s_barrier
    ds_read_b128 v[160:163], v3 offset:0
    ds_read_b128 v[164:167], v3 offset:4096
    ds_read_b128 v[168:171], v3 offset:8192
    ds_read_b128 v[172:175], v3 offset:12288
    s_waitcnt vmcnt(16)
    s_waitcnt lgkmcnt(3)
    v_mfma_f32_32x32x16_bf16 v[64:79], v[160:163], a[0:3], 0
    ds_read_b128 v[176:179], v3 offset:1024
    s_waitcnt lgkmcnt(3)
    v_mfma_f32_32x32x16_bf16 v[80:95], v[164:167], a[0:3], 0
    ds_read_b128 v[180:183], v3 offset:5120
    buffer_load_dwordx4 a[48:51], v193, s[40:43], s51 offen offset:0
    s_waitcnt lgkmcnt(3)
    v_mfma_f32_32x32x16_bf16 v[96:111], v[168:171], a[0:3], 0
    ds_read_b128 v[184:187], v3 offset:9216
    s_waitcnt lgkmcnt(3)
    v_mfma_f32_32x32x16_bf16 v[112:127], v[172:175], a[0:3], 0
    ds_read_b128 v[188:191], v3 offset:13312
    s_waitcnt lgkmcnt(3)
    v_mfma_f32_32x32x16_bf16 v[64:79], v[176:179], a[4:7], v[64:79]
    ds_read_b128 v[160:163], v3 offset:2048
    s_waitcnt lgkmcnt(3)
    v_mfma_f32_32x32x16_bf16 v[80:95], v[180:183], a[4:7], v[80:95]
    ds_read_b128 v[164:167], v3 offset:6144
    buffer_load_dwordx4 a[52:55], v193, s[40:43], s51 offen offset:1024
    s_waitcnt lgkmcnt(3)
    v_mfma_f32_32x32x16_bf16 v[96:111], v[184:187], a[4:7], v[96:111]
    ds_read_b128 v[168:171], v3 offset:10240
    s_waitcnt vmcnt(10)
    v_pk_add_f32 v[16:17], v[16:17], v[20:21]
    v_pk_add_f32 v[16:17], v[16:17], v[24:25]
    v_pk_add_f32 v[16:17], v[16:17], v[28:29]
    v_pk_add_f32 v[18:19], v[18:19], v[22:23]
    v_pk_add_f32 v[18:19], v[18:19], v[26:27]
    v_pk_add_f32 v[18:19], v[18:19], v[30:31]
    v_pk_add_f32 v[16:17], v[16:17], v[18:19]
    v_mov_b32 v18, v16
    v_mov_b32 v19, v17
    s_nop 0
    v_permlane32_swap_b32 v16, v18
    v_permlane32_swap_b32 v17, v19
    v_pk_add_f32 v[16:17], v[16:17], v[18:19]
    v_mul_f32 v16, 0x3b000000, v16
    v_mul_f32 v17, 0x3b000000, v17
    v_fma_f32 v17, -v16, v16, v17
    v_max_f32 v17, 0, v17
    v_cvt_pk_bf16_f32 v17, v17, v17
    v_lshlrev_b32 v17, 16, v17
    v_add_f32 v17, 0x3727c5ac, v17
    v_cvt_pk_bf16_f32 v17, v17, v17
    v_lshlrev_b32 v17, 16, v17
    v_sqrt_f32 v17, v17
    v_sub_f32 v16, 0, v16
    v_cvt_pk_bf16_f32 v56, v16, v17
    v_mov_b32 v57, v56
    v_mov_b32 v58, v56
    v_mov_b32 v59, 0
    v_and_b32 v62, 0xffff0000, v56
    v_rcp_f32 v18, v62
    v_mov_b32 v63, v62
    v_mul_f32 v60, 0xbfb8aa3b, v18
    v_mul_f32 v61, 0xbfb8aa3b, v18
    s_waitcnt lgkmcnt(3)
    v_mfma_f32_32x32x16_bf16 v[112:127], v[188:191], a[4:7], v[112:127]
    ds_read_b128 v[172:175], v3 offset:14336
    s_waitcnt lgkmcnt(3)
    v_mfma_f32_32x32x16_bf16 v[64:79], v[160:163], a[8:11], v[64:79]
    ds_read_b128 v[176:179], v3 offset:3072
    s_waitcnt lgkmcnt(3)
    v_mfma_f32_32x32x16_bf16 v[80:95], v[164:167], a[8:11], v[80:95]
    ds_read_b128 v[180:183], v3 offset:7168
    buffer_load_dwordx4 a[56:59], v193, s[40:43], s51 offen offset:2048
    s_waitcnt lgkmcnt(3)
    v_mfma_f32_32x32x16_bf16 v[96:111], v[168:171], a[8:11], v[96:111]
    ds_read_b128 v[184:187], v3 offset:11264
    s_waitcnt lgkmcnt(3)
    v_mfma_f32_32x32x16_bf16 v[112:127], v[172:175], a[8:11], v[112:127]
    ds_read_b128 v[188:191], v3 offset:15360
    s_waitcnt lgkmcnt(3)
    v_mfma_f32_32x32x16_bf16 v[64:79], v[176:179], a[12:15], v[64:79]
    ds_read_b128 v[160:163], v3 offset:16384
    s_waitcnt lgkmcnt(3)
    v_mfma_f32_32x32x16_bf16 v[80:95], v[180:183], a[12:15], v[80:95]
    ds_read_b128 v[164:167], v3 offset:20480
    buffer_load_dwordx4 a[60:63], v193, s[40:43], s51 offen offset:3072
    s_waitcnt lgkmcnt(3)
    v_mfma_f32_32x32x16_bf16 v[96:111], v[184:187], a[12:15], v[96:111]
    ds_read_b128 v[168:171], v3 offset:24576
    s_waitcnt lgkmcnt(3)
    v_mfma_f32_32x32x16_bf16 v[112:127], v[188:191], a[12:15], v[112:127]
    ds_read_b128 v[172:175], v3 offset:28672
    v_mfma_f32_32x32x16_bf16 v[64:79], v[32:35], v[56:59], v[64:79]
    v_mfma_f32_32x32x16_bf16 v[80:95], v[36:39], v[56:59], v[80:95]
    v_mfma_f32_32x32x16_bf16 v[96:111], v[40:43], v[56:59], v[96:111]
    v_mfma_f32_32x32x16_bf16 v[112:127], v[44:47], v[56:59], v[112:127]
    s_waitcnt vmcnt(8)
    s_waitcnt lgkmcnt(3)
    v_mfma_f32_32x32x16_bf16 v[64:79], v[160:163], a[16:19], v[64:79]
    ds_read_b128 v[176:179], v3 offset:17408
    s_waitcnt lgkmcnt(3)
    v_mfma_f32_32x32x16_bf16 v[80:95], v[164:167], a[16:19], v[80:95]
    ds_read_b128 v[180:183], v3 offset:21504
    buffer_load_dwordx4 a[64:67], v194, s[40:43], s50 offen offset:0
    s_waitcnt lgkmcnt(3)
    v_mfma_f32_32x32x16_bf16 v[96:111], v[168:171], a[16:19], v[96:111]
    ds_read_b128 v[184:187], v3 offset:25600
    s_waitcnt lgkmcnt(3)
    v_mfma_f32_32x32x16_bf16 v[112:127], v[172:175], a[16:19], v[112:127]
    ds_read_b128 v[188:191], v3 offset:29696
    s_waitcnt lgkmcnt(3)
    v_mfma_f32_32x32x16_bf16 v[64:79], v[176:179], a[20:23], v[64:79]
    ds_read_b128 v[160:163], v3 offset:18432
    s_waitcnt lgkmcnt(3)
    v_mfma_f32_32x32x16_bf16 v[80:95], v[180:183], a[20:23], v[80:95]
    ds_read_b128 v[164:167], v3 offset:22528
    buffer_load_dwordx4 a[68:71], v194, s[40:43], s50 offen offset:1024
    s_waitcnt lgkmcnt(3)
    v_mfma_f32_32x32x16_bf16 v[96:111], v[184:187], a[20:23], v[96:111]
    ds_read_b128 v[168:171], v3 offset:26624
    s_waitcnt lgkmcnt(3)
    v_mfma_f32_32x32x16_bf16 v[112:127], v[188:191], a[20:23], v[112:127]
    ds_read_b128 v[172:175], v3 offset:30720
    s_waitcnt lgkmcnt(3)
    v_mfma_f32_32x32x16_bf16 v[64:79], v[160:163], a[24:27], v[64:79]
    ds_read_b128 v[176:179], v3 offset:19456
    s_waitcnt lgkmcnt(3)
    v_mfma_f32_32x32x16_bf16 v[80:95], v[164:167], a[24:27], v[80:95]
    ds_read_b128 v[180:183], v3 offset:23552
    buffer_load_dwordx4 a[72:75], v194, s[40:43], s50 offen offset:2048
    s_waitcnt lgkmcnt(3)
    v_mfma_f32_32x32x16_bf16 v[96:111], v[168:171], a[24:27], v[96:111]
    ds_read_b128 v[184:187], v3 offset:27648
    s_waitcnt lgkmcnt(3)
    v_mfma_f32_32x32x16_bf16 v[112:127], v[172:175], a[24:27], v[112:127]
    ds_read_b128 v[188:191], v3 offset:31744
    s_waitcnt lgkmcnt(3)
    v_mfma_f32_32x32x16_bf16 v[64:79], v[176:179], a[28:31], v[64:79]
    ds_read_b128 v[160:163], v3 offset:32768
    s_waitcnt lgkmcnt(3)
    v_mfma_f32_32x32x16_bf16 v[80:95], v[180:183], a[28:31], v[80:95]
    ds_read_b128 v[164:167], v3 offset:36864
    buffer_load_dwordx4 a[76:79], v194, s[40:43], s50 offen offset:3072
    s_waitcnt lgkmcnt(3)
    v_mfma_f32_32x32x16_bf16 v[96:111], v[184:187], a[28:31], v[96:111]
    ds_read_b128 v[168:171], v3 offset:40960
    s_waitcnt lgkmcnt(3)
    v_mfma_f32_32x32x16_bf16 v[112:127], v[188:191], a[28:31], v[112:127]
    ds_read_b128 v[172:175], v3 offset:45056
    s_waitcnt vmcnt(8)
    s_waitcnt lgkmcnt(3)
    v_mfma_f32_32x32x16_bf16 v[64:79], v[160:163], a[32:35], v[64:79]
    ds_read_b128 v[176:179], v3 offset:33792
    s_waitcnt lgkmcnt(3)
    v_mfma_f32_32x32x16_bf16 v[80:95], v[164:167], a[32:35], v[80:95]
    ds_read_b128 v[180:183], v3 offset:37888
    buffer_load_dwordx4 a[80:83], v194, s[40:43], s51 offen offset:0
    s_waitcnt lgkmcnt(3)
    v_mfma_f32_32x32x16_bf16 v[96:111], v[168:171], a[32:35], v[96:111]
    ds_read_b128 v[184:187], v3 offset:41984
    s_waitcnt lgkmcnt(3)
    v_mfma_f32_32x32x16_bf16 v[112:127], v[172:175], a[32:35], v[112:127]
    ds_read_b128 v[188:191], v3 offset:46080
    s_waitcnt lgkmcnt(3)
    v_mfma_f32_32x32x16_bf16 v[64:79], v[176:179], a[36:39], v[64:79]
    ds_read_b128 v[160:163], v3 offset:34816
    s_waitcnt lgkmcnt(3)
    v_mfma_f32_32x32x16_bf16 v[80:95], v[180:183], a[36:39], v[80:95]
    ds_read_b128 v[164:167], v3 offset:38912
    buffer_load_dwordx4 a[84:87], v194, s[40:43], s51 offen offset:1024
    s_waitcnt lgkmcnt(3)
    v_mfma_f32_32x32x16_bf16 v[96:111], v[184:187], a[36:39], v[96:111]
    ds_read_b128 v[168:171], v3 offset:43008
    s_waitcnt lgkmcnt(3)
    v_mfma_f32_32x32x16_bf16 v[112:127], v[188:191], a[36:39], v[112:127]
    ds_read_b128 v[172:175], v3 offset:47104
    s_waitcnt lgkmcnt(3)
    v_mfma_f32_32x32x16_bf16 v[64:79], v[160:163], a[40:43], v[64:79]
    ds_read_b128 v[176:179], v3 offset:35840
    s_waitcnt lgkmcnt(3)
    v_mfma_f32_32x32x16_bf16 v[80:95], v[164:167], a[40:43], v[80:95]
    ds_read_b128 v[180:183], v3 offset:39936
    buffer_load_dwordx4 a[88:91], v194, s[40:43], s51 offen offset:2048
    s_waitcnt lgkmcnt(3)
    v_mfma_f32_32x32x16_bf16 v[96:111], v[168:171], a[40:43], v[96:111]
    ds_read_b128 v[184:187], v3 offset:44032
    s_waitcnt lgkmcnt(3)
    v_mfma_f32_32x32x16_bf16 v[112:127], v[172:175], a[40:43], v[112:127]
    ds_read_b128 v[188:191], v3 offset:48128
    s_waitcnt lgkmcnt(3)
    v_mfma_f32_32x32x16_bf16 v[64:79], v[176:179], a[44:47], v[64:79]
    ds_read_b128 v[160:163], v3 offset:49152
    s_waitcnt lgkmcnt(3)
    v_mfma_f32_32x32x16_bf16 v[80:95], v[180:183], a[44:47], v[80:95]
    ds_read_b128 v[164:167], v3 offset:53248
    buffer_load_dwordx4 a[92:95], v194, s[40:43], s51 offen offset:3072
    s_waitcnt lgkmcnt(3)
    v_mfma_f32_32x32x16_bf16 v[96:111], v[184:187], a[44:47], v[96:111]
    ds_read_b128 v[168:171], v3 offset:57344
    s_waitcnt lgkmcnt(3)
    v_mfma_f32_32x32x16_bf16 v[112:127], v[188:191], a[44:47], v[112:127]
    ds_read_b128 v[172:175], v3 offset:61440
    s_waitcnt vmcnt(8)
    s_waitcnt lgkmcnt(3)
    v_mfma_f32_32x32x16_bf16 v[64:79], v[160:163], a[48:51], v[64:79]
    ds_read_b128 v[176:179], v3 offset:50176
    s_waitcnt lgkmcnt(3)
    v_mfma_f32_32x32x16_bf16 v[80:95], v[164:167], a[48:51], v[80:95]
    ds_read_b128 v[180:183], v3 offset:54272
    buffer_load_dwordx4 a[96:99], v195, s[40:43], s50 offen offset:0
    s_waitcnt lgkmcnt(3)
    v_mfma_f32_32x32x16_bf16 v[96:111], v[168:171], a[48:51], v[96:111]
    ds_read_b128 v[184:187], v3 offset:58368
    s_waitcnt lgkmcnt(3)
    v_mfma_f32_32x32x16_bf16 v[112:127], v[172:175], a[48:51], v[112:127]
    ds_read_b128 v[188:191], v3 offset:62464
    s_waitcnt lgkmcnt(3)
    v_mfma_f32_32x32x16_bf16 v[64:79], v[176:179], a[52:55], v[64:79]
    ds_read_b128 v[160:163], v3 offset:51200
    s_waitcnt lgkmcnt(3)
    v_mfma_f32_32x32x16_bf16 v[80:95], v[180:183], a[52:55], v[80:95]
    ds_read_b128 v[164:167], v3 offset:55296
    buffer_load_dwordx4 a[100:103], v195, s[40:43], s50 offen offset:1024
    s_waitcnt lgkmcnt(3)
    v_mfma_f32_32x32x16_bf16 v[96:111], v[184:187], a[52:55], v[96:111]
    ds_read_b128 v[168:171], v3 offset:59392
    s_waitcnt lgkmcnt(3)
    v_mfma_f32_32x32x16_bf16 v[112:127], v[188:191], a[52:55], v[112:127]
    ds_read_b128 v[172:175], v3 offset:63488
    s_waitcnt lgkmcnt(3)
    v_mfma_f32_32x32x16_bf16 v[64:79], v[160:163], a[56:59], v[64:79]
    ds_read_b128 v[176:179], v3 offset:52224
    s_waitcnt lgkmcnt(3)
    v_mfma_f32_32x32x16_bf16 v[80:95], v[164:167], a[56:59], v[80:95]
    ds_read_b128 v[180:183], v3 offset:56320
    buffer_load_dwordx4 a[104:107], v195, s[40:43], s50 offen offset:2048
    s_waitcnt lgkmcnt(3)
    v_mfma_f32_32x32x16_bf16 v[96:111], v[168:171], a[56:59], v[96:111]
    ds_read_b128 v[184:187], v3 offset:60416
    s_waitcnt lgkmcnt(3)
    v_mfma_f32_32x32x16_bf16 v[112:127], v[172:175], a[56:59], v[112:127]
    ds_read_b128 v[188:191], v3 offset:64512
    s_waitcnt lgkmcnt(3)
    v_mfma_f32_32x32x16_bf16 v[64:79], v[176:179], a[60:63], v[64:79]
    ds_read_b128 v[160:163], v11 offset:0
    s_waitcnt lgkmcnt(3)
    v_mfma_f32_32x32x16_bf16 v[80:95], v[180:183], a[60:63], v[80:95]
    ds_read_b128 v[164:167], v11 offset:4096
    buffer_load_dwordx4 a[108:111], v195, s[40:43], s50 offen offset:3072
    s_waitcnt lgkmcnt(3)
    v_mfma_f32_32x32x16_bf16 v[96:111], v[184:187], a[60:63], v[96:111]
    ds_read_b128 v[168:171], v11 offset:8192
    s_waitcnt lgkmcnt(3)
    v_mfma_f32_32x32x16_bf16 v[112:127], v[188:191], a[60:63], v[112:127]
    ds_read_b128 v[172:175], v11 offset:12288
    s_waitcnt vmcnt(8)
    s_waitcnt lgkmcnt(3)
    v_mfma_f32_32x32x16_bf16 v[64:79], v[160:163], a[64:67], v[64:79]
    ds_read_b128 v[176:179], v11 offset:1024
    s_waitcnt lgkmcnt(3)
    v_mfma_f32_32x32x16_bf16 v[80:95], v[164:167], a[64:67], v[80:95]
    ds_read_b128 v[180:183], v11 offset:5120
    buffer_load_dwordx4 a[112:115], v195, s[40:43], s51 offen offset:0
    s_waitcnt lgkmcnt(3)
    v_mfma_f32_32x32x16_bf16 v[96:111], v[168:171], a[64:67], v[96:111]
    ds_read_b128 v[184:187], v11 offset:9216
    s_waitcnt lgkmcnt(3)
    v_mfma_f32_32x32x16_bf16 v[112:127], v[172:175], a[64:67], v[112:127]
    ds_read_b128 v[188:191], v11 offset:13312
    s_waitcnt lgkmcnt(3)
    v_mfma_f32_32x32x16_bf16 v[64:79], v[176:179], a[68:71], v[64:79]
    ds_read_b128 v[160:163], v11 offset:2048
    s_waitcnt lgkmcnt(3)
    v_mfma_f32_32x32x16_bf16 v[80:95], v[180:183], a[68:71], v[80:95]
    ds_read_b128 v[164:167], v11 offset:6144
    buffer_load_dwordx4 a[116:119], v195, s[40:43], s51 offen offset:1024
    s_waitcnt lgkmcnt(3)
    v_mfma_f32_32x32x16_bf16 v[96:111], v[184:187], a[68:71], v[96:111]
    ds_read_b128 v[168:171], v11 offset:10240
    s_waitcnt lgkmcnt(3)
    v_mfma_f32_32x32x16_bf16 v[112:127], v[188:191], a[68:71], v[112:127]
    ds_read_b128 v[172:175], v11 offset:14336
    s_waitcnt lgkmcnt(3)
    v_mfma_f32_32x32x16_bf16 v[64:79], v[160:163], a[72:75], v[64:79]
    ds_read_b128 v[176:179], v11 offset:3072
    s_waitcnt lgkmcnt(3)
    v_mfma_f32_32x32x16_bf16 v[80:95], v[164:167], a[72:75], v[80:95]
    ds_read_b128 v[180:183], v11 offset:7168
    buffer_load_dwordx4 a[120:123], v195, s[40:43], s51 offen offset:2048
    s_waitcnt lgkmcnt(3)
    v_mfma_f32_32x32x16_bf16 v[96:111], v[168:171], a[72:75], v[96:111]
    ds_read_b128 v[184:187], v11 offset:11264
    s_waitcnt lgkmcnt(3)
    v_mfma_f32_32x32x16_bf16 v[112:127], v[172:175], a[72:75], v[112:127]
    ds_read_b128 v[188:191], v11 offset:15360
    s_waitcnt lgkmcnt(3)
    v_mfma_f32_32x32x16_bf16 v[64:79], v[176:179], a[76:79], v[64:79]
    ds_read_b128 v[160:163], v11 offset:16384
    s_waitcnt lgkmcnt(3)
    v_mfma_f32_32x32x16_bf16 v[80:95], v[180:183], a[76:79], v[80:95]
    ds_read_b128 v[164:167], v11 offset:20480
    buffer_load_dwordx4 a[124:127], v195, s[40:43], s51 offen offset:3072
    s_waitcnt lgkmcnt(3)
    v_mfma_f32_32x32x16_bf16 v[96:111], v[184:187], a[76:79], v[96:111]
    ds_read_b128 v[168:171], v11 offset:24576
    s_waitcnt lgkmcnt(3)
    v_mfma_f32_32x32x16_bf16 v[112:127], v[188:191], a[76:79], v[112:127]
    ds_read_b128 v[172:175], v11 offset:28672
    s_waitcnt vmcnt(8)
    s_waitcnt lgkmcnt(3)
    v_mfma_f32_32x32x16_bf16 v[64:79], v[160:163], a[80:83], v[64:79]
    ds_read_b128 v[176:179], v11 offset:17408
    s_waitcnt lgkmcnt(3)
    v_mfma_f32_32x32x16_bf16 v[80:95], v[164:167], a[80:83], v[80:95]
    ds_read_b128 v[180:183], v11 offset:21504
    s_waitcnt lgkmcnt(3)
    v_mfma_f32_32x32x16_bf16 v[96:111], v[168:171], a[80:83], v[96:111]
    ds_read_b128 v[184:187], v11 offset:25600
    s_waitcnt lgkmcnt(3)
    v_mfma_f32_32x32x16_bf16 v[112:127], v[172:175], a[80:83], v[112:127]
    ds_read_b128 v[188:191], v11 offset:29696
    s_waitcnt lgkmcnt(3)
    v_mfma_f32_32x32x16_bf16 v[64:79], v[176:179], a[84:87], v[64:79]
    ds_read_b128 v[160:163], v11 offset:18432
    s_waitcnt lgkmcnt(3)
    v_mfma_f32_32x32x16_bf16 v[80:95], v[180:183], a[84:87], v[80:95]
    ds_read_b128 v[164:167], v11 offset:22528
    s_waitcnt lgkmcnt(3)
    v_mfma_f32_32x32x16_bf16 v[96:111], v[184:187], a[84:87], v[96:111]
    ds_read_b128 v[168:171], v11 offset:26624
    s_waitcnt lgkmcnt(3)
    v_mfma_f32_32x32x16_bf16 v[112:127], v[188:191], a[84:87], v[112:127]
    ds_read_b128 v[172:175], v11 offset:30720
    s_waitcnt lgkmcnt(3)
    v_mfma_f32_32x32x16_bf16 v[64:79], v[160:163], a[88:91], v[64:79]
    ds_read_b128 v[176:179], v11 offset:19456
    s_waitcnt lgkmcnt(3)
    v_mfma_f32_32x32x16_bf16 v[80:95], v[164:167], a[88:91], v[80:95]
    ds_read_b128 v[180:183], v11 offset:23552
    s_waitcnt lgkmcnt(3)
    v_mfma_f32_32x32x16_bf16 v[96:111], v[168:171], a[88:91], v[96:111]
    ds_read_b128 v[184:187], v11 offset:27648
    s_add_u32 s48, s100, s19
    s_add_u32 s49, s101, s19
    buffer_load_dwordx4 v[224:227], v3, s[40:43], s48 offen offset:0
    buffer_load_dwordx4 v[228:231], v3, s[40:43], s49 offen offset:0
    s_waitcnt lgkmcnt(3)
    v_mfma_f32_32x32x16_bf16 v[112:127], v[172:175], a[88:91], v[112:127]
    ds_read_b128 v[188:191], v11 offset:31744
    buffer_load_dwordx4 v[232:235], v3, s[40:43], s48 offen offset:1024
    s_waitcnt lgkmcnt(3)
    v_mfma_f32_32x32x16_bf16 v[64:79], v[176:179], a[92:95], v[64:79]
    ds_read_b128 v[160:163], v11 offset:32768
    buffer_load_dwordx4 v[236:239], v3, s[40:43], s49 offen offset:1024
    s_waitcnt lgkmcnt(3)
    v_mfma_f32_32x32x16_bf16 v[80:95], v[180:183], a[92:95], v[80:95]
    ds_read_b128 v[164:167], v11 offset:36864
    buffer_load_dwordx4 v[240:243], v3, s[40:43], s48 offen offset:2048
    s_waitcnt lgkmcnt(3)
    v_mfma_f32_32x32x16_bf16 v[96:111], v[184:187], a[92:95], v[96:111]
    ds_read_b128 v[168:171], v11 offset:40960
    buffer_load_dwordx4 v[244:247], v3, s[40:43], s49 offen offset:2048
    s_waitcnt lgkmcnt(3)
    v_mfma_f32_32x32x16_bf16 v[112:127], v[188:191], a[92:95], v[112:127]
    ds_read_b128 v[172:175], v11 offset:45056
    buffer_load_dwordx4 v[248:251], v3, s[40:43], s48 offen offset:3072
    s_waitcnt vmcnt(11)
    s_waitcnt lgkmcnt(3)
    v_mfma_f32_32x32x16_bf16 v[64:79], v[160:163], a[96:99], v[64:79]
    ds_read_b128 v[176:179], v11 offset:33792
    buffer_load_dwordx4 v[252:255], v3, s[40:43], s49 offen offset:3072
    s_waitcnt lgkmcnt(3)
    v_mfma_f32_32x32x16_bf16 v[80:95], v[164:167], a[96:99], v[80:95]
    ds_read_b128 v[180:183], v11 offset:37888
    s_add_u32 s48, s100, s16
    s_add_u32 s49, s101, s16
    buffer_load_dwordx4 a[128:131], v3, s[40:43], s48 offen offset:0
    s_waitcnt lgkmcnt(3)
    v_mfma_f32_32x32x16_bf16 v[96:111], v[168:171], a[96:99], v[96:111]
    ds_read_b128 v[184:187], v11 offset:41984
    buffer_load_dwordx4 a[132:135], v3, s[40:43], s49 offen offset:0
    s_waitcnt lgkmcnt(3)
    v_mfma_f32_32x32x16_bf16 v[112:127], v[172:175], a[96:99], v[112:127]
    ds_read_b128 v[188:191], v11 offset:46080
    buffer_load_dwordx4 a[136:139], v3, s[40:43], s48 offen offset:1024
    s_waitcnt lgkmcnt(3)
    v_mfma_f32_32x32x16_bf16 v[64:79], v[176:179], a[100:103], v[64:79]
    ds_read_b128 v[160:163], v11 offset:34816
    buffer_load_dwordx4 a[140:143], v3, s[40:43], s49 offen offset:1024
    s_waitcnt lgkmcnt(3)
    v_mfma_f32_32x32x16_bf16 v[80:95], v[180:183], a[100:103], v[80:95]
    ds_read_b128 v[164:167], v11 offset:38912
    buffer_load_dwordx4 a[144:147], v3, s[40:43], s48 offen offset:2048
    s_waitcnt lgkmcnt(3)
    v_mfma_f32_32x32x16_bf16 v[96:111], v[184:187], a[100:103], v[96:111]
    ds_read_b128 v[168:171], v11 offset:43008
    buffer_load_dwordx4 a[148:151], v3, s[40:43], s49 offen offset:2048
    s_waitcnt lgkmcnt(3)
    v_mfma_f32_32x32x16_bf16 v[112:127], v[188:191], a[100:103], v[112:127]
    ds_read_b128 v[172:175], v11 offset:47104
    buffer_load_dwordx4 a[152:155], v3, s[40:43], s48 offen offset:3072
    s_waitcnt lgkmcnt(3)
    v_mfma_f32_32x32x16_bf16 v[64:79], v[160:163], a[104:107], v[64:79]
    ds_read_b128 v[176:179], v11 offset:35840
    buffer_load_dwordx4 a[156:159], v3, s[40:43], s49 offen offset:3072
    s_waitcnt lgkmcnt(3)
    v_mfma_f32_32x32x16_bf16 v[80:95], v[164:167], a[104:107], v[80:95]
    ds_read_b128 v[180:183], v11 offset:39936
    s_add_u32 s48, s48, 4096
    s_add_u32 s49, s49, 4096
    buffer_load_dwordx4 a[160:163], v3, s[40:43], s48 offen offset:0
    s_waitcnt lgkmcnt(3)
    v_mfma_f32_32x32x16_bf16 v[96:111], v[168:171], a[104:107], v[96:111]
    ds_read_b128 v[184:187], v11 offset:44032
    buffer_load_dwordx4 a[164:167], v3, s[40:43], s49 offen offset:0
    s_waitcnt lgkmcnt(3)
    v_mfma_f32_32x32x16_bf16 v[112:127], v[172:175], a[104:107], v[112:127]
    ds_read_b128 v[188:191], v11 offset:48128
    buffer_load_dwordx4 a[168:171], v3, s[40:43], s48 offen offset:1024
    s_waitcnt lgkmcnt(3)
    v_mfma_f32_32x32x16_bf16 v[64:79], v[176:179], a[108:111], v[64:79]
    ds_read_b128 v[160:163], v11 offset:49152
    buffer_load_dwordx4 a[172:175], v3, s[40:43], s49 offen offset:1024
    s_waitcnt lgkmcnt(3)
    v_mfma_f32_32x32x16_bf16 v[80:95], v[180:183], a[108:111], v[80:95]
    ds_read_b128 v[164:167], v11 offset:53248
    s_add_u32 s48, s100, s17
    s_add_u32 s49, s101, s17
    buffer_load_dwordx4 a[176:179], v3, s[40:43], s48 offen offset:0
    s_waitcnt lgkmcnt(3)
    v_mfma_f32_32x32x16_bf16 v[96:111], v[184:187], a[108:111], v[96:111]
    ds_read_b128 v[168:171], v11 offset:57344
    buffer_load_dwordx4 a[180:183], v3, s[40:43], s49 offen offset:0
    s_waitcnt lgkmcnt(3)
    v_mfma_f32_32x32x16_bf16 v[112:127], v[188:191], a[108:111], v[112:127]
    ds_read_b128 v[172:175], v11 offset:61440
    buffer_load_dwordx4 a[184:187], v3, s[40:43], s48 offen offset:1024
    s_waitcnt vmcnt(23)
    s_waitcnt lgkmcnt(3)
    v_mfma_f32_32x32x16_bf16 v[64:79], v[160:163], a[112:115], v[64:79]
    ds_read_b128 v[176:179], v11 offset:50176
    buffer_load_dwordx4 a[188:191], v3, s[40:43], s49 offen offset:1024
    s_waitcnt lgkmcnt(3)
    v_mfma_f32_32x32x16_bf16 v[80:95], v[164:167], a[112:115], v[80:95]
    ds_read_b128 v[180:183], v11 offset:54272
    buffer_load_dwordx4 a[192:195], v3, s[40:43], s48 offen offset:2048
    s_waitcnt lgkmcnt(3)
    v_mfma_f32_32x32x16_bf16 v[96:111], v[168:171], a[112:115], v[96:111]
    ds_read_b128 v[184:187], v11 offset:58368
    buffer_load_dwordx4 a[196:199], v3, s[40:43], s49 offen offset:2048
    s_waitcnt lgkmcnt(3)
    v_mfma_f32_32x32x16_bf16 v[112:127], v[172:175], a[112:115], v[112:127]
    ds_read_b128 v[188:191], v11 offset:62464
    buffer_load_dwordx4 a[200:203], v3, s[40:43], s48 offen offset:3072
    s_waitcnt lgkmcnt(3)
    v_mfma_f32_32x32x16_bf16 v[64:79], v[176:179], a[116:119], v[64:79]
    ds_read_b128 v[160:163], v11 offset:51200
    buffer_load_dwordx4 a[204:207], v3, s[40:43], s49 offen offset:3072
    s_waitcnt lgkmcnt(3)
    v_mfma_f32_32x32x16_bf16 v[80:95], v[180:183], a[116:119], v[80:95]
    ds_read_b128 v[164:167], v11 offset:55296
    s_add_u32 s48, s48, 4096
    s_add_u32 s49, s49, 4096
    buffer_load_dwordx4 a[208:211], v3, s[40:43], s48 offen offset:0
    s_waitcnt lgkmcnt(3)
    v_mfma_f32_32x32x16_bf16 v[96:111], v[184:187], a[116:119], v[96:111]
    ds_read_b128 v[168:171], v11 offset:59392
    buffer_load_dwordx4 a[212:215], v3, s[40:43], s49 offen offset:0
    s_waitcnt lgkmcnt(3)
    v_mfma_f32_32x32x16_bf16 v[112:127], v[188:191], a[116:119], v[112:127]
    ds_read_b128 v[172:175], v11 offset:63488
    buffer_load_dwordx4 a[216:219], v3, s[40:43], s48 offen offset:1024
    s_waitcnt lgkmcnt(3)
    v_mfma_f32_32x32x16_bf16 v[64:79], v[160:163], a[120:123], v[64:79]
    ds_read_b128 v[176:179], v11 offset:52224
    buffer_load_dwordx4 a[220:223], v3, s[40:43], s49 offen offset:1024
    s_waitcnt lgkmcnt(3)
    v_mfma_f32_32x32x16_bf16 v[80:95], v[164:167], a[120:123], v[80:95]
    ds_read_b128 v[180:183], v11 offset:56320
    s_add_u32 s48, s100, s18
    s_add_u32 s49, s101, s18
    buffer_load_dwordx4 a[224:227], v3, s[40:43], s48 offen offset:0
    s_waitcnt lgkmcnt(3)
    v_mfma_f32_32x32x16_bf16 v[96:111], v[168:171], a[120:123], v[96:111]
    ds_read_b128 v[184:187], v11 offset:60416
    buffer_load_dwordx4 a[228:231], v3, s[40:43], s49 offen offset:0
    s_waitcnt lgkmcnt(3)
    v_mfma_f32_32x32x16_bf16 v[112:127], v[172:175], a[120:123], v[112:127]
    ds_read_b128 v[188:191], v11 offset:64512
    buffer_load_dwordx4 a[232:235], v3, s[40:43], s48 offen offset:1024
    s_waitcnt lgkmcnt(3)
    v_mfma_f32_32x32x16_bf16 v[64:79], v[176:179], a[124:127], v[64:79]
    buffer_load_dwordx4 a[236:239], v3, s[40:43], s49 offen offset:1024
    s_waitcnt lgkmcnt(2)
    v_mfma_f32_32x32x16_bf16 v[80:95], v[180:183], a[124:127], v[80:95]
    buffer_load_dwordx4 a[240:243], v3, s[40:43], s48 offen offset:2048
    s_waitcnt lgkmcnt(1)
    v_mfma_f32_32x32x16_bf16 v[96:111], v[184:187], a[124:127], v[96:111]
    buffer_load_dwordx4 a[244:247], v3, s[40:43], s49 offen offset:2048
    s_waitcnt lgkmcnt(0)
    v_mfma_f32_32x32x16_bf16 v[112:127], v[188:191], a[124:127], v[112:127]
    buffer_load_dwordx4 a[248:251], v3, s[40:43], s48 offen offset:3072
    buffer_load_dwordx4 a[252:255], v3, s[40:43], s49 offen offset:3072
    s_add_u32 s48, s48, 4096
    s_add_u32 s49, s49, 4096
    buffer_load_dwordx4 v[208:211], v3, s[40:43], s48 offen offset:0
    buffer_load_dwordx4 v[212:215], v3, s[40:43], s49 offen offset:0
    buffer_load_dwordx4 v[216:219], v3, s[40:43], s48 offen offset:1024
    buffer_load_dwordx4 v[220:223], v3, s[40:43], s49 offen offset:1024
    v_pk_mul_f32 v[64:65], v[64:65], v[60:61]
    v_exp_f32 v64, v64
    v_exp_f32 v65, v65
    v_pk_mul_f32 v[66:67], v[66:67], v[60:61]
    v_exp_f32 v66, v66
    v_exp_f32 v67, v67
    v_pk_mul_f32 v[68:69], v[68:69], v[60:61]
    v_exp_f32 v68, v68
    v_exp_f32 v69, v69
    v_pk_mul_f32 v[70:71], v[70:71], v[60:61]
    v_exp_f32 v70, v70
    v_exp_f32 v71, v71
    v_pk_mul_f32 v[72:73], v[72:73], v[60:61]
    v_exp_f32 v72, v72
    v_exp_f32 v73, v73
    v_pk_mul_f32 v[74:75], v[74:75], v[60:61]
    v_exp_f32 v74, v74
    v_exp_f32 v75, v75
    v_pk_mul_f32 v[76:77], v[76:77], v[60:61]
    v_exp_f32 v76, v76
    v_exp_f32 v77, v77
    v_pk_mul_f32 v[78:79], v[78:79], v[60:61]
    v_exp_f32 v78, v78
    v_exp_f32 v79, v79
    v_pk_fma_f32 v[64:65], v[64:65], v[62:63], v[62:63]
    v_rcp_f32 v64, v64
    v_rcp_f32 v65, v65
    v_pk_fma_f32 v[66:67], v[66:67], v[62:63], v[62:63]
    v_rcp_f32 v66, v66
    v_rcp_f32 v67, v67
    v_pk_fma_f32 v[68:69], v[68:69], v[62:63], v[62:63]
    v_rcp_f32 v68, v68
    v_rcp_f32 v69, v69
    v_pk_fma_f32 v[70:71], v[70:71], v[62:63], v[62:63]
    v_rcp_f32 v70, v70
    v_rcp_f32 v71, v71
    v_pk_fma_f32 v[72:73], v[72:73], v[62:63], v[62:63]
    v_rcp_f32 v72, v72
    v_rcp_f32 v73, v73
    v_pk_fma_f32 v[74:75], v[74:75], v[62:63], v[62:63]
    v_rcp_f32 v74, v74
    v_rcp_f32 v75, v75
    v_pk_fma_f32 v[76:77], v[76:77], v[62:63], v[62:63]
    v_rcp_f32 v76, v76
    v_rcp_f32 v77, v77
    v_pk_fma_f32 v[78:79], v[78:79], v[62:63], v[62:63]
    v_rcp_f32 v78, v78
    v_rcp_f32 v79, v79
    v_pk_mul_f32 v[80:81], v[80:81], v[64:65]
    v_pk_mul_f32 v[82:83], v[82:83], v[66:67]
    v_pk_mul_f32 v[84:85], v[84:85], v[68:69]
    v_pk_mul_f32 v[86:87], v[86:87], v[70:71]
    v_pk_mul_f32 v[88:89], v[88:89], v[72:73]
    v_pk_mul_f32 v[90:91], v[90:91], v[74:75]
    v_pk_mul_f32 v[92:93], v[92:93], v[76:77]
    v_pk_mul_f32 v[94:95], v[94:95], v[78:79]
    v_cvt_pk_bf16_f32 v192, v80, v81
    v_cvt_pk_bf16_f32 v193, v82, v83
    v_cvt_pk_bf16_f32 v194, v84, v85
    v_cvt_pk_bf16_f32 v195, v86, v87
    v_cvt_pk_bf16_f32 v196, v88, v89
    v_cvt_pk_bf16_f32 v197, v90, v91
    v_cvt_pk_bf16_f32 v198, v92, v93
    v_cvt_pk_bf16_f32 v199, v94, v95
    buffer_store_dwordx4 v[192:195], v3, s[40:43], s52 offen sc1
    buffer_store_dwordx4 v[196:199], v3, s[40:43], s52 offen offset:1024 sc1
    v_pk_mul_f32 v[96:97], v[96:97], v[60:61]
    v_exp_f32 v96, v96
    v_exp_f32 v97, v97
    v_pk_mul_f32 v[98:99], v[98:99], v[60:61]
    v_exp_f32 v98, v98
    v_exp_f32 v99, v99
    v_pk_mul_f32 v[100:101], v[100:101], v[60:61]
    v_exp_f32 v100, v100
    v_exp_f32 v101, v101
    v_pk_mul_f32 v[102:103], v[102:103], v[60:61]
    v_exp_f32 v102, v102
    v_exp_f32 v103, v103
    v_pk_mul_f32 v[104:105], v[104:105], v[60:61]
    v_exp_f32 v104, v104
    v_exp_f32 v105, v105
    v_pk_mul_f32 v[106:107], v[106:107], v[60:61]
    v_exp_f32 v106, v106
    v_exp_f32 v107, v107
    v_pk_mul_f32 v[108:109], v[108:109], v[60:61]
    v_exp_f32 v108, v108
    v_exp_f32 v109, v109
    v_pk_mul_f32 v[110:111], v[110:111], v[60:61]
    v_exp_f32 v110, v110
    v_exp_f32 v111, v111
    v_pk_fma_f32 v[96:97], v[96:97], v[62:63], v[62:63]
    v_rcp_f32 v96, v96
    v_rcp_f32 v97, v97
    v_pk_fma_f32 v[98:99], v[98:99], v[62:63], v[62:63]
    v_rcp_f32 v98, v98
    v_rcp_f32 v99, v99
    v_pk_fma_f32 v[100:101], v[100:101], v[62:63], v[62:63]
    v_rcp_f32 v100, v100
    v_rcp_f32 v101, v101
    v_pk_fma_f32 v[102:103], v[102:103], v[62:63], v[62:63]
    v_rcp_f32 v102, v102
    v_rcp_f32 v103, v103
    v_pk_fma_f32 v[104:105], v[104:105], v[62:63], v[62:63]
    v_rcp_f32 v104, v104
    v_rcp_f32 v105, v105
    v_pk_fma_f32 v[106:107], v[106:107], v[62:63], v[62:63]
    v_rcp_f32 v106, v106
    v_rcp_f32 v107, v107
    v_pk_fma_f32 v[108:109], v[108:109], v[62:63], v[62:63]
    v_rcp_f32 v108, v108
    v_rcp_f32 v109, v109
    v_pk_fma_f32 v[110:111], v[110:111], v[62:63], v[62:63]
    v_rcp_f32 v110, v110
    v_rcp_f32 v111, v111
    v_pk_mul_f32 v[112:113], v[112:113], v[96:97]
    v_pk_mul_f32 v[114:115], v[114:115], v[98:99]
    v_pk_mul_f32 v[116:117], v[116:117], v[100:101]
    v_pk_mul_f32 v[118:119], v[118:119], v[102:103]
    v_pk_mul_f32 v[120:121], v[120:121], v[104:105]
    v_pk_mul_f32 v[122:123], v[122:123], v[106:107]
    v_pk_mul_f32 v[124:125], v[124:125], v[108:109]
    v_pk_mul_f32 v[126:127], v[126:127], v[110:111]
    v_cvt_pk_bf16_f32 v200, v112, v113
    v_cvt_pk_bf16_f32 v201, v114, v115
    v_cvt_pk_bf16_f32 v202, v116, v117
    v_cvt_pk_bf16_f32 v203, v118, v119
    v_cvt_pk_bf16_f32 v204, v120, v121
    v_cvt_pk_bf16_f32 v205, v122, v123
    v_cvt_pk_bf16_f32 v206, v124, v125
    v_cvt_pk_bf16_f32 v207, v126, v127
    buffer_store_dwordx4 v[200:203], v3, s[40:43], s53 offen sc1
    buffer_store_dwordx4 v[204:207], v3, s[40:43], s53 offen offset:1024 sc1
    s_lshl_b32 s13, s9, 11
    s_lshl_b32 s63, s8, 2
    s_add_u32 s13, s13, s63
    s_add_u32 s13, s13, 0x88000
    v_mov_b32 v5, 0
    buffer_load_dword v5, v1, s[40:43], s28 offen sc1
    s_waitcnt vmcnt(1)
    v_mov_b32 v13, 1
    v_mov_b32 v14, 155680
    s_mov_b64 exec, 1
    ds_add_rtn_u32 v15, v14, v13
    s_mov_b64 exec, 0xffff
    v_lshlrev_b32 v14, 7, v2
    s_waitcnt lgkmcnt(0)
    v_readfirstlane_b32 s63, v15
    s_nop 0
    s_and_b32 s63, s63, 3
    s_cmp_lg_u32 s63, 3
    s_cbranch_scc1 k345_b2_f4
    buffer_store_dword v13, v14, s[40:43], s13 offen sc1
k345_b2_f4:
    s_mov_b64 exec, -1
    s_branch k345_p4done
k345_help3:
    s_waitcnt vmcnt(0) lgkmcnt(0)
    s_barrier
    s_mov_b32 s60, 0
    s_lshl_b32 s4, s9, 1
    s_mov_b32 s5, 0
    s_branch k345_p3
k345_help4:
    s_mov_b32 s61, 0
    s_lshr_b32 s9, s4, 1
    s_mov_b32 s8, 0
k345_p4again:
    s_waitcnt vmcnt(0) lgkmcnt(0)
    s_barrier
    s_min_u32 s98, s8, 11
    s_lshl_b32 s63, s8, 1
    s_add_u32 s98, s98, s63
    s_lshl_b32 s63, s98, 16
    s_add_u32 s63, s63, 0x500000
    s_add_u32 s96, s63, s10
    s_add_u32 s97, s63, s11
    s_lshl_b32 s99, s9, 2
    s_add_u32 s99, s99, s3
    s_add_u32 s63, s8, s9
    s_mov_b32 s62, 0
    s_lshl_b32 s62, s62, 13
    v_add_u32 v192, s62, v3
    s_mov_b32 s62, 1
    s_lshl_b32 s62, s62, 13
    v_add_u32 v193, s62, v3
    s_mov_b32 s62, 2
    s_lshl_b32 s62, s62, 13
    v_add_u32 v194, s62, v3
    s_mov_b32 s62, 3
    s_lshl_b32 s62, s62, 13
    v_add_u32 v195, s62, v3
    s_lshl_b32 s12, s98, 1
    s_add_u32 s12, s12, s3
    s_lshl_b32 s12, s12, 12
    s_add_u32 s12, s12, 0x300000
    buffer_load_dwordx4 v[196:199], v3, s[40:43], s12 offen offset:0
    buffer_load_dwordx4 v[200:203], v3, s[40:43], s12 offen offset:1024
    buffer_load_dwordx4 v[204:207], v3, s[40:43], s12 offen offset:2048
    buffer_load_dwordx4 v[208:211], v3, s[40:43], s12 offen offset:3072
    s_add_u32 s12, s12, 16384
    buffer_load_dwordx4 v[212:215], v3, s[40:43], s12 offen offset:0
    buffer_load_dwordx4 v[216:219], v3, s[40:43], s12 offen offset:1024
    buffer_load_dwordx4 v[220:223], v3, s[40:43], s12 offen offset:2048
    buffer_load_dwordx4 v[224:227], v3, s[40:43], s12 offen offset:3072
    s_add_u32 m0, s10, 0
    s_add_u32 s63, s96, 0
    buffer_load_dwordx4 v192, s[40:43], s63 offen lds
    s_add_u32 m0, s10, 4096
    s_add_u32 s63, s96, 32768
    buffer_load_dwordx4 v192, s[40:43], s63 offen lds
    s_add_u32 m0, s10, 8192
    s_add_u32 s63, s96, 65536
    buffer_load_dwordx4 v192, s[40:43], s63 offen lds
    s_add_u32 m0, s10, 12288
    s_add_u32 s63, s96, 98304
    buffer_load_dwordx4 v192, s[40:43], s63 offen lds
    s_add_u32 m0, s10, 16384
    s_add_u32 s63, s96, 4096
    buffer_load_dwordx4 v192, s[40:43], s63 offen lds
    s_add_u32 m0, s10, 20480
    s_add_u32 s63, s96, 36864
    buffer_load_dwordx4 v192, s[40:43], s63 offen lds
    s_add_u32 m0, s10, 24576
    s_add_u32 s63, s96, 69632
    buffer_load_dwordx4 v192, s[40:43], s63 offen lds
    s_add_u32 m0, s10, 28672
    s_add_u32 s63, s96, 102400
    buffer_load_dwordx4 v192, s[40:43], s63 offen lds
    s_add_u32 m0, s10, 32768
    s_add_u32 s63, s96, 0
    buffer_load_dwordx4 v193, s[40:43], s63 offen lds
    s_add_u32 m0, s10, 36864
    s_add_u32 s63, s96, 32768
    buffer_load_dwordx4 v193, s[40:43], s63 offen lds
    s_add_u32 m0, s10, 40960
    s_add_u32 s63, s96, 65536
    buffer_load_dwordx4 v193, s[40:43], s63 offen lds
    s_add_u32 m0, s10, 45056
    s_add_u32 s63, s96, 98304
    buffer_load_dwordx4 v193, s[40:43], s63 offen lds
    s_add_u32 m0, s10, 49152
    s_add_u32 s63, s96, 4096
    buffer_load_dwordx4 v193, s[40:43], s63 offen lds
    s_add_u32 m0, s10, 53248
    s_add_u32 s63, s96, 36864
    buffer_load_dwordx4 v193, s[40:43], s63 offen lds
    s_add_u32 m0, s10, 57344
    s_add_u32 s63, s96, 69632
    buffer_load_dwordx4 v193, s[40:43], s63 offen lds
    s_add_u32 m0, s10, 61440
    s_add_u32 s63, s96, 102400
    buffer_load_dwordx4 v193, s[40:43], s63 offen lds
    s_add_u32 m0, s10, 65536
    s_add_u32 s63, s96, 0
    buffer_load_dwordx4 v194, s[40:43], s63 offen lds
    s_add_u32 m0, s10, 69632
    s_add_u32 s63, s96, 32768
    buffer_load_dwordx4 v194, s[40:43], s63 offen lds
    s_add_u32 m0, s10, 73728
    s_add_u32 s63, s96, 65536
    buffer_load_dwordx4 v194, s[40:43], s63 offen lds
    s_add_u32 m0, s10, 77824
    s_add_u32 s63, s96, 98304
    buffer_load_dwordx4 v194, s[40:43], s63 offen lds
    s_add_u32 m0, s10, 81920
    s_add_u32 s63, s96, 4096
    buffer_load_dwordx4 v194, s[40:43], s63 offen lds
    s_add_u32 m0, s10, 86016
    s_add_u32 s63, s96, 36864
    buffer_load_dwordx4 v194, s[40:43], s63 offen lds
    s_add_u32 m0, s10, 90112
    s_add_u32 s63, s96, 69632
    buffer_load_dwordx4 v194, s[40:43], s63 offen lds
    s_add_u32 m0, s10, 94208
    s_add_u32 s63, s96, 102400
    buffer_load_dwordx4 v194, s[40:43], s63 offen lds
    s_waitcnt vmcnt(0)
    s_branch k345_p4
k345_p4done:
    s_cmp_lt_i32 s61, 0
    s_cbranch_scc1 k345_p5
    s_add_u32 s61, s61, 1
    s_mov_b32 s8, s61
    s_cmp_lt_u32 s61, 16
    s_cbranch_scc1 k345_p4again
    s_mov_b32 s61, -1
k345_p5:
    s_and_b32 s4, s2, 7
    s_lshl_b32 s4, s4, 2
    s_bfe_u32 s5, s2, 0x20003
    s_add_u32 s4, s4, s5
    s_lshr_b32 s5, s2, 5
    s_lshl_b32 s12, s4, 1
    s_add_u32 s12, s12, s6
    s_xor_b32 s13, s12, 1
    s_lshl_b32 s14, s5, 1
    s_add_u32 s14, s14, s7
    s_mul_i32 s50, s12, 86
    s_lshl_b32 s50, s50, 10
    s_add_u32 s50, s50, 0x1600000
    s_mul_i32 s51, s13, 86
    s_lshl_b32 s51, s51, 10
    s_add_u32 s51, s51, 0x1600000
    buffer_load_dword v5, v1, s[40:43], s28 offen sc1
    s_lshl_b32 s52, s12, 15
    s_lshl_b32 s53, s14, 11
    s_add_u32 s53, s53, s52
    s_add_u32 s53, s53, 0x1200000
    s_lshl_b32 s54, s14, 6
    s_add_u32 s52, s52, s54
    s_lshl_b32 s54, s14, 7
    s_add_u32 s54, s54, 10240
    buffer_load_dwordx4 v[16:19], v3, s[40:43], s53 offen
    buffer_load_dwordx4 v[20:23], v3, s[40:43], s53 offen offset:1024
    v_mov_b32 v64, 0
    v_mov_b32 v65, 0
    v_mov_b32 v66, 0
    v_mov_b32 v67, 0
    v_mov_b32 v68, 0
    v_mov_b32 v69, 0
    v_mov_b32 v70, 0
    v_mov_b32 v71, 0
    v_mov_b32 v72, 0
    v_mov_b32 v73, 0
    v_mov_b32 v74, 0
    v_mov_b32 v75, 0
    v_mov_b32 v76, 0
    v_mov_b32 v77, 0
    v_mov_b32 v78, 0
    v_mov_b32 v79, 0
    v_mov_b32 v80, 0
    v_mov_b32 v81, 0
    v_mov_b32 v82, 0
    v_mov_b32 v83, 0
    v_mov_b32 v84, 0
    v_mov_b32 v85, 0
    v_mov_b32 v86, 0
    v_mov_b32 v87, 0
    v_mov_b32 v88, 0
    v_mov_b32 v89, 0
    v_mov_b32 v90, 0
    v_mov_b32 v91, 0
    v_mov_b32 v92, 0
    v_mov_b32 v93, 0
    v_mov_b32 v94, 0
    v_mov_b32 v95, 0
    v_mov_b32 v96, 0
    v_mov_b32 v97, 0
    v_mov_b32 v98, 0
    v_mov_b32 v99, 0
    v_mov_b32 v100, 0
    v_mov_b32 v101, 0
    v_mov_b32 v102, 0
    v_mov_b32 v103, 0
    v_mov_b32 v104, 0
    v_mov_b32 v105, 0
    v_mov_b32 v106, 0
    v_mov_b32 v107, 0
    v_mov_b32 v108, 0
    v_mov_b32 v109, 0
    v_mov_b32 v110, 0
    v_mov_b32 v111, 0
    v_mov_b32 v112, 0
    v_mov_b32 v113, 0
    v_mov_b32 v114, 0
    v_mov_b32 v115, 0
    v_mov_b32 v116, 0
    v_mov_b32 v117, 0
    v_mov_b32 v118, 0
    v_mov_b32 v119, 0
    v_mov_b32 v120, 0
    v_mov_b32 v121, 0
    v_mov_b32 v122, 0
    v_mov_b32 v123, 0
    v_mov_b32 v124, 0
    v_mov_b32 v125, 0
    v_mov_b32 v126, 0
    v_mov_b32 v127, 0
    s_mov_b32 s24, 0
    s_mov_b32 s25, -1
    s_mov_b32 s27, 0
    s_mov_b32 s62, 0
    s_branch k345_5top
k345_5ld0:
    s_add_u32 s48, s50, s16
    s_add_u32 s49, s51, s16
    s_bitset1_b32 s24, 0
    s_mov_b32 s29, s25
    s_mov_b32 s25, 0
    s_cmp_eq_u32 s29, 1
    s_cbranch_scc1 k345_5p1_0
    s_cmp_eq_u32 s29, 2
    s_cbranch_scc1 k345_5p2_0
    s_cmp_eq_u32 s29, 3
    s_cbranch_scc1 k345_5p3_0
    buffer_load_dwordx4 a[0:3], v3, s[40:43], s48 offen offset:0
    buffer_load_dwordx4 a[4:7], v3, s[40:43], s49 offen offset:0
    buffer_load_dwordx4 a[8:11], v3, s[40:43], s48 offen offset:1024
    buffer_load_dwordx4 a[12:15], v3, s[40:43], s49 offen offset:1024
    buffer_load_dwordx4 a[16:19], v3, s[40:43], s48 offen offset:2048
    buffer_load_dwordx4 a[20:23], v3, s[40:43], s49 offen offset:2048
    buffer_load_dwordx4 a[24:27], v3, s[40:43], s48 offen offset:3072
    buffer_load_dwordx4 a[28:31], v3, s[40:43], s49 offen offset:3072
    s_add_u32 s48, s48, 4096
    s_add_u32 s49, s49, 4096
    buffer_load_dwordx4 a[32:35], v3, s[40:43], s48 offen offset:0
    buffer_load_dwordx4 a[36:39], v3, s[40:43], s49 offen offset:0
    buffer_load_dwordx4 a[40:43], v3, s[40:43], s48 offen offset:1024
    buffer_load_dwordx4 a[44:47], v3, s[40:43], s49 offen offset:1024
    s_branch k345_5top
k345_5p1_0:
    s_waitcnt vmcnt(10)
    v_mfma_f32_32x32x16_bf16 v[64:79], a[176:179], a[48:51], v[64:79]
    buffer_load_dwordx4 a[0:3], v3, s[40:43], s48 offen offset:0
    v_mfma_f32_32x32x16_bf16 v[80:95], a[180:183], a[48:51], v[80:95]
    buffer_load_dwordx4 a[4:7], v3, s[40:43], s49 offen offset:0
    v_mfma_f32_32x32x16_bf16 v[96:111], a[176:179], a[52:55], v[96:111]
    buffer_load_dwordx4 a[8:11], v3, s[40:43], s48 offen offset:1024
    v_mfma_f32_32x32x16_bf16 v[112:127], a[180:183], a[52:55], v[112:127]
    buffer_load_dword v5, v1, s[40:43], s28 offen sc1
    s_waitcnt vmcnt(12)
    v_mfma_f32_32x32x16_bf16 v[64:79], a[184:187], a[56:59], v[64:79]
    buffer_load_dwordx4 a[12:15], v3, s[40:43], s49 offen offset:1024
    v_mfma_f32_32x32x16_bf16 v[80:95], a[188:191], a[56:59], v[80:95]
    buffer_load_dwordx4 a[16:19], v3, s[40:43], s48 offen offset:2048
    v_mfma_f32_32x32x16_bf16 v[96:111], a[184:187], a[60:63], v[96:111]
    buffer_load_dwordx4 a[20:23], v3, s[40:43], s49 offen offset:2048
    v_mfma_f32_32x32x16_bf16 v[112:127], a[188:191], a[60:63], v[112:127]
    s_waitcnt vmcnt(13)
    v_mfma_f32_32x32x16_bf16 v[64:79], a[192:195], a[64:67], v[64:79]
    buffer_load_dwordx4 a[24:27], v3, s[40:43], s48 offen offset:3072
    v_mfma_f32_32x32x16_bf16 v[80:95], a[196:199], a[64:67], v[80:95]
    buffer_load_dwordx4 a[28:31], v3, s[40:43], s49 offen offset:3072
    v_mfma_f32_32x32x16_bf16 v[96:111], a[192:195], a[68:71], v[96:111]
    s_add_u32 s48, s48, 4096
    s_add_u32 s49, s49, 4096
    buffer_load_dwordx4 a[32:35], v3, s[40:43], s48 offen offset:0
    v_mfma_f32_32x32x16_bf16 v[112:127], a[196:199], a[68:71], v[112:127]
    s_waitcnt vmcnt(14)
    v_mfma_f32_32x32x16_bf16 v[64:79], a[200:203], a[72:75], v[64:79]
    buffer_load_dwordx4 a[36:39], v3, s[40:43], s49 offen offset:0
    v_mfma_f32_32x32x16_bf16 v[80:95], a[204:207], a[72:75], v[80:95]
    buffer_load_dwordx4 a[40:43], v3, s[40:43], s48 offen offset:1024
    v_mfma_f32_32x32x16_bf16 v[96:111], a[200:203], a[76:79], v[96:111]
    buffer_load_dwordx4 a[44:47], v3, s[40:43], s49 offen offset:1024
    v_mfma_f32_32x32x16_bf16 v[112:127], a[204:207], a[76:79], v[112:127]
    buffer_load_dword v5, v1, s[40:43], s28 offen sc1
    s_waitcnt vmcnt(16)
    v_mfma_f32_32x32x16_bf16 v[64:79], a[208:211], a[80:83], v[64:79]
    v_mfma_f32_32x32x16_bf16 v[80:95], a[212:215], a[80:83], v[80:95]
    v_mfma_f32_32x32x16_bf16 v[96:111], a[208:211], a[84:87], v[96:111]
    v_mfma_f32_32x32x16_bf16 v[112:127], a[212:215], a[84:87], v[112:127]
    s_waitcnt vmcnt(14)
    v_mfma_f32_32x32x16_bf16 v[64:79], a[216:219], a[88:91], v[64:79]
    v_mfma_f32_32x32x16_bf16 v[80:95], a[220:223], a[88:91], v[80:95]
    v_mfma_f32_32x32x16_bf16 v[96:111], a[216:219], a[92:95], v[96:111]
    v_mfma_f32_32x32x16_bf16 v[112:127], a[220:223], a[92:95], v[112:127]
k345_5m1_0_x:
    s_branch k345_5top
k345_5p2_0:
    s_waitcnt vmcnt(10)
    v_mfma_f32_32x32x16_bf16 v[64:79], a[224:227], a[96:99], v[64:79]
    buffer_load_dwordx4 a[0:3], v3, s[40:43], s48 offen offset:0
    v_mfma_f32_32x32x16_bf16 v[80:95], a[228:231], a[96:99], v[80:95]
    buffer_load_dwordx4 a[4:7], v3, s[40:43], s49 offen offset:0
    v_mfma_f32_32x32x16_bf16 v[96:111], a[224:227], a[100:103], v[96:111]
    buffer_load_dwordx4 a[8:11], v3, s[40:43], s48 offen offset:1024
    v_mfma_f32_32x32x16_bf16 v[112:127], a[228:231], a[100:103], v[112:127]
    buffer_load_dword v5, v1, s[40:43], s28 offen sc1
    s_waitcnt vmcnt(12)
    v_mfma_f32_32x32x16_bf16 v[64:79], a[232:235], a[104:107], v[64:79]
    buffer_load_dwordx4 a[12:15], v3, s[40:43], s49 offen offset:1024
    v_mfma_f32_32x32x16_bf16 v[80:95], a[236:239], a[104:107], v[80:95]
    buffer_load_dwordx4 a[16:19], v3, s[40:43], s48 offen offset:2048
    v_mfma_f32_32x32x16_bf16 v[96:111], a[232:235], a[108:111], v[96:111]
    buffer_load_dwordx4 a[20:23], v3, s[40:43], s49 offen offset:2048
    v_mfma_f32_32x32x16_bf16 v[112:127], a[236:239], a[108:111], v[112:127]
    s_waitcnt vmcnt(13)
    v_mfma_f32_32x32x16_bf16 v[64:79], a[240:243], a[112:115], v[64:79]
    buffer_load_dwordx4 a[24:27], v3, s[40:43], s48 offen offset:3072
    v_mfma_f32_32x32x16_bf16 v[80:95], a[244:247], a[112:115], v[80:95]
    buffer_load_dwordx4 a[28:31], v3, s[40:43], s49 offen offset:3072
    v_mfma_f32_32x32x16_bf16 v[96:111], a[240:243], a[116:119], v[96:111]
    s_add_u32 s48, s48, 4096
    s_add_u32 s49, s49, 4096
    buffer_load_dwordx4 a[32:35], v3, s[40:43], s48 offen offset:0
    v_mfma_f32_32x32x16_bf16 v[112:127], a[244:247], a[116:119], v[112:127]
    s_waitcnt vmcnt(14)
    v_mfma_f32_32x32x16_bf16 v[64:79], a[248:251], a[120:123], v[64:79]
    buffer_load_dwordx4 a[36:39], v3, s[40:43], s49 offen offset:0
    v_mfma_f32_32x32x16_bf16 v[80:95], a[252:255], a[120:123], v[80:95]
    buffer_load_dwordx4 a[40:43], v3, s[40:43], s48 offen offset:1024
    v_mfma_f32_32x32x16_bf16 v[96:111], a[248:251], a[124:127], v[96:111]
    buffer_load_dwordx4 a[44:47], v3, s[40:43], s49 offen offset:1024
    v_mfma_f32_32x32x16_bf16 v[112:127], a[252:255], a[124:127], v[112:127]
    buffer_load_dword v5, v1, s[40:43], s28 offen sc1
    s_cmp_eq_u32 s3, 3
    s_cbranch_scc1 k345_5m2_0_x
    s_waitcnt vmcnt(16)
    v_mfma_f32_32x32x16_bf16 v[64:79], v[208:211], v[160:163], v[64:79]
    v_mfma_f32_32x32x16_bf16 v[80:95], v[212:215], v[160:163], v[80:95]
    v_mfma_f32_32x32x16_bf16 v[96:111], v[208:211], v[164:167], v[96:111]
    v_mfma_f32_32x32x16_bf16 v[112:127], v[212:215], v[164:167], v[112:127]
    s_waitcnt vmcnt(14)
    v_mfma_f32_32x32x16_bf16 v[64:79], v[216:219], v[168:171], v[64:79]
    v_mfma_f32_32x32x16_bf16 v[80:95], v[220:223], v[168:171], v[80:95]
    v_mfma_f32_32x32x16_bf16 v[96:111], v[216:219], v[172:175], v[96:111]
    v_mfma_f32_32x32x16_bf16 v[112:127], v[220:223], v[172:175], v[112:127]
k345_5m2_0_x:
    s_branch k345_5top
k345_5p3_0:
    s_waitcnt vmcnt(6)
    v_mfma_f32_32x32x16_bf16 v[64:79], v[224:227], v[176:179], v[64:79]
    buffer_load_dwordx4 a[0:3], v3, s[40:43], s48 offen offset:0
    v_mfma_f32_32x32x16_bf16 v[80:95], v[228:231], v[176:179], v[80:95]
    buffer_load_dwordx4 a[4:7], v3, s[40:43], s49 offen offset:0
    v_mfma_f32_32x32x16_bf16 v[96:111], v[224:227], v[180:183], v[96:111]
    buffer_load_dwordx4 a[8:11], v3, s[40:43], s48 offen offset:1024
    v_mfma_f32_32x32x16_bf16 v[112:127], v[228:231], v[180:183], v[112:127]
    buffer_load_dword v5, v1, s[40:43], s28 offen sc1
    s_waitcnt vmcnt(8)
    v_mfma_f32_32x32x16_bf16 v[64:79], v[232:235], v[184:187], v[64:79]
    buffer_load_dwordx4 a[12:15], v3, s[40:43], s49 offen offset:1024
    v_mfma_f32_32x32x16_bf16 v[80:95], v[236:239], v[184:187], v[80:95]
    buffer_load_dwordx4 a[16:19], v3, s[40:43], s48 offen offset:2048
    v_mfma_f32_32x32x16_bf16 v[96:111], v[232:235], v[188:191], v[96:111]
    buffer_load_dwordx4 a[20:23], v3, s[40:43], s49 offen offset:2048
    v_mfma_f32_32x32x16_bf16 v[112:127], v[236:239], v[188:191], v[112:127]
    s_waitcnt vmcnt(9)
    v_mfma_f32_32x32x16_bf16 v[64:79], v[240:243], v[192:195], v[64:79]
    buffer_load_dwordx4 a[24:27], v3, s[40:43], s48 offen offset:3072
    v_mfma_f32_32x32x16_bf16 v[80:95], v[244:247], v[192:195], v[80:95]
    buffer_load_dwordx4 a[28:31], v3, s[40:43], s49 offen offset:3072
    v_mfma_f32_32x32x16_bf16 v[96:111], v[240:243], v[196:199], v[96:111]
    s_add_u32 s48, s48, 4096
    s_add_u32 s49, s49, 4096
    buffer_load_dwordx4 a[32:35], v3, s[40:43], s48 offen offset:0
    v_mfma_f32_32x32x16_bf16 v[112:127], v[244:247], v[196:199], v[112:127]
    s_waitcnt vmcnt(10)
    v_mfma_f32_32x32x16_bf16 v[64:79], v[248:251], v[200:203], v[64:79]
    buffer_load_dwordx4 a[36:39], v3, s[40:43], s49 offen offset:0
    v_mfma_f32_32x32x16_bf16 v[80:95], v[252:255], v[200:203], v[80:95]
    buffer_load_dwordx4 a[40:43], v3, s[40:43], s48 offen offset:1024
    v_mfma_f32_32x32x16_bf16 v[96:111], v[248:251], v[204:207], v[96:111]
    buffer_load_dwordx4 a[44:47], v3, s[40:43], s49 offen offset:1024
    v_mfma_f32_32x32x16_bf16 v[112:127], v[252:255], v[204:207], v[112:127]
    buffer_load_dword v5, v1, s[40:43], s28 offen sc1
k345_5m3_0_x:
    s_branch k345_5top
k345_5ld1:
    s_add_u32 s48, s50, s17
    s_add_u32 s49, s51, s17
    s_bitset1_b32 s24, 1
    s_mov_b32 s29, s25
    s_mov_b32 s25, 1
    s_cmp_eq_u32 s29, 0
    s_cbranch_scc1 k345_5p0_1
    s_cmp_eq_u32 s29, 2
    s_cbranch_scc1 k345_5p2_1
    s_cmp_eq_u32 s29, 3
    s_cbranch_scc1 k345_5p3_1
    buffer_load_dwordx4 a[48:51], v3, s[40:43], s48 offen offset:0
    buffer_load_dwordx4 a[52:55], v3, s[40:43], s49 offen offset:0
    buffer_load_dwordx4 a[56:59], v3, s[40:43], s48 offen offset:1024
    buffer_load_dwordx4 a[60:63], v3, s[40:43], s49 offen offset:1024
    buffer_load_dwordx4 a[64:67], v3, s[40:43], s48 offen offset:2048
    buffer_load_dwordx4 a[68:71], v3, s[40:43], s49 offen offset:2048
    buffer_load_dwordx4 a[72:75], v3, s[40:43], s48 offen offset:3072
    buffer_load_dwordx4 a[76:79], v3, s[40:43], s49 offen offset:3072
    s_add_u32 s48, s48, 4096
    s_add_u32 s49, s49, 4096
    buffer_load_dwordx4 a[80:83], v3, s[40:43], s48 offen offset:0
    buffer_load_dwordx4 a[84:87], v3, s[40:43], s49 offen offset:0
    buffer_load_dwordx4 a[88:91], v3, s[40:43], s48 offen offset:1024
    buffer_load_dwordx4 a[92:95], v3, s[40:43], s49 offen offset:1024
    s_branch k345_5top
k345_5p0_1:
    s_waitcnt vmcnt(10)
    v_mfma_f32_32x32x16_bf16 v[64:79], a[128:131], a[0:3], v[64:79]
    buffer_load_dwordx4 a[48:51], v3, s[40:43], s48 offen offset:0
    v_mfma_f32_32x32x16_bf16 v[80:95], a[132:135], a[0:3], v[80:95]
    buffer_load_dwordx4 a[52:55], v3, s[40:43], s49 offen offset:0
    v_mfma_f32_32x32x16_bf16 v[96:111], a[128:131], a[4:7], v[96:111]
    buffer_load_dwordx4 a[56:59], v3, s[40:43], s48 offen offset:1024
    v_mfma_f32_32x32x16_bf16 v[112:127], a[132:135], a[4:7], v[112:127]
    buffer_load_dword v5, v1, s[40:43], s28 offen sc1
    s_waitcnt vmcnt(12)
    v_mfma_f32_32x32x16_bf16 v[64:79], a[136:139], a[8:11], v[64:79]
    buffer_load_dwordx4 a[60:63], v3, s[40:43], s49 offen offset:1024
    v_mfma_f32_32x32x16_bf16 v[80:95], a[140:143], a[8:11], v[80:95]
    buffer_load_dwordx4 a[64:67], v3, s[40:43], s48 offen offset:2048
    v_mfma_f32_32x32x16_bf16 v[96:111], a[136:139], a[12:15], v[96:111]
    buffer_load_dwordx4 a[68:71], v3, s[40:43], s49 offen offset:2048
    v_mfma_f32_32x32x16_bf16 v[112:127], a[140:143], a[12:15], v[112:127]
    s_waitcnt vmcnt(13)
    v_mfma_f32_32x32x16_bf16 v[64:79], a[144:147], a[16:19], v[64:79]
    buffer_load_dwordx4 a[72:75], v3, s[40:43], s48 offen offset:3072
    v_mfma_f32_32x32x16_bf16 v[80:95], a[148:151], a[16:19], v[80:95]
    buffer_load_dwordx4 a[76:79], v3, s[40:43], s49 offen offset:3072
    v_mfma_f32_32x32x16_bf16 v[96:111], a[144:147], a[20:23], v[96:111]
    s_add_u32 s48, s48, 4096
    s_add_u32 s49, s49, 4096
    buffer_load_dwordx4 a[80:83], v3, s[40:43], s48 offen offset:0
    v_mfma_f32_32x32x16_bf16 v[112:127], a[148:151], a[20:23], v[112:127]
    s_waitcnt vmcnt(14)
    v_mfma_f32_32x32x16_bf16 v[64:79], a[152:155], a[24:27], v[64:79]
    buffer_load_dwordx4 a[84:87], v3, s[40:43], s49 offen offset:0
    v_mfma_f32_32x32x16_bf16 v[80:95], a[156:159], a[24:27], v[80:95]
    buffer_load_dwordx4 a[88:91], v3, s[40:43], s48 offen offset:1024
    v_mfma_f32_32x32x16_bf16 v[96:111], a[152:155], a[28:31], v[96:111]
    buffer_load_dwordx4 a[92:95], v3, s[40:43], s49 offen offset:1024
    v_mfma_f32_32x32x16_bf16 v[112:127], a[156:159], a[28:31], v[112:127]
    buffer_load_dword v5, v1, s[40:43], s28 offen sc1
    s_waitcnt vmcnt(16)
    v_mfma_f32_32x32x16_bf16 v[64:79], a[160:163], a[32:35], v[64:79]
    v_mfma_f32_32x32x16_bf16 v[80:95], a[164:167], a[32:35], v[80:95]
    v_mfma_f32_32x32x16_bf16 v[96:111], a[160:163], a[36:39], v[96:111]
    v_mfma_f32_32x32x16_bf16 v[112:127], a[164:167], a[36:39], v[112:127]
    s_waitcnt vmcnt(14)
    v_mfma_f32_32x32x16_bf16 v[64:79], a[168:171], a[40:43], v[64:79]
    v_mfma_f32_32x32x16_bf16 v[80:95], a[172:175], a[40:43], v[80:95]
    v_mfma_f32_32x32x16_bf16 v[96:111], a[168:171], a[44:47], v[96:111]
    v_mfma_f32_32x32x16_bf16 v[112:127], a[172:175], a[44:47], v[112:127]
k345_5m0_1_x:
    s_branch k345_5top
k345_5p2_1:
    s_waitcnt vmcnt(10)
    v_mfma_f32_32x32x16_bf16 v[64:79], a[224:227], a[96:99], v[64:79]
    buffer_load_dwordx4 a[48:51], v3, s[40:43], s48 offen offset:0
    v_mfma_f32_32x32x16_bf16 v[80:95], a[228:231], a[96:99], v[80:95]
    buffer_load_dwordx4 a[52:55], v3, s[40:43], s49 offen offset:0
    v_mfma_f32_32x32x16_bf16 v[96:111], a[224:227], a[100:103], v[96:111]
    buffer_load_dwordx4 a[56:59], v3, s[40:43], s48 offen offset:1024
    v_mfma_f32_32x32x16_bf16 v[112:127], a[228:231], a[100:103], v[112:127]
    buffer_load_dword v5, v1, s[40:43], s28 offen sc1
    s_waitcnt vmcnt(12)
    v_mfma_f32_32x32x16_bf16 v[64:79], a[232:235], a[104:107], v[64:79]
    buffer_load_dwordx4 a[60:63], v3, s[40:43], s49 offen offset:1024
    v_mfma_f32_32x32x16_bf16 v[80:95], a[236:239], a[104:107], v[80:95]
    buffer_load_dwordx4 a[64:67], v3, s[40:43], s48 offen offset:2048
    v_mfma_f32_32x32x16_bf16 v[96:111], a[232:235], a[108:111], v[96:111]
    buffer_load_dwordx4 a[68:71], v3, s[40:43], s49 offen offset:2048
    v_mfma_f32_32x32x16_bf16 v[112:127], a[236:239], a[108:111], v[112:127]
    s_waitcnt vmcnt(13)
    v_mfma_f32_32x32x16_bf16 v[64:79], a[240:243], a[112:115], v[64:79]
    buffer_load_dwordx4 a[72:75], v3, s[40:43], s48 offen offset:3072
    v_mfma_f32_32x32x16_bf16 v[80:95], a[244:247], a[112:115], v[80:95]
    buffer_load_dwordx4 a[76:79], v3, s[40:43], s49 offen offset:3072
    v_mfma_f32_32x32x16_bf16 v[96:111], a[240:243], a[116:119], v[96:111]
    s_add_u32 s48, s48, 4096
    s_add_u32 s49, s49, 4096
    buffer_load_dwordx4 a[80:83], v3, s[40:43], s48 offen offset:0
    v_mfma_f32_32x32x16_bf16 v[112:127], a[244:247], a[116:119], v[112:127]
    s_waitcnt vmcnt(14)
    v_mfma_f32_32x32x16_bf16 v[64:79], a[248:251], a[120:123], v[64:79]
    buffer_load_dwordx4 a[84:87], v3, s[40:43], s49 offen offset:0
    v_mfma_f32_32x32x16_bf16 v[80:95], a[252:255], a[120:123], v[80:95]
    buffer_load_dwordx4 a[88:91], v3, s[40:43], s48 offen offset:1024
    v_mfma_f32_32x32x16_bf16 v[96:111], a[248:251], a[124:127], v[96:111]
    buffer_load_dwordx4 a[92:95], v3, s[40:43], s49 offen offset:1024
    v_mfma_f32_32x32x16_bf16 v[112:127], a[252:255], a[124:127], v[112:127]
    buffer_load_dword v5, v1, s[40:43], s28 offen sc1
    s_cmp_eq_u32 s3, 3
    s_cbranch_scc1 k345_5m2_1_x
    s_waitcnt vmcnt(16)
    v_mfma_f32_32x32x16_bf16 v[64:79], v[208:211], v[160:163], v[64:79]
    v_mfma_f32_32x32x16_bf16 v[80:95], v[212:215], v[160:163], v[80:95]
    v_mfma_f32_32x32x16_bf16 v[96:111], v[208:211], v[164:167], v[96:111]
    v_mfma_f32_32x32x16_bf16 v[112:127], v[212:215], v[164:167], v[112:127]
    s_waitcnt vmcnt(14)
    v_mfma_f32_32x32x16_bf16 v[64:79], v[216:219], v[168:171], v[64:79]
    v_mfma_f32_32x32x16_bf16 v[80:95], v[220:223], v[168:171], v[80:95]
    v_mfma_f32_32x32x16_bf16 v[96:111], v[216:219], v[172:175], v[96:111]
    v_mfma_f32_32x32x16_bf16 v[112:127], v[220:223], v[172:175], v[112:127]
k345_5m2_1_x:
    s_branch k345_5top
k345_5p3_1:
    s_waitcnt vmcnt(6)
    v_mfma_f32_32x32x16_bf16 v[64:79], v[224:227], v[176:179], v[64:79]
    buffer_load_dwordx4 a[48:51], v3, s[40:43], s48 offen offset:0
    v_mfma_f32_32x32x16_bf16 v[80:95], v[228:231], v[176:179], v[80:95]
    buffer_load_dwordx4 a[52:55], v3, s[40:43], s49 offen offset:0
    v_mfma_f32_32x32x16_bf16 v[96:111], v[224:227], v[180:183], v[96:111]
    buffer_load_dwordx4 a[56:59], v3, s[40:43], s48 offen offset:1024
    v_mfma_f32_32x32x16_bf16 v[112:127], v[228:231], v[180:183], v[112:127]
    buffer_load_dword v5, v1, s[40:43], s28 offen sc1
    s_waitcnt vmcnt(8)
    v_mfma_f32_32x32x16_bf16 v[64:79], v[232:235], v[184:187], v[64:79]
    buffer_load_dwordx4 a[60:63], v3, s[40:43], s49 offen offset:1024
    v_mfma_f32_32x32x16_bf16 v[80:95], v[236:239], v[184:187], v[80:95]
    buffer_load_dwordx4 a[64:67], v3, s[40:43], s48 offen offset:2048
    v_mfma_f32_32x32x16_bf16 v[96:111], v[232:235], v[188:191], v[96:111]
    buffer_load_dwordx4 a[68:71], v3, s[40:43], s49 offen offset:2048
    v_mfma_f32_32x32x16_bf16 v[112:127], v[236:239], v[188:191], v[112:127]
    s_waitcnt vmcnt(9)
    v_mfma_f32_32x32x16_bf16 v[64:79], v[240:243], v[192:195], v[64:79]
    buffer_load_dwordx4 a[72:75], v3, s[40:43], s48 offen offset:3072
    v_mfma_f32_32x32x16_bf16 v[80:95], v[244:247], v[192:195], v[80:95]
    buffer_load_dwordx4 a[76:79], v3, s[40:43], s49 offen offset:3072
    v_mfma_f32_32x32x16_bf16 v[96:111], v[240:243], v[196:199], v[96:111]
    s_add_u32 s48, s48, 4096
    s_add_u32 s49, s49, 4096
    buffer_load_dwordx4 a[80:83], v3, s[40:43], s48 offen offset:0
    v_mfma_f32_32x32x16_bf16 v[112:127], v[244:247], v[196:199], v[112:127]
    s_waitcnt vmcnt(10)
    v_mfma_f32_32x32x16_bf16 v[64:79], v[248:251], v[200:203], v[64:79]
    buffer_load_dwordx4 a[84:87], v3, s[40:43], s49 offen offset:0
    v_mfma_f32_32x32x16_bf16 v[80:95], v[252:255], v[200:203], v[80:95]
    buffer_load_dwordx4 a[88:91], v3, s[40:43], s48 offen offset:1024
    v_mfma_f32_32x32x16_bf16 v[96:111], v[248:251], v[204:207], v[96:111]
    buffer_load_dwordx4 a[92:95], v3, s[40:43], s49 offen offset:1024
    v_mfma_f32_32x32x16_bf16 v[112:127], v[252:255], v[204:207], v[112:127]
    buffer_load_dword v5, v1, s[40:43], s28 offen sc1
k345_5m3_1_x:
    s_branch k345_5top
k345_5ld2:
    s_add_u32 s48, s50, s18
    s_add_u32 s49, s51, s18
    s_bitset1_b32 s24, 2
    s_mov_b32 s29, s25
    s_mov_b32 s25, 2
    s_cmp_eq_u32 s29, 0
    s_cbranch_scc1 k345_5p0_2
    s_cmp_eq_u32 s29, 1
    s_cbranch_scc1 k345_5p1_2
    s_cmp_eq_u32 s29, 3
    s_cbranch_scc1 k345_5p3_2
    buffer_load_dwordx4 a[96:99], v3, s[40:43], s48 offen offset:0
    buffer_load_dwordx4 a[100:103], v3, s[40:43], s49 offen offset:0
    buffer_load_dwordx4 a[104:107], v3, s[40:43], s48 offen offset:1024
    buffer_load_dwordx4 a[108:111], v3, s[40:43], s49 offen offset:1024
    buffer_load_dwordx4 a[112:115], v3, s[40:43], s48 offen offset:2048
    buffer_load_dwordx4 a[116:119], v3, s[40:43], s49 offen offset:2048
    buffer_load_dwordx4 a[120:123], v3, s[40:43], s48 offen offset:3072
    buffer_load_dwordx4 a[124:127], v3, s[40:43], s49 offen offset:3072
    s_add_u32 s48, s48, s30
    s_add_u32 s49, s49, s30
    buffer_load_dwordx4 v[160:163], v3, s[40:43], s48 offen offset:0
    buffer_load_dwordx4 v[164:167], v3, s[40:43], s49 offen offset:0
    buffer_load_dwordx4 v[168:171], v3, s[40:43], s48 offen offset:1024
    buffer_load_dwordx4 v[172:175], v3, s[40:43], s49 offen offset:1024
    s_branch k345_5top
k345_5p0_2:
    s_waitcnt vmcnt(10)
    v_mfma_f32_32x32x16_bf16 v[64:79], a[128:131], a[0:3], v[64:79]
    buffer_load_dwordx4 a[96:99], v3, s[40:43], s48 offen offset:0
    v_mfma_f32_32x32x16_bf16 v[80:95], a[132:135], a[0:3], v[80:95]
    buffer_load_dwordx4 a[100:103], v3, s[40:43], s49 offen offset:0
    v_mfma_f32_32x32x16_bf16 v[96:111], a[128:131], a[4:7], v[96:111]
    buffer_load_dwordx4 a[104:107], v3, s[40:43], s48 offen offset:1024
    v_mfma_f32_32x32x16_bf16 v[112:127], a[132:135], a[4:7], v[112:127]
    buffer_load_dword v5, v1, s[40:43], s28 offen sc1
    s_waitcnt vmcnt(12)
    v_mfma_f32_32x32x16_bf16 v[64:79], a[136:139], a[8:11], v[64:79]
    buffer_load_dwordx4 a[108:111], v3, s[40:43], s49 offen offset:1024
    v_mfma_f32_32x32x16_bf16 v[80:95], a[140:143], a[8:11], v[80:95]
    buffer_load_dwordx4 a[112:115], v3, s[40:43], s48 offen offset:2048
    v_mfma_f32_32x32x16_bf16 v[96:111], a[136:139], a[12:15], v[96:111]
    buffer_load_dwordx4 a[116:119], v3, s[40:43], s49 offen offset:2048
    v_mfma_f32_32x32x16_bf16 v[112:127], a[140:143], a[12:15], v[112:127]
    s_waitcnt vmcnt(13)
    v_mfma_f32_32x32x16_bf16 v[64:79], a[144:147], a[16:19], v[64:79]
    buffer_load_dwordx4 a[120:123], v3, s[40:43], s48 offen offset:3072
    v_mfma_f32_32x32x16_bf16 v[80:95], a[148:151], a[16:19], v[80:95]
    buffer_load_dwordx4 a[124:127], v3, s[40:43], s49 offen offset:3072
    v_mfma_f32_32x32x16_bf16 v[96:111], a[144:147], a[20:23], v[96:111]
    s_add_u32 s48, s48, s30
    s_add_u32 s49, s49, s30
    buffer_load_dwordx4 v[160:163], v3, s[40:43], s48 offen offset:0
    v_mfma_f32_32x32x16_bf16 v[112:127], a[148:151], a[20:23], v[112:127]
    s_waitcnt vmcnt(14)
    v_mfma_f32_32x32x16_bf16 v[64:79], a[152:155], a[24:27], v[64:79]
    buffer_load_dwordx4 v[164:167], v3, s[40:43], s49 offen offset:0
    v_mfma_f32_32x32x16_bf16 v[80:95], a[156:159], a[24:27], v[80:95]
    buffer_load_dwordx4 v[168:171], v3, s[40:43], s48 offen offset:1024
    v_mfma_f32_32x32x16_bf16 v[96:111], a[152:155], a[28:31], v[96:111]
    buffer_load_dwordx4 v[172:175], v3, s[40:43], s49 offen offset:1024
    v_mfma_f32_32x32x16_bf16 v[112:127], a[156:159], a[28:31], v[112:127]
    buffer_load_dword v5, v1, s[40:43], s28 offen sc1
    s_waitcnt vmcnt(16)
    v_mfma_f32_32x32x16_bf16 v[64:79], a[160:163], a[32:35], v[64:79]
    v_mfma_f32_32x32x16_bf16 v[80:95], a[164:167], a[32:35], v[80:95]
    v_mfma_f32_32x32x16_bf16 v[96:111], a[160:163], a[36:39], v[96:111]
    v_mfma_f32_32x32x16_bf16 v[112:127], a[164:167], a[36:39], v[112:127]
    s_waitcnt vmcnt(14)
    v_mfma_f32_32x32x16_bf16 v[64:79], a[168:171], a[40:43], v[64:79]
    v_mfma_f32_32x32x16_bf16 v[80:95], a[172:175], a[40:43], v[80:95]
    v_mfma_f32_32x32x16_bf16 v[96:111], a[168:171], a[44:47], v[96:111]
    v_mfma_f32_32x32x16_bf16 v[112:127], a[172:175], a[44:47], v[112:127]
k345_5m0_2_x:
    s_branch k345_5top
k345_5p1_2:
    s_waitcnt vmcnt(10)
    v_mfma_f32_32x32x16_bf16 v[64:79], a[176:179], a[48:51], v[64:79]
    buffer_load_dwordx4 a[96:99], v3, s[40:43], s48 offen offset:0
    v_mfma_f32_32x32x16_bf16 v[80:95], a[180:183], a[48:51], v[80:95]
    buffer_load_dwordx4 a[100:103], v3, s[40:43], s49 offen offset:0
    v_mfma_f32_32x32x16_bf16 v[96:111], a[176:179], a[52:55], v[96:111]
    buffer_load_dwordx4 a[104:107], v3, s[40:43], s48 offen offset:1024
    v_mfma_f32_32x32x16_bf16 v[112:127], a[180:183], a[52:55], v[112:127]
    buffer_load_dword v5, v1, s[40:43], s28 offen sc1
    s_waitcnt vmcnt(12)
    v_mfma_f32_32x32x16_bf16 v[64:79], a[184:187], a[56:59], v[64:79]
    buffer_load_dwordx4 a[108:111], v3, s[40:43], s49 offen offset:1024
    v_mfma_f32_32x32x16_bf16 v[80:95], a[188:191], a[56:59], v[80:95]
    buffer_load_dwordx4 a[112:115], v3, s[40:43], s48 offen offset:2048
    v_mfma_f32_32x32x16_bf16 v[96:111], a[184:187], a[60:63], v[96:111]
    buffer_load_dwordx4 a[116:119], v3, s[40:43], s49 offen offset:2048
    v_mfma_f32_32x32x16_bf16 v[112:127], a[188:191], a[60:63], v[112:127]
    s_waitcnt vmcnt(13)
    v_mfma_f32_32x32x16_bf16 v[64:79], a[192:195], a[64:67], v[64:79]
    buffer_load_dwordx4 a[120:123], v3, s[40:43], s48 offen offset:3072
    v_mfma_f32_32x32x16_bf16 v[80:95], a[196:199], a[64:67], v[80:95]
    buffer_load_dwordx4 a[124:127], v3, s[40:43], s49 offen offset:3072
    v_mfma_f32_32x32x16_bf16 v[96:111], a[192:195], a[68:71], v[96:111]
    s_add_u32 s48, s48, s30
    s_add_u32 s49, s49, s30
    buffer_load_dwordx4 v[160:163], v3, s[40:43], s48 offen offset:0
    v_mfma_f32_32x32x16_bf16 v[112:127], a[196:199], a[68:71], v[112:127]
    s_waitcnt vmcnt(14)
    v_mfma_f32_32x32x16_bf16 v[64:79], a[200:203], a[72:75], v[64:79]
    buffer_load_dwordx4 v[164:167], v3, s[40:43], s49 offen offset:0
    v_mfma_f32_32x32x16_bf16 v[80:95], a[204:207], a[72:75], v[80:95]
    buffer_load_dwordx4 v[168:171], v3, s[40:43], s48 offen offset:1024
    v_mfma_f32_32x32x16_bf16 v[96:111], a[200:203], a[76:79], v[96:111]
    buffer_load_dwordx4 v[172:175], v3, s[40:43], s49 offen offset:1024
    v_mfma_f32_32x32x16_bf16 v[112:127], a[204:207], a[76:79], v[112:127]
    buffer_load_dword v5, v1, s[40:43], s28 offen sc1
    s_waitcnt vmcnt(16)
    v_mfma_f32_32x32x16_bf16 v[64:79], a[208:211], a[80:83], v[64:79]
    v_mfma_f32_32x32x16_bf16 v[80:95], a[212:215], a[80:83], v[80:95]
    v_mfma_f32_32x32x16_bf16 v[96:111], a[208:211], a[84:87], v[96:111]
    v_mfma_f32_32x32x16_bf16 v[112:127], a[212:215], a[84:87], v[112:127]
    s_waitcnt vmcnt(14)
    v_mfma_f32_32x32x16_bf16 v[64:79], a[216:219], a[88:91], v[64:79]
    v_mfma_f32_32x32x16_bf16 v[80:95], a[220:223], a[88:91], v[80:95]
    v_mfma_f32_32x32x16_bf16 v[96:111], a[216:219], a[92:95], v[96:111]
    v_mfma_f32_32x32x16_bf16 v[112:127], a[220:223], a[92:95], v[112:127]
k345_5m1_2_x:
    s_branch k345_5top
k345_5p3_2:
    s_waitcnt vmcnt(6)
    v_mfma_f32_32x32x16_bf16 v[64:79], v[224:227], v[176:179], v[64:79]
    buffer_load_dwordx4 a[96:99], v3, s[40:43], s48 offen offset:0
    v_mfma_f32_32x32x16_bf16 v[80:95], v[228:231], v[176:179], v[80:95]
    buffer_load_dwordx4 a[100:103], v3, s[40:43], s49 offen offset:0
    v_mfma_f32_32x32x16_bf16 v[96:111], v[224:227], v[180:183], v[96:111]
    buffer_load_dwordx4 a[104:107], v3, s[40:43], s48 offen offset:1024
    v_mfma_f32_32x32x16_bf16 v[112:127], v[228:231], v[180:183], v[112:127]
    buffer_load_dword v5, v1, s[40:43], s28 offen sc1
    s_waitcnt vmcnt(8)
    v_mfma_f32_32x32x16_bf16 v[64:79], v[232:235], v[184:187], v[64:79]
    buffer_load_dwordx4 a[108:111], v3, s[40:43], s49 offen offset:1024
    v_mfma_f32_32x32x16_bf16 v[80:95], v[236:239], v[184:187], v[80:95]
    buffer_load_dwordx4 a[112:115], v3, s[40:43], s48 offen offset:2048
    v_mfma_f32_32x32x16_bf16 v[96:111], v[232:235], v[188:191], v[96:111]
    buffer_load_dwordx4 a[116:119], v3, s[40:43], s49 offen offset:2048
    v_mfma_f32_32x32x16_bf16 v[112:127], v[236:239], v[188:191], v[112:127]
    s_waitcnt vmcnt(9)
    v_mfma_f32_32x32x16_bf16 v[64:79], v[240:243], v[192:195], v[64:79]
    buffer_load_dwordx4 a[120:123], v3, s[40:43], s48 offen offset:3072
    v_mfma_f32_32x32x16_bf16 v[80:95], v[244:247], v[192:195], v[80:95]
    buffer_load_dwordx4 a[124:127], v3, s[40:43], s49 offen offset:3072
    v_mfma_f32_32x32x16_bf16 v[96:111], v[240:243], v[196:199], v[96:111]
    s_add_u32 s48, s48, s30
    s_add_u32 s49, s49, s30
    buffer_load_dwordx4 v[160:163], v3, s[40:43], s48 offen offset:0
    v_mfma_f32_32x32x16_bf16 v[112:127], v[244:247], v[196:199], v[112:127]
    s_waitcnt vmcnt(10)
    v_mfma_f32_32x32x16_bf16 v[64:79], v[248:251], v[200:203], v[64:79]
    buffer_load_dwordx4 v[164:167], v3, s[40:43], s49 offen offset:0
    v_mfma_f32_32x32x16_bf16 v[80:95], v[252:255], v[200:203], v[80:95]
    buffer_load_dwordx4 v[168:171], v3, s[40:43], s48 offen offset:1024
    v_mfma_f32_32x32x16_bf16 v[96:111], v[248:251], v[204:207], v[96:111]
    buffer_load_dwordx4 v[172:175], v3, s[40:43], s49 offen offset:1024
    v_mfma_f32_32x32x16_bf16 v[112:127], v[252:255], v[204:207], v[112:127]
    buffer_load_dword v5, v1, s[40:43], s28 offen sc1
k345_5m3_2_x:
    s_branch k345_5top
k345_5ld3:
    s_add_u32 s48, s50, s19
    s_add_u32 s49, s51, s19
    s_bitset1_b32 s24, 3
    s_mov_b32 s29, s25
    s_mov_b32 s25, 3
    s_cmp_eq_u32 s29, 0
    s_cbranch_scc1 k345_5p0_3
    s_cmp_eq_u32 s29, 1
    s_cbranch_scc1 k345_5p1_3
    s_cmp_eq_u32 s29, 2
    s_cbranch_scc1 k345_5p2_3
    buffer_load_dwordx4 v[24:27], v9, s[40:43], s54 offen offset:0
    buffer_load_dwordx4 v[28:31], v9, s[40:43], s54 offen offset:16
    buffer_load_dwordx4 v[32:35], v9, s[40:43], s54 offen offset:64
    buffer_load_dwordx4 v[36:39], v9, s[40:43], s54 offen offset:80
    buffer_load_dwordx4 v[176:179], v3, s[40:43], s48 offen offset:0
    buffer_load_dwordx4 v[180:183], v3, s[40:43], s49 offen offset:0
    buffer_load_dwordx4 v[184:187], v3, s[40:43], s48 offen offset:1024
    buffer_load_dwordx4 v[188:191], v3, s[40:43], s49 offen offset:1024
    buffer_load_dwordx4 v[192:195], v3, s[40:43], s48 offen offset:2048
    buffer_load_dwordx4 v[196:199], v3, s[40:43], s49 offen offset:2048
    buffer_load_dwordx4 v[200:203], v3, s[40:43], s48 offen offset:3072
    buffer_load_dwordx4 v[204:207], v3, s[40:43], s49 offen offset:3072
    s_branch k345_5top
k345_5p0_3:
    s_waitcnt vmcnt(10)
    v_mfma_f32_32x32x16_bf16 v[64:79], a[128:131], a[0:3], v[64:79]
    buffer_load_dwordx4 v[24:27], v9, s[40:43], s54 offen offset:0
    v_mfma_f32_32x32x16_bf16 v[80:95], a[132:135], a[0:3], v[80:95]
    buffer_load_dwordx4 v[28:31], v9, s[40:43], s54 offen offset:16
    v_mfma_f32_32x32x16_bf16 v[96:111], a[128:131], a[4:7], v[96:111]
    buffer_load_dwordx4 v[32:35], v9, s[40:43], s54 offen offset:64
    v_mfma_f32_32x32x16_bf16 v[112:127], a[132:135], a[4:7], v[112:127]
    buffer_load_dword v5, v1, s[40:43], s28 offen sc1
    s_waitcnt vmcnt(12)
    v_mfma_f32_32x32x16_bf16 v[64:79], a[136:139], a[8:11], v[64:79]
    buffer_load_dwordx4 v[36:39], v9, s[40:43], s54 offen offset:80
    v_mfma_f32_32x32x16_bf16 v[80:95], a[140:143], a[8:11], v[80:95]
    buffer_load_dwordx4 v[176:179], v3, s[40:43], s48 offen offset:0
    v_mfma_f32_32x32x16_bf16 v[96:111], a[136:139], a[12:15], v[96:111]
    buffer_load_dwordx4 v[180:183], v3, s[40:43], s49 offen offset:0
    v_mfma_f32_32x32x16_bf16 v[112:127], a[140:143], a[12:15], v[112:127]
    s_waitcnt vmcnt(13)
    v_mfma_f32_32x32x16_bf16 v[64:79], a[144:147], a[16:19], v[64:79]
    buffer_load_dwordx4 v[184:187], v3, s[40:43], s48 offen offset:1024
    v_mfma_f32_32x32x16_bf16 v[80:95], a[148:151], a[16:19], v[80:95]
    buffer_load_dwordx4 v[188:191], v3, s[40:43], s49 offen offset:1024
    v_mfma_f32_32x32x16_bf16 v[96:111], a[144:147], a[20:23], v[96:111]
    buffer_load_dwordx4 v[192:195], v3, s[40:43], s48 offen offset:2048
    v_mfma_f32_32x32x16_bf16 v[112:127], a[148:151], a[20:23], v[112:127]
    s_waitcnt vmcnt(14)
    v_mfma_f32_32x32x16_bf16 v[64:79], a[152:155], a[24:27], v[64:79]
    buffer_load_dwordx4 v[196:199], v3, s[40:43], s49 offen offset:2048
    v_mfma_f32_32x32x16_bf16 v[80:95], a[156:159], a[24:27], v[80:95]
    buffer_load_dwordx4 v[200:203], v3, s[40:43], s48 offen offset:3072
    v_mfma_f32_32x32x16_bf16 v[96:111], a[152:155], a[28:31], v[96:111]
    buffer_load_dwordx4 v[204:207], v3, s[40:43], s49 offen offset:3072
    v_mfma_f32_32x32x16_bf16 v[112:127], a[156:159], a[28:31], v[112:127]
    buffer_load_dword v5, v1, s[40:43], s28 offen sc1
    s_waitcnt vmcnt(16)
    v_mfma_f32_32x32x16_bf16 v[64:79], a[160:163], a[32:35], v[64:79]
    v_mfma_f32_32x32x16_bf16 v[80:95], a[164:167], a[32:35], v[80:95]
    v_mfma_f32_32x32x16_bf16 v[96:111], a[160:163], a[36:39], v[96:111]
    v_mfma_f32_32x32x16_bf16 v[112:127], a[164:167], a[36:39], v[112:127]
    s_waitcnt vmcnt(14)
    v_mfma_f32_32x32x16_bf16 v[64:79], a[168:171], a[40:43], v[64:79]
    v_mfma_f32_32x32x16_bf16 v[80:95], a[172:175], a[40:43], v[80:95]
    v_mfma_f32_32x32x16_bf16 v[96:111], a[168:171], a[44:47], v[96:111]
    v_mfma_f32_32x32x16_bf16 v[112:127], a[172:175], a[44:47], v[112:127]
k345_5m0_3_x:
    s_branch k345_5top
k345_5p1_3:
    s_waitcnt vmcnt(10)
    v_mfma_f32_32x32x16_bf16 v[64:79], a[176:179], a[48:51], v[64:79]
    buffer_load_dwordx4 v[24:27], v9, s[40:43], s54 offen offset:0
    v_mfma_f32_32x32x16_bf16 v[80:95], a[180:183], a[48:51], v[80:95]
    buffer_load_dwordx4 v[28:31], v9, s[40:43], s54 offen offset:16
    v_mfma_f32_32x32x16_bf16 v[96:111], a[176:179], a[52:55], v[96:111]
    buffer_load_dwordx4 v[32:35], v9, s[40:43], s54 offen offset:64
    v_mfma_f32_32x32x16_bf16 v[112:127], a[180:183], a[52:55], v[112:127]
    buffer_load_dword v5, v1, s[40:43], s28 offen sc1
    s_waitcnt vmcnt(12)
    v_mfma_f32_32x32x16_bf16 v[64:79], a[184:187], a[56:59], v[64:79]
    buffer_load_dwordx4 v[36:39], v9, s[40:43], s54 offen offset:80
    v_mfma_f32_32x32x16_bf16 v[80:95], a[188:191], a[56:59], v[80:95]
    buffer_load_dwordx4 v[176:179], v3, s[40:43], s48 offen offset:0
    v_mfma_f32_32x32x16_bf16 v[96:111], a[184:187], a[60:63], v[96:111]
    buffer_load_dwordx4 v[180:183], v3, s[40:43], s49 offen offset:0
    v_mfma_f32_32x32x16_bf16 v[112:127], a[188:191], a[60:63], v[112:127]
    s_waitcnt vmcnt(13)
    v_mfma_f32_32x32x16_bf16 v[64:79], a[192:195], a[64:67], v[64:79]
    buffer_load_dwordx4 v[184:187], v3, s[40:43], s48 offen offset:1024
    v_mfma_f32_32x32x16_bf16 v[80:95], a[196:199], a[64:67], v[80:95]
    buffer_load_dwordx4 v[188:191], v3, s[40:43], s49 offen offset:1024
    v_mfma_f32_32x32x16_bf16 v[96:111], a[192:195], a[68:71], v[96:111]
    buffer_load_dwordx4 v[192:195], v3, s[40:43], s48 offen offset:2048
    v_mfma_f32_32x32x16_bf16 v[112:127], a[196:199], a[68:71], v[112:127]
    s_waitcnt vmcnt(14)
    v_mfma_f32_32x32x16_bf16 v[64:79], a[200:203], a[72:75], v[64:79]
    buffer_load_dwordx4 v[196:199], v3, s[40:43], s49 offen offset:2048
    v_mfma_f32_32x32x16_bf16 v[80:95], a[204:207], a[72:75], v[80:95]
    buffer_load_dwordx4 v[200:203], v3, s[40:43], s48 offen offset:3072
    v_mfma_f32_32x32x16_bf16 v[96:111], a[200:203], a[76:79], v[96:111]
    buffer_load_dwordx4 v[204:207], v3, s[40:43], s49 offen offset:3072
    v_mfma_f32_32x32x16_bf16 v[112:127], a[204:207], a[76:79], v[112:127]
    buffer_load_dword v5, v1, s[40:43], s28 offen sc1
    s_waitcnt vmcnt(16)
    v_mfma_f32_32x32x16_bf16 v[64:79], a[208:211], a[80:83], v[64:79]
    v_mfma_f32_32x32x16_bf16 v[80:95], a[212:215], a[80:83], v[80:95]
    v_mfma_f32_32x32x16_bf16 v[96:111], a[208:211], a[84:87], v[96:111]
    v_mfma_f32_32x32x16_bf16 v[112:127], a[212:215], a[84:87], v[112:127]
    s_waitcnt vmcnt(14)
    v_mfma_f32_32x32x16_bf16 v[64:79], a[216:219], a[88:91], v[64:79]
    v_mfma_f32_32x32x16_bf16 v[80:95], a[220:223], a[88:91], v[80:95]
    v_mfma_f32_32x32x16_bf16 v[96:111], a[216:219], a[92:95], v[96:111]
    v_mfma_f32_32x32x16_bf16 v[112:127], a[220:223], a[92:95], v[112:127]
k345_5m1_3_x:
    s_branch k345_5top
k345_5p2_3:
    s_waitcnt vmcnt(10)
    v_mfma_f32_32x32x16_bf16 v[64:79], a[224:227], a[96:99], v[64:79]
    buffer_load_dwordx4 v[24:27], v9, s[40:43], s54 offen offset:0
    v_mfma_f32_32x32x16_bf16 v[80:95], a[228:231], a[96:99], v[80:95]
    buffer_load_dwordx4 v[28:31], v9, s[40:43], s54 offen offset:16
    v_mfma_f32_32x32x16_bf16 v[96:111], a[224:227], a[100:103], v[96:111]
    buffer_load_dwordx4 v[32:35], v9, s[40:43], s54 offen offset:64
    v_mfma_f32_32x32x16_bf16 v[112:127], a[228:231], a[100:103], v[112:127]
    buffer_load_dword v5, v1, s[40:43], s28 offen sc1
    s_waitcnt vmcnt(12)
    v_mfma_f32_32x32x16_bf16 v[64:79], a[232:235], a[104:107], v[64:79]
    buffer_load_dwordx4 v[36:39], v9, s[40:43], s54 offen offset:80
    v_mfma_f32_32x32x16_bf16 v[80:95], a[236:239], a[104:107], v[80:95]
    buffer_load_dwordx4 v[176:179], v3, s[40:43], s48 offen offset:0
    v_mfma_f32_32x32x16_bf16 v[96:111], a[232:235], a[108:111], v[96:111]
    buffer_load_dwordx4 v[180:183], v3, s[40:43], s49 offen offset:0
    v_mfma_f32_32x32x16_bf16 v[112:127], a[236:239], a[108:111], v[112:127]
    s_waitcnt vmcnt(13)
    v_mfma_f32_32x32x16_bf16 v[64:79], a[240:243], a[112:115], v[64:79]
    buffer_load_dwordx4 v[184:187], v3, s[40:43], s48 offen offset:1024
    v_mfma_f32_32x32x16_bf16 v[80:95], a[244:247], a[112:115], v[80:95]
    buffer_load_dwordx4 v[188:191], v3, s[40:43], s49 offen offset:1024
    v_mfma_f32_32x32x16_bf16 v[96:111], a[240:243], a[116:119], v[96:111]
    buffer_load_dwordx4 v[192:195], v3, s[40:43], s48 offen offset:2048
    v_mfma_f32_32x32x16_bf16 v[112:127], a[244:247], a[116:119], v[112:127]
    s_waitcnt vmcnt(14)
    v_mfma_f32_32x32x16_bf16 v[64:79], a[248:251], a[120:123], v[64:79]
    buffer_load_dwordx4 v[196:199], v3, s[40:43], s49 offen offset:2048
    v_mfma_f32_32x32x16_bf16 v[80:95], a[252:255], a[120:123], v[80:95]
    buffer_load_dwordx4 v[200:203], v3, s[40:43], s48 offen offset:3072
    v_mfma_f32_32x32x16_bf16 v[96:111], a[248:251], a[124:127], v[96:111]
    buffer_load_dwordx4 v[204:207], v3, s[40:43], s49 offen offset:3072
    v_mfma_f32_32x32x16_bf16 v[112:127], a[252:255], a[124:127], v[112:127]
    buffer_load_dword v5, v1, s[40:43], s28 offen sc1
    s_cmp_eq_u32 s3, 3
    s_cbranch_scc1 k345_5m2_3_x
    s_waitcnt vmcnt(16)
    v_mfma_f32_32x32x16_bf16 v[64:79], v[208:211], v[160:163], v[64:79]
    v_mfma_f32_32x32x16_bf16 v[80:95], v[212:215], v[160:163], v[80:95]
    v_mfma_f32_32x32x16_bf16 v[96:111], v[208:211], v[164:167], v[96:111]
    v_mfma_f32_32x32x16_bf16 v[112:127], v[212:215], v[164:167], v[112:127]
    s_waitcnt vmcnt(14)
    v_mfma_f32_32x32x16_bf16 v[64:79], v[216:219], v[168:171], v[64:79]
    v_mfma_f32_32x32x16_bf16 v[80:95], v[220:223], v[168:171], v[80:95]
    v_mfma_f32_32x32x16_bf16 v[96:111], v[216:219], v[172:175], v[96:111]
    v_mfma_f32_32x32x16_bf16 v[112:127], v[220:223], v[172:175], v[112:127]
k345_5m2_3_x:
    s_branch k345_5top
k345_5m1_0:
    buffer_load_dword v5, v1, s[40:43], s28 offen sc1
    s_waitcnt vmcnt(11)
    v_mfma_f32_32x32x16_bf16 v[64:79], a[128:131], a[0:3], v[64:79]
    v_mfma_f32_32x32x16_bf16 v[80:95], a[132:135], a[0:3], v[80:95]
    v_mfma_f32_32x32x16_bf16 v[96:111], a[128:131], a[4:7], v[96:111]
    v_mfma_f32_32x32x16_bf16 v[112:127], a[132:135], a[4:7], v[112:127]
    buffer_load_dword v5, v1, s[40:43], s28 offen sc1
    s_waitcnt vmcnt(10)
    v_mfma_f32_32x32x16_bf16 v[64:79], a[136:139], a[8:11], v[64:79]
    v_mfma_f32_32x32x16_bf16 v[80:95], a[140:143], a[8:11], v[80:95]
    v_mfma_f32_32x32x16_bf16 v[96:111], a[136:139], a[12:15], v[96:111]
    v_mfma_f32_32x32x16_bf16 v[112:127], a[140:143], a[12:15], v[112:127]
    s_waitcnt vmcnt(8)
    v_mfma_f32_32x32x16_bf16 v[64:79], a[144:147], a[16:19], v[64:79]
    v_mfma_f32_32x32x16_bf16 v[80:95], a[148:151], a[16:19], v[80:95]
    v_mfma_f32_32x32x16_bf16 v[96:111], a[144:147], a[20:23], v[96:111]
    v_mfma_f32_32x32x16_bf16 v[112:127], a[148:151], a[20:23], v[112:127]
    s_waitcnt vmcnt(6)
    v_mfma_f32_32x32x16_bf16 v[64:79], a[152:155], a[24:27], v[64:79]
    v_mfma_f32_32x32x16_bf16 v[80:95], a[156:159], a[24:27], v[80:95]
    v_mfma_f32_32x32x16_bf16 v[96:111], a[152:155], a[28:31], v[96:111]
    v_mfma_f32_32x32x16_bf16 v[112:127], a[156:159], a[28:31], v[112:127]
    buffer_load_dword v5, v1, s[40:43], s28 offen sc1
    s_waitcnt vmcnt(5)
    v_mfma_f32_32x32x16_bf16 v[64:79], a[160:163], a[32:35], v[64:79]
    v_mfma_f32_32x32x16_bf16 v[80:95], a[164:167], a[32:35], v[80:95]
    v_mfma_f32_32x32x16_bf16 v[96:111], a[160:163], a[36:39], v[96:111]
    v_mfma_f32_32x32x16_bf16 v[112:127], a[164:167], a[36:39], v[112:127]
    s_waitcnt vmcnt(3)
    v_mfma_f32_32x32x16_bf16 v[64:79], a[168:171], a[40:43], v[64:79]
    v_mfma_f32_32x32x16_bf16 v[80:95], a[172:175], a[40:43], v[80:95]
    v_mfma_f32_32x32x16_bf16 v[96:111], a[168:171], a[44:47], v[96:111]
    v_mfma_f32_32x32x16_bf16 v[112:127], a[172:175], a[44:47], v[112:127]
k345_5m0_None_x:
    s_mov_b32 s25, -1
    s_cmp_eq_u32 s24, 15
    s_cbranch_scc1 k345_5end
    s_branch k345_5top
k345_5m1_1:
    buffer_load_dword v5, v1, s[40:43], s28 offen sc1
    s_waitcnt vmcnt(11)
    v_mfma_f32_32x32x16_bf16 v[64:79], a[176:179], a[48:51], v[64:79]
    v_mfma_f32_32x32x16_bf16 v[80:95], a[180:183], a[48:51], v[80:95]
    v_mfma_f32_32x32x16_bf16 v[96:111], a[176:179], a[52:55], v[96:111]
    v_mfma_f32_32x32x16_bf16 v[112:127], a[180:183], a[52:55], v[112:127]
    buffer_load_dword v5, v1, s[40:43], s28 offen sc1
    s_waitcnt vmcnt(10)
    v_mfma_f32_32x32x16_bf16 v[64:79], a[184:187], a[56:59], v[64:79]
    v_mfma_f32_32x32x16_bf16 v[80:95], a[188:191], a[56:59], v[80:95]
    v_mfma_f32_32x32x16_bf16 v[96:111], a[184:187], a[60:63], v[96:111]
    v_mfma_f32_32x32x16_bf16 v[112:127], a[188:191], a[60:63], v[112:127]
    s_waitcnt vmcnt(8)
    v_mfma_f32_32x32x16_bf16 v[64:79], a[192:195], a[64:67], v[64:79]
    v_mfma_f32_32x32x16_bf16 v[80:95], a[196:199], a[64:67], v[80:95]
    v_mfma_f32_32x32x16_bf16 v[96:111], a[192:195], a[68:71], v[96:111]
    v_mfma_f32_32x32x16_bf16 v[112:127], a[196:199], a[68:71], v[112:127]
    s_waitcnt vmcnt(6)
    v_mfma_f32_32x32x16_bf16 v[64:79], a[200:203], a[72:75], v[64:79]
    v_mfma_f32_32x32x16_bf16 v[80:95], a[204:207], a[72:75], v[80:95]
    v_mfma_f32_32x32x16_bf16 v[96:111], a[200:203], a[76:79], v[96:111]
    v_mfma_f32_32x32x16_bf16 v[112:127], a[204:207], a[76:79], v[112:127]
    buffer_load_dword v5, v1, s[40:43], s28 offen sc1
    s_waitcnt vmcnt(5)
    v_mfma_f32_32x32x16_bf16 v[64:79], a[208:211], a[80:83], v[64:79]
    v_mfma_f32_32x32x16_bf16 v[80:95], a[212:215], a[80:83], v[80:95]
    v_mfma_f32_32x32x16_bf16 v[96:111], a[208:211], a[84:87], v[96:111]
    v_mfma_f32_32x32x16_bf16 v[112:127], a[212:215], a[84:87], v[112:127]
    s_waitcnt vmcnt(3)
    v_mfma_f32_32x32x16_bf16 v[64:79], a[216:219], a[88:91], v[64:79]
    v_mfma_f32_32x32x16_bf16 v[80:95], a[220:223], a[88:91], v[80:95]
    v_mfma_f32_32x32x16_bf16 v[96:111], a[216:219], a[92:95], v[96:111]
    v_mfma_f32_32x32x16_bf16 v[112:127], a[220:223], a[92:95], v[112:127]
k345_5m1_None_x:
    s_mov_b32 s25, -1
    s_cmp_eq_u32 s24, 15
    s_cbranch_scc1 k345_5end
    s_branch k345_5top
k345_5m1_2:
    buffer_load_dword v5, v1, s[40:43], s28 offen sc1
    s_waitcnt vmcnt(11)
    v_mfma_f32_32x32x16_bf16 v[64:79], a[224:227], a[96:99], v[64:79]
    v_mfma_f32_32x32x16_bf16 v[80:95], a[228:231], a[96:99], v[80:95]
    v_mfma_f32_32x32x16_bf16 v[96:111], a[224:227], a[100:103], v[96:111]
    v_mfma_f32_32x32x16_bf16 v[112:127], a[228:231], a[100:103], v[112:127]
    buffer_load_dword v5, v1, s[40:43], s28 offen sc1
    s_waitcnt vmcnt(10)
    v_mfma_f32_32x32x16_bf16 v[64:79], a[232:235], a[104:107], v[64:79]
    v_mfma_f32_32x32x16_bf16 v[80:95], a[236:239], a[104:107], v[80:95]
    v_mfma_f32_32x32x16_bf16 v[96:111], a[232:235], a[108:111], v[96:111]
    v_mfma_f32_32x32x16_bf16 v[112:127], a[236:239], a[108:111], v[112:127]
    s_waitcnt vmcnt(8)
    v_mfma_f32_32x32x16_bf16 v[64:79], a[240:243], a[112:115], v[64:79]
    v_mfma_f32_32x32x16_bf16 v[80:95], a[244:247], a[112:115], v[80:95]
    v_mfma_f32_32x32x16_bf16 v[96:111], a[240:243], a[116:119], v[96:111]
    v_mfma_f32_32x32x16_bf16 v[112:127], a[244:247], a[116:119], v[112:127]
    s_waitcnt vmcnt(6)
    v_mfma_f32_32x32x16_bf16 v[64:79], a[248:251], a[120:123], v[64:79]
    v_mfma_f32_32x32x16_bf16 v[80:95], a[252:255], a[120:123], v[80:95]
    v_mfma_f32_32x32x16_bf16 v[96:111], a[248:251], a[124:127], v[96:111]
    v_mfma_f32_32x32x16_bf16 v[112:127], a[252:255], a[124:127], v[112:127]
    buffer_load_dword v5, v1, s[40:43], s28 offen sc1
    s_cmp_eq_u32 s3, 3
    s_cbranch_scc0 k345_5m2_None_x_c
    s_waitcnt vmcnt(3)
    s_branch k345_5m2_None_x
k345_5m2_None_x_c:
    s_waitcnt vmcnt(5)
    v_mfma_f32_32x32x16_bf16 v[64:79], v[208:211], v[160:163], v[64:79]
    v_mfma_f32_32x32x16_bf16 v[80:95], v[212:215], v[160:163], v[80:95]
    v_mfma_f32_32x32x16_bf16 v[96:111], v[208:211], v[164:167], v[96:111]
    v_mfma_f32_32x32x16_bf16 v[112:127], v[212:215], v[164:167], v[112:127]
    s_waitcnt vmcnt(3)
    v_mfma_f32_32x32x16_bf16 v[64:79], v[216:219], v[168:171], v[64:79]
    v_mfma_f32_32x32x16_bf16 v[80:95], v[220:223], v[168:171], v[80:95]
    v_mfma_f32_32x32x16_bf16 v[96:111], v[216:219], v[172:175], v[96:111]
    v_mfma_f32_32x32x16_bf16 v[112:127], v[220:223], v[172:175], v[112:127]
k345_5m2_None_x:
    s_mov_b32 s25, -1
    s_cmp_eq_u32 s24, 15
    s_cbranch_scc1 k345_5end
    s_branch k345_5top
k345_5m1_3:
    buffer_load_dword v5, v1, s[40:43], s28 offen sc1
    s_waitcnt vmcnt(7)
    v_mfma_f32_32x32x16_bf16 v[64:79], v[224:227], v[176:179], v[64:79]
    v_mfma_f32_32x32x16_bf16 v[80:95], v[228:231], v[176:179], v[80:95]
    v_mfma_f32_32x32x16_bf16 v[96:111], v[224:227], v[180:183], v[96:111]
    v_mfma_f32_32x32x16_bf16 v[112:127], v[228:231], v[180:183], v[112:127]
    buffer_load_dword v5, v1, s[40:43], s28 offen sc1
    s_waitcnt vmcnt(6)
    v_mfma_f32_32x32x16_bf16 v[64:79], v[232:235], v[184:187], v[64:79]
    v_mfma_f32_32x32x16_bf16 v[80:95], v[236:239], v[184:187], v[80:95]
    v_mfma_f32_32x32x16_bf16 v[96:111], v[232:235], v[188:191], v[96:111]
    v_mfma_f32_32x32x16_bf16 v[112:127], v[236:239], v[188:191], v[112:127]
    s_waitcnt vmcnt(4)
    v_mfma_f32_32x32x16_bf16 v[64:79], v[240:243], v[192:195], v[64:79]
    v_mfma_f32_32x32x16_bf16 v[80:95], v[244:247], v[192:195], v[80:95]
    v_mfma_f32_32x32x16_bf16 v[96:111], v[240:243], v[196:199], v[96:111]
    v_mfma_f32_32x32x16_bf16 v[112:127], v[244:247], v[196:199], v[112:127]
    s_waitcnt vmcnt(2)
    v_mfma_f32_32x32x16_bf16 v[64:79], v[248:251], v[200:203], v[64:79]
    v_mfma_f32_32x32x16_bf16 v[80:95], v[252:255], v[200:203], v[80:95]
    v_mfma_f32_32x32x16_bf16 v[96:111], v[248:251], v[204:207], v[96:111]
    v_mfma_f32_32x32x16_bf16 v[112:127], v[252:255], v[204:207], v[112:127]
    buffer_load_dword v5, v1, s[40:43], s28 offen sc1
k345_5m3_None_x:
    s_mov_b32 s25, -1
    s_cmp_eq_u32 s24, 15
    s_cbranch_scc1 k345_5end
k345_5top:
    v_cmp_eq_u32 vcc, 1, v5
    s_nop 0
    s_mov_b32 s26, vcc_lo
    s_bitcmp1_b32 s24, 3
    s_cbranch_scc1 k345_5n3
    s_bitcmp1_b32 s26, s23
    s_cbranch_scc1 k345_5ld3
k345_5n3:
    s_bitcmp1_b32 s24, 0
    s_cbranch_scc1 k345_5n0
    s_bitcmp1_b32 s26, s20
    s_cbranch_scc1 k345_5ld0
k345_5n0:
    s_bitcmp1_b32 s24, 1
    s_cbranch_scc1 k345_5n1
    s_bitcmp1_b32 s26, s21
    s_cbranch_scc1 k345_5ld1
k345_5n1:
    s_bitcmp1_b32 s24, 2
    s_cbranch_scc1 k345_5n2
    s_bitcmp1_b32 s26, s22
    s_cbranch_scc1 k345_5ld2
k345_5n2:
    s_cmp_eq_u32 s25, 0
    s_cbranch_scc1 k345_5m1_0
    s_cmp_eq_u32 s25, 1
    s_cbranch_scc1 k345_5m1_1
    s_cmp_eq_u32 s25, 2
    s_cbranch_scc1 k345_5m1_2
    s_cmp_eq_u32 s25, 3
    s_cbranch_scc1 k345_5m1_3
    buffer_load_dword v5, v1, s[40:43], s28 offen sc1
    s_sleep 4
    s_waitcnt vmcnt(8)
    s_add_u32 s27, s27, 1
    s_cmp_lt_u32 s27, 16000
    s_cbranch_scc1 k345_5top
    s_mov_b32 s62, 1
k345_5end:
    s_xor_b32 s13, s3, 1
    s_mul_i32 s13, s13, 3
    s_add_u32 s13, s13, 24
    s_lshl_b32 s13, s13, 12
    v_add_u32 v13, s13, v3
    s_nop 1
    ds_write_b128 v13, v[80:83] offset:0
    ds_write_b128 v13, v[84:87] offset:1024
    ds_write_b128 v13, v[88:91] offset:2048
    ds_write_b128 v13, v[92:95] offset:3072
    s_xor_b32 s13, s3, 2
    s_mul_i32 s13, s13, 3
    s_add_u32 s13, s13, 25
    s_lshl_b32 s13, s13, 12
    v_add_u32 v14, s13, v3
    ds_write_b128 v14, v[96:99] offset:0
    ds_write_b128 v14, v[100:103] offset:1024
    ds_write_b128 v14, v[104:107] offset:2048
    ds_write_b128 v14, v[108:111] offset:3072
    s_xor_b32 s13, s3, 3
    s_mul_i32 s13, s13, 3
    s_add_u32 s13, s13, 26
    s_lshl_b32 s13, s13, 12
    v_add_u32 v15, s13, v3
    ds_write_b128 v15, v[112:115] offset:0
    ds_write_b128 v15, v[116:119] offset:1024
    ds_write_b128 v15, v[120:123] offset:2048
    ds_write_b128 v15, v[124:127] offset:3072
    s_mul_i32 s13, s3, 12288
    s_add_u32 s13, s13, 98304
    v_add_u32 v13, s13, v3
    s_lshl_b32 s63, s3, 2
    s_add_u32 s63, s63, 155664
    v_mov_b32 v14, s63
    v_mov_b32 v15, s62
    ds_write_b32 v14, v15
    v_mov_b32 v14, 155664
    s_waitcnt lgkmcnt(0)
    s_barrier
    ds_read_b128 v[144:147], v13 offset:0
    ds_read_b128 v[148:151], v13 offset:1024
    ds_read_b128 v[152:155], v13 offset:2048
    ds_read_b128 v[156:159], v13 offset:3072
    ds_read_b128 v[160:163], v13 offset:4096
    ds_read_b128 v[164:167], v13 offset:5120
    ds_read_b128 v[168:171], v13 offset:6144
    ds_read_b128 v[172:175], v13 offset:7168
    ds_read_b128 v[176:179], v13 offset:8192
    ds_read_b128 v[180:183], v13 offset:9216
    ds_read_b128 v[184:187], v13 offset:10240
    ds_read_b128 v[188:191], v13 offset:11264
    ds_read_b128 v[192:195], v14
    s_waitcnt lgkmcnt(9)
    v_pk_add_f32 v[64:65], v[64:65], v[144:145]
    v_pk_add_f32 v[66:67], v[66:67], v[146:147]
    v_pk_add_f32 v[68:69], v[68:69], v[148:149]
    v_pk_add_f32 v[70:71], v[70:71], v[150:151]
    v_pk_add_f32 v[72:73], v[72:73], v[152:153]
    v_pk_add_f32 v[74:75], v[74:75], v[154:155]
    v_pk_add_f32 v[76:77], v[76:77], v[156:157]
    v_pk_add_f32 v[78:79], v[78:79], v[158:159]
    s_waitcnt lgkmcnt(5)
    v_pk_add_f32 v[64:65], v[64:65], v[160:161]
    v_pk_add_f32 v[66:67], v[66:67], v[162:163]
    v_pk_add_f32 v[68:69], v[68:69], v[164:165]
    v_pk_add_f32 v[70:71], v[70:71], v[166:167]
    v_pk_add_f32 v[72:73], v[72:73], v[168:169]
    v_pk_add_f32 v[74:75], v[74:75], v[170:171]
    v_pk_add_f32 v[76:77], v[76:77], v[172:173]
    v_pk_add_f32 v[78:79], v[78:79], v[174:175]
    s_waitcnt lgkmcnt(1)
    v_pk_add_f32 v[64:65], v[64:65], v[176:177]
    v_pk_add_f32 v[66:67], v[66:67], v[178:179]
    v_pk_add_f32 v[68:69], v[68:69], v[180:181]
    v_pk_add_f32 v[70:71], v[70:71], v[182:183]
    v_pk_add_f32 v[72:73], v[72:73], v[184:185]
    v_pk_add_f32 v[74:75], v[74:75], v[186:187]
    v_pk_add_f32 v[76:77], v[76:77], v[188:189]
    v_pk_add_f32 v[78:79], v[78:79], v[190:191]
    s_waitcnt lgkmcnt(0)
    v_or3_b32 v192, v192, v193, v194
    v_or_b32 v192, v192, v195
    s_nop 0
    v_readfirstlane_b32 s63, v192
    s_nop 0
    s_cmp_lg_u32 s63, 0
    s_cbranch_scc1 k345_help4
    v_lshlrev_b32 v144, 16, v16
    v_and_b32 v145, 0xffff0000, v16
    v_pk_fma_f32 v[64:65], v[64:65], v[24:25], v[144:145]
    v_cvt_pk_bf16_f32 v148, v64, v65
    v_lshlrev_b32 v146, 16, v17
    v_and_b32 v147, 0xffff0000, v17
    v_pk_fma_f32 v[66:67], v[66:67], v[26:27], v[146:147]
    v_cvt_pk_bf16_f32 v149, v66, v67
    v_lshlrev_b32 v144, 16, v18
    v_and_b32 v145, 0xffff0000, v18
    v_pk_fma_f32 v[68:69], v[68:69], v[28:29], v[144:145]
    v_cvt_pk_bf16_f32 v150, v68, v69
    v_lshlrev_b32 v146, 16, v19
    v_and_b32 v147, 0xffff0000, v19
    v_pk_fma_f32 v[70:71], v[70:71], v[30:31], v[146:147]
    v_cvt_pk_bf16_f32 v151, v70, v71
    v_lshlrev_b32 v144, 16, v20
    v_and_b32 v145, 0xffff0000, v20
    v_pk_fma_f32 v[72:73], v[72:73], v[32:33], v[144:145]
    v_cvt_pk_bf16_f32 v152, v72, v73
    v_lshlrev_b32 v146, 16, v21
    v_and_b32 v147, 0xffff0000, v21
    v_pk_fma_f32 v[74:75], v[74:75], v[34:35], v[146:147]
    v_cvt_pk_bf16_f32 v153, v74, v75
    v_lshlrev_b32 v144, 16, v22
    v_and_b32 v145, 0xffff0000, v22
    v_pk_fma_f32 v[76:77], v[76:77], v[36:37], v[144:145]
    v_cvt_pk_bf16_f32 v154, v76, v77
    v_lshlrev_b32 v146, 16, v23
    v_and_b32 v147, 0xffff0000, v23
    v_pk_fma_f32 v[78:79], v[78:79], v[38:39], v[146:147]
    v_cvt_pk_bf16_f32 v155, v78, v79
    buffer_store_dwordx4 v[148:151], v10, s[56:59], s52 offen
    buffer_store_dwordx4 v[152:155], v10, s[56:59], s52 offen offset:32
    s_endpgm
k345_kernel_end:
    s_endpgm
.section .rodata,"a"
.p2align 6
.amdhsa_kernel k01_kernel
  .amdhsa_next_free_vgpr 128
  .amdhsa_next_free_sgpr 96
  .amdhsa_accum_offset 128
  .amdhsa_group_segment_fixed_size 0
  .amdhsa_kernarg_size 96
  .amdhsa_user_sgpr_count 2
  .amdhsa_user_sgpr_kernarg_segment_ptr 1
  .amdhsa_system_sgpr_workgroup_id_x 1
  .amdhsa_system_sgpr_workgroup_id_y 0
.end_amdhsa_kernel
.p2align 6
.amdhsa_kernel k2_kernel
  .amdhsa_next_free_vgpr 124
  .amdhsa_next_free_sgpr 96
  .amdhsa_accum_offset 124
  .amdhsa_group_segment_fixed_size 0
  .amdhsa_kernarg_size 96
  .amdhsa_user_sgpr_count 2
  .amdhsa_user_sgpr_kernarg_segment_ptr 1
  .amdhsa_system_sgpr_workgroup_id_x 1
  .amdhsa_system_sgpr_workgroup_id_y 0
.end_amdhsa_kernel
.p2align 6
.amdhsa_kernel k345_kernel
  .amdhsa_next_free_vgpr 512
  .amdhsa_next_free_sgpr 102
  .amdhsa_accum_offset 256
  .amdhsa_group_segment_fixed_size 0
  .amdhsa_kernarg_size 96
  .amdhsa_user_sgpr_count 2
  .amdhsa_user_sgpr_kernarg_segment_ptr 1
  .amdhsa_system_sgpr_workgroup_id_x 1
  .amdhsa_system_sgpr_workgroup_id_y 0
.end_amdhsa_kernel
```
